```python
import torch

def _softmax(x, axis=-1):
    return torch.softmax(x, dim=axis)
def _gelu(x):
    return torch.nn.functional.gelu(x, approximate="tanh")
def _silu(x):
    return torch.nn.functional.silu(x)
def _sigmoid(x):
    return torch.sigmoid(x)
def _layernorm(x, axis=-1, eps=1e-5):
    m = x.mean(dim=axis, keepdim=True)
    v = x.var(dim=axis, keepdim=True, unbiased=False)
    return (x - m) / torch.sqrt(v + eps)
def _scatter_add(tgt, idx, src, axis=0):
    return tgt.clone().index_add_(axis, idx, src)
def _segment_sum(src, seg, n):
    out = torch.zeros((n,) + src.shape[1:], dtype=src.dtype)
    return out.index_add_(0, seg, src)
def _pad(x, pw):
    flat = tuple(v for pair in reversed(pw) for v in pair)
    return torch.nn.functional.pad(x, flat)

kernel_name = 'interleave_layers__spectral_gfnet__linear_attn_block__prompt'

def setup_inputs():

    _w = (lambda a: (lambda t: t.to(torch.bfloat16) if t.is_floating_point() else t)(torch.as_tensor(a)))
    def _A_setup():
        B, S, D = 1, 2048, 576
        Df = D // 2 + 1
        return {
            "x": _w((lambda *s: torch.randn(*s, dtype=torch.bfloat16) * 0.05)(B, S, D)),
            "w_r": _w((lambda *s: torch.randn(*s, dtype=torch.bfloat16) * 0.4)(S, Df) * 0.02),
            "w_i": _w((lambda *s: torch.randn(*s, dtype=torch.bfloat16) * 0.4)(S, Df) * 0.02),
        }
    _A_in = _A_setup()

    def _B_setup():
        B, S, D = 1, 2048, 576
        return {
            "x": _w((lambda *s: torch.randn(*s, dtype=torch.bfloat16) * 0.05)(B, S, D)),
            "wqkv": _w((lambda *s: torch.randn(*s, dtype=torch.bfloat16) * 0.05)(D, 3 * D)),
            "wo": _w((lambda *s: torch.randn(*s, dtype=torch.bfloat16) * 0.05)(D, D)),
        }
    _B_in = _B_setup()

    return {
        "A_x": _A_in["x"],
        "A_w_r": _A_in["w_r"],
        "A_w_i": _A_in["w_i"],
        "B_x": _B_in["x"],
        "B_wqkv": _B_in["wqkv"],
        "B_wo": _B_in["wo"],
    }

def reference(A_x, A_w_r, A_w_i, B_x, B_wqkv, B_wo):
    def _A_ref(x, w_r, w_i):
        B, S, D = x.shape
        X = (lambda x, axes=(-2,-1): torch.fft.rfft2(x.float(), dim=axes))(x, axes=(-2, -1))
        W = w_r + 1j * w_i
        X = X * W
        y = (lambda x, s, axes=(-2,-1): torch.fft.irfft2(x, s=s, dim=axes).to(torch.bfloat16))(X, (S, D), axes=(-2, -1))
        return y

    def _B_ref(x, wqkv, wo):
        B, S, D = x.shape
        H = 32; Dh = D // H
        qkv = (lambda x, *d: x.permute(*d))((x @ wqkv).reshape(B, S, 3, H, Dh), 2, 0, 3, 1, 4)
        q, k, v = qkv[0], qkv[1], qkv[2]
        phi = lambda t: torch.where(t > 0, t + 1, torch.exp(t)) + 1e-6
        pq, pk = phi(q), phi(k)
        kv = torch.einsum("bhsd,bhse->bhde", pk, v)
        z = torch.einsum("bhsd->bhd", pk)
        num = torch.einsum("bhqd,bhde->bhqe", pq, kv)
        den = torch.einsum("bhqd,bhd->bhq", pq, z)[..., None] + 1e-6
        o = num / den
        return (lambda x, *d: x.permute(*d))(o, 0, 2, 1, 3).reshape(B, S, D) @ wo

    x = A_x
    x = x + _A_ref(_layernorm(x, axis=-1), A_w_r, A_w_i)
    x = x + _B_ref(_layernorm(x, axis=-1), B_wqkv, B_wo)
    x = x + _A_ref(_layernorm(x, axis=-1), A_w_r, A_w_i)
    x = x + _B_ref(_layernorm(x, axis=-1), B_wqkv, B_wo)
    return x
```

```asm
; @launch grid=(256,1,1) block=(512,1,1) lds=163840
.amdgcn_target "amdgcn-amd-amdhsa--gfx950"
.text
.globl interleave_layers__spectral_gfnet__linear_attn_block__prompt_kernel
.p2align 8
.type interleave_layers__spectral_gfnet__linear_attn_block__prompt_kernel,@function
interleave_layers__spectral_gfnet__linear_attn_block__prompt_kernel:
    s_cmp_ge_u32 s2, 256
    s_cbranch_scc1 L_end
    s_load_dwordx4 s[8:11], s[0:1], 0
    s_load_dwordx4 s[16:19], s[0:1], 32
    s_load_dwordx2 s[12:13], s[0:1], 16
    s_load_dwordx2 s[4:5], s[0:1], 64
    s_load_dwordx2 s[6:7], s[0:1], 48
    v_lshrrev_b32 v1, 6, v0
    s_nop 0
    v_readfirstlane_b32 s56, v1
    s_mov_b32 s62, 0x40000
    s_mov_b32 s63, 0x20000
    s_cmp_lg_u32 s56, 4
    s_cbranch_scc1 L_nopf
    s_getpc_b64 s[68:69]
L_pf:
    s_sub_u32 s68, s68, L_pf - interleave_layers__spectral_gfnet__linear_attn_block__prompt_kernel
    s_subb_u32 s69, s69, 0
    s_lshr_b32 s3, s2, 3
    s_lshl_b32 s3, s3, 4
    v_and_b32 v1, 15, v0
    v_add_u32 v1, s3, v1
    v_lshlrev_b32 v1, 7, v1
    v_min_u32 v1, L_interleave_layers__spectral_gfnet__linear_attn_block__prompt_kernel_codeend - interleave_layers__spectral_gfnet__linear_attn_block__prompt_kernel - 4, v1
    global_load_dword v207, v1, s[68:69]
L_nopf:
    v_bfe_u32 v8, v0, 3, 3
    v_and_b32 v9, 7, v0
    s_sub_u32 s20, s2, 80
    s_cmp_lt_u32 s20, 64
    s_cbranch_scc1 L_p1_wft
    s_sub_u32 s20, s2, 144
    s_cmp_lt_u32 s20, 108
    s_cselect_b32 s25, 48, 36
    s_cselect_b32 s26, 0, 36
    s_cselect_b32 s27, 32, 60
    s_cselect_b32 s45, 1, 0
    s_lshl_b32 s25, s25, 1
    s_sub_u32 s21, s2, 172
    s_cmp_ge_u32 s2, 252
    s_cselect_b32 s20, s21, s20
    s_cmp_lt_u32 s2, 80
    s_cselect_b32 s20, s2, s20
    s_lshr_b32 s21, s20, 3
    s_mul_i32 s22, s21, 0x5556
    s_lshr_b32 s22, s22, 16
    s_mul_i32 s23, s22, 3
    s_sub_u32 s23, s21, s23
    s_lshl_b32 s22, s22, 3
    s_and_b32 s21, s20, 7
    s_add_u32 s22, s22, s21
    s_add_u32 s22, s22, s26
    s_and_b32 s21, s20, 3
    s_add_u32 s27, s27, s21
    s_sub_u32 s21, s20, s25
    s_lshr_b32 s21, s21, 2
    s_cmp_ge_u32 s20, s25
    s_cselect_b32 s22, s27, s22
    s_cselect_b32 s23, s21, s23
    s_mov_b32 s31, 0x20000
    s_and_b32 s24, s56, 3
    s_lshr_b32 s57, s56, 2
    s_and_b32 s25, s22, 1
    s_lshl_b32 s25, s25, 2
    s_add_u32 s25, s25, s24
    s_lshl_b32 s25, s25, 8
    s_lshr_b32 s26, s22, 1
    s_add_u32 s25, s25, s26
    v_and_b32 v5, 6, v8
    v_xor_b32 v5, v9, v5
    v_lshlrev_b32 v3, 5, v8
    v_add_u32 v3, s25, v3
    v_mul_u32_u24 v7, 1152, v3
    v_lshl_add_u32 v7, v5, 4, v7
    s_mul_i32 s26, s57, 640
    v_add_u32 v7, s26, v7
    s_mul_i32 s25, s57, 20480
    s_lshl_b32 s26, s24, 10
    s_add_u32 s25, s25, s26
    s_mov_b32 s30, 0x240000
    s_waitcnt lgkmcnt(0)
    s_mov_b32 s28, s8
    s_mov_b32 s29, s9
    s_add_u32 m0, s25, 81920
    s_nop 0
    buffer_load_dwordx4 v7, s[28:31], 0 offen offset:0 lds
    s_add_u32 m0, s25, 85888
    s_nop 0
    buffer_load_dwordx4 v7, s[28:31], 0 offen offset:128 lds
    s_add_u32 m0, s25, 89856
    s_nop 0
    buffer_load_dwordx4 v7, s[28:31], 0 offen offset:256 lds
    s_add_u32 m0, s25, 93824
    s_nop 0
    buffer_load_dwordx4 v7, s[28:31], 0 offen offset:384 lds
    s_add_u32 m0, s25, 97792
    s_nop 0
    buffer_load_dwordx4 v7, s[28:31], 0 offen offset:512 lds
    s_mul_i32 s25, s22, 3
    s_add_u32 s25, s25, s23
    s_cmp_eq_u32 s56, 7
    s_cselect_b32 s40, s18, s16
    s_cselect_b32 s41, s19, s17
    s_cselect_b32 s26, 1, 3
    s_cselect_b32 s27, 7, 5
    s_mul_i32 s42, s26, 663552
    s_mov_b32 s43, 0x20000
    s_mul_i32 s26, s26, 27
    s_mul_i32 s25, s25, s26
    s_sub_u32 s26, s26, 1
    s_lshl_b32 s27, s27, 6
    s_cmp_lt_u32 s56, 5
    s_cselect_b32 s42, 0, s42
    v_subrev_u32 v4, s27, v0
    v_min_u32 v4, s26, v4
    v_add_u32 v4, s25, v4
    v_lshlrev_b32 v4, 7, v4
    buffer_load_dword v206, v4, s[40:43], 0 offen
    s_add_u32 s60, s4, 0x1380000
    s_addc_u32 s61, s5, 0
    s_load_dwordx2 s[64:65], s[60:61], 0x28000
    v_and_b32 v1, 15, v0
    v_bfe_u32 v2, v0, 4, 2
    s_lshr_b32 s57, s56, 2
    s_add_u32 s24, s56, s57
    s_and_b32 s24, s24, 3
    s_mul_i32 s32, s23, 12
    s_mul_i32 s33, s24, 3
    s_add_u32 s32, s32, s33
    s_lshl_b32 s33, s32, 4
    s_mov_b32 s36, 0x3ae38e39
    s_mov_b32 s37, 0x3d715bef
    s_mov_b32 s38, 0x3d2aaaab
    s_mov_b32 s39, 0x41c80000
    s_mov_b32 s40, 0x42000000
    v_cvt_f32_u32 v152, v2
    v_mul_f32 v152, 0x41000000, v152
    v_add_u32 v3, s33, v1
    s_add_u32 s33, s33, 16
    v_lshrrev_b32 v4, 1, v3
    v_and_b32 v5, 1, v3
    v_cvt_f32_u32 v149, v5
    v_mul_f32 v149, 0x3e800000, v149
    v_mov_b32 v150, s37
    v_mov_b32 v5, 0x120
    v_cmp_eq_u32 vcc, 0, v3
    s_nop 1
    v_cndmask_b32 v4, v4, v5, vcc
    v_cmp_gt_u32 vcc, 2, v3
    v_mov_b32 v5, s38
    s_nop 0
    v_cndmask_b32 v150, v150, v5, vcc
    v_cndmask_b32 v149, v149, 0, vcc
    v_cvt_f32_u32 v148, v4
    v_mul_f32 v148, s36, v148
    v_mul_f32 v153, s40, v148
    v_cos_f32 v153, v153
    v_fma_f32 v151, v152, v148, v149
    v_cos_f32 v132, v151
    v_add_f32 v151, v148, v151
    v_cos_f32 v133, v151
    v_add_f32 v151, v148, v151
    v_cos_f32 v134, v151
    v_add_f32 v151, v148, v151
    v_cos_f32 v135, v151
    v_add_f32 v151, v148, v151
    v_cos_f32 v136, v151
    v_add_f32 v151, v148, v151
    v_cos_f32 v137, v151
    v_add_f32 v151, v148, v151
    v_cos_f32 v138, v151
    v_add_f32 v151, v148, v151
    v_cos_f32 v139, v151
    v_fma_f32 v151, v148, s39, v151
    v_cos_f32 v140, v151
    v_add_f32 v151, v148, v151
    v_cos_f32 v141, v151
    v_add_f32 v151, v148, v151
    v_cos_f32 v142, v151
    v_add_f32 v151, v148, v151
    v_cos_f32 v143, v151
    v_add_f32 v151, v148, v151
    v_cos_f32 v144, v151
    v_add_f32 v151, v148, v151
    v_cos_f32 v145, v151
    v_add_f32 v151, v148, v151
    v_cos_f32 v146, v151
    v_add_f32 v151, v148, v151
    v_cos_f32 v147, v151
    v_pk_mul_f32 v[132:133], v[132:133], v[150:151] op_sel_hi:[1,0]
    v_pk_mul_f32 v[134:135], v[134:135], v[150:151] op_sel_hi:[1,0]
    v_pk_mul_f32 v[136:137], v[136:137], v[150:151] op_sel_hi:[1,0]
    v_pk_mul_f32 v[138:139], v[138:139], v[150:151] op_sel_hi:[1,0]
    v_pk_mul_f32 v[140:141], v[140:141], v[150:151] op_sel_hi:[1,0]
    v_pk_mul_f32 v[142:143], v[142:143], v[150:151] op_sel_hi:[1,0]
    v_pk_mul_f32 v[144:145], v[144:145], v[150:151] op_sel_hi:[1,0]
    v_pk_mul_f32 v[146:147], v[146:147], v[150:151] op_sel_hi:[1,0]
    v_add_f32 v151, v153, v153
    v_mov_b32 v148, v151
    v_cvt_pk_bf16_f32 v24, v132, v133
    v_cvt_pk_bf16_f32 v25, v134, v135
    v_cvt_pk_bf16_f32 v26, v136, v137
    v_cvt_pk_bf16_f32 v27, v138, v139
    v_pk_fma_f32 v[132:133], v[148:149], v[140:141], v[132:133] op_sel_hi:[0,1,1] neg_lo:[0,0,1] neg_hi:[0,0,1]
    v_pk_fma_f32 v[134:135], v[148:149], v[142:143], v[134:135] op_sel_hi:[0,1,1] neg_lo:[0,0,1] neg_hi:[0,0,1]
    v_pk_fma_f32 v[136:137], v[148:149], v[144:145], v[136:137] op_sel_hi:[0,1,1] neg_lo:[0,0,1] neg_hi:[0,0,1]
    v_pk_fma_f32 v[138:139], v[148:149], v[146:147], v[138:139] op_sel_hi:[0,1,1] neg_lo:[0,0,1] neg_hi:[0,0,1]
    v_cvt_pk_bf16_f32 v36, v140, v141
    v_cvt_pk_bf16_f32 v37, v142, v143
    v_cvt_pk_bf16_f32 v38, v144, v145
    v_cvt_pk_bf16_f32 v39, v146, v147
    v_pk_fma_f32 v[140:141], v[148:149], v[132:133], v[140:141] op_sel_hi:[0,1,1] neg_lo:[0,0,1] neg_hi:[0,0,1]
    v_pk_fma_f32 v[142:143], v[148:149], v[134:135], v[142:143] op_sel_hi:[0,1,1] neg_lo:[0,0,1] neg_hi:[0,0,1]
    v_pk_fma_f32 v[144:145], v[148:149], v[136:137], v[144:145] op_sel_hi:[0,1,1] neg_lo:[0,0,1] neg_hi:[0,0,1]
    v_pk_fma_f32 v[146:147], v[148:149], v[138:139], v[146:147] op_sel_hi:[0,1,1] neg_lo:[0,0,1] neg_hi:[0,0,1]
    v_cvt_pk_bf16_f32 v48, v132, v133
    v_cvt_pk_bf16_f32 v49, v134, v135
    v_cvt_pk_bf16_f32 v50, v136, v137
    v_cvt_pk_bf16_f32 v51, v138, v139
    v_pk_fma_f32 v[132:133], v[148:149], v[140:141], v[132:133] op_sel_hi:[0,1,1] neg_lo:[0,0,1] neg_hi:[0,0,1]
    v_pk_fma_f32 v[134:135], v[148:149], v[142:143], v[134:135] op_sel_hi:[0,1,1] neg_lo:[0,0,1] neg_hi:[0,0,1]
    v_pk_fma_f32 v[136:137], v[148:149], v[144:145], v[136:137] op_sel_hi:[0,1,1] neg_lo:[0,0,1] neg_hi:[0,0,1]
    v_pk_fma_f32 v[138:139], v[148:149], v[146:147], v[138:139] op_sel_hi:[0,1,1] neg_lo:[0,0,1] neg_hi:[0,0,1]
    v_cvt_pk_bf16_f32 v60, v140, v141
    v_cvt_pk_bf16_f32 v61, v142, v143
    v_cvt_pk_bf16_f32 v62, v144, v145
    v_cvt_pk_bf16_f32 v63, v146, v147
    v_pk_fma_f32 v[140:141], v[148:149], v[132:133], v[140:141] op_sel_hi:[0,1,1] neg_lo:[0,0,1] neg_hi:[0,0,1]
    v_pk_fma_f32 v[142:143], v[148:149], v[134:135], v[142:143] op_sel_hi:[0,1,1] neg_lo:[0,0,1] neg_hi:[0,0,1]
    v_pk_fma_f32 v[144:145], v[148:149], v[136:137], v[144:145] op_sel_hi:[0,1,1] neg_lo:[0,0,1] neg_hi:[0,0,1]
    v_pk_fma_f32 v[146:147], v[148:149], v[138:139], v[146:147] op_sel_hi:[0,1,1] neg_lo:[0,0,1] neg_hi:[0,0,1]
    v_cvt_pk_bf16_f32 v72, v132, v133
    v_cvt_pk_bf16_f32 v73, v134, v135
    v_cvt_pk_bf16_f32 v74, v136, v137
    v_cvt_pk_bf16_f32 v75, v138, v139
    v_pk_fma_f32 v[132:133], v[148:149], v[140:141], v[132:133] op_sel_hi:[0,1,1] neg_lo:[0,0,1] neg_hi:[0,0,1]
    v_pk_fma_f32 v[134:135], v[148:149], v[142:143], v[134:135] op_sel_hi:[0,1,1] neg_lo:[0,0,1] neg_hi:[0,0,1]
    v_pk_fma_f32 v[136:137], v[148:149], v[144:145], v[136:137] op_sel_hi:[0,1,1] neg_lo:[0,0,1] neg_hi:[0,0,1]
    v_pk_fma_f32 v[138:139], v[148:149], v[146:147], v[138:139] op_sel_hi:[0,1,1] neg_lo:[0,0,1] neg_hi:[0,0,1]
    v_cvt_pk_bf16_f32 v84, v140, v141
    v_cvt_pk_bf16_f32 v85, v142, v143
    v_cvt_pk_bf16_f32 v86, v144, v145
    v_cvt_pk_bf16_f32 v87, v146, v147
    v_pk_fma_f32 v[140:141], v[148:149], v[132:133], v[140:141] op_sel_hi:[0,1,1] neg_lo:[0,0,1] neg_hi:[0,0,1]
    v_pk_fma_f32 v[142:143], v[148:149], v[134:135], v[142:143] op_sel_hi:[0,1,1] neg_lo:[0,0,1] neg_hi:[0,0,1]
    v_pk_fma_f32 v[144:145], v[148:149], v[136:137], v[144:145] op_sel_hi:[0,1,1] neg_lo:[0,0,1] neg_hi:[0,0,1]
    v_pk_fma_f32 v[146:147], v[148:149], v[138:139], v[146:147] op_sel_hi:[0,1,1] neg_lo:[0,0,1] neg_hi:[0,0,1]
    v_cvt_pk_bf16_f32 v96, v132, v133
    v_cvt_pk_bf16_f32 v97, v134, v135
    v_cvt_pk_bf16_f32 v98, v136, v137
    v_cvt_pk_bf16_f32 v99, v138, v139
    v_pk_fma_f32 v[132:133], v[148:149], v[140:141], v[132:133] op_sel_hi:[0,1,1] neg_lo:[0,0,1] neg_hi:[0,0,1]
    v_pk_fma_f32 v[134:135], v[148:149], v[142:143], v[134:135] op_sel_hi:[0,1,1] neg_lo:[0,0,1] neg_hi:[0,0,1]
    v_pk_fma_f32 v[136:137], v[148:149], v[144:145], v[136:137] op_sel_hi:[0,1,1] neg_lo:[0,0,1] neg_hi:[0,0,1]
    v_pk_fma_f32 v[138:139], v[148:149], v[146:147], v[138:139] op_sel_hi:[0,1,1] neg_lo:[0,0,1] neg_hi:[0,0,1]
    v_cvt_pk_bf16_f32 v108, v140, v141
    v_cvt_pk_bf16_f32 v109, v142, v143
    v_cvt_pk_bf16_f32 v110, v144, v145
    v_cvt_pk_bf16_f32 v111, v146, v147
    v_cvt_pk_bf16_f32 v120, v132, v133
    v_cvt_pk_bf16_f32 v121, v134, v135
    v_cvt_pk_bf16_f32 v122, v136, v137
    v_cvt_pk_bf16_f32 v123, v138, v139
    v_add_u32 v3, s33, v1
    s_add_u32 s33, s33, 16
    v_lshrrev_b32 v4, 1, v3
    v_and_b32 v5, 1, v3
    v_cvt_f32_u32 v149, v5
    v_mul_f32 v149, 0x3e800000, v149
    v_mov_b32 v150, s37
    v_cvt_f32_u32 v148, v4
    v_mul_f32 v148, s36, v148
    v_mul_f32 v153, s40, v148
    v_cos_f32 v153, v153
    v_fma_f32 v151, v152, v148, v149
    v_cos_f32 v132, v151
    v_add_f32 v151, v148, v151
    v_cos_f32 v133, v151
    v_add_f32 v151, v148, v151
    v_cos_f32 v134, v151
    v_add_f32 v151, v148, v151
    v_cos_f32 v135, v151
    v_add_f32 v151, v148, v151
    v_cos_f32 v136, v151
    v_add_f32 v151, v148, v151
    v_cos_f32 v137, v151
    v_add_f32 v151, v148, v151
    v_cos_f32 v138, v151
    v_add_f32 v151, v148, v151
    v_cos_f32 v139, v151
    v_fma_f32 v151, v148, s39, v151
    v_cos_f32 v140, v151
    v_add_f32 v151, v148, v151
    v_cos_f32 v141, v151
    v_add_f32 v151, v148, v151
    v_cos_f32 v142, v151
    v_add_f32 v151, v148, v151
    v_cos_f32 v143, v151
    v_add_f32 v151, v148, v151
    v_cos_f32 v144, v151
    v_add_f32 v151, v148, v151
    v_cos_f32 v145, v151
    v_add_f32 v151, v148, v151
    v_cos_f32 v146, v151
    v_add_f32 v151, v148, v151
    v_cos_f32 v147, v151
    v_pk_mul_f32 v[132:133], v[132:133], v[150:151] op_sel_hi:[1,0]
    v_pk_mul_f32 v[134:135], v[134:135], v[150:151] op_sel_hi:[1,0]
    v_pk_mul_f32 v[136:137], v[136:137], v[150:151] op_sel_hi:[1,0]
    v_pk_mul_f32 v[138:139], v[138:139], v[150:151] op_sel_hi:[1,0]
    v_pk_mul_f32 v[140:141], v[140:141], v[150:151] op_sel_hi:[1,0]
    v_pk_mul_f32 v[142:143], v[142:143], v[150:151] op_sel_hi:[1,0]
    v_pk_mul_f32 v[144:145], v[144:145], v[150:151] op_sel_hi:[1,0]
    v_pk_mul_f32 v[146:147], v[146:147], v[150:151] op_sel_hi:[1,0]
    v_add_f32 v151, v153, v153
    v_mov_b32 v148, v151
    v_cvt_pk_bf16_f32 v28, v132, v133
    v_cvt_pk_bf16_f32 v29, v134, v135
    v_cvt_pk_bf16_f32 v30, v136, v137
    v_cvt_pk_bf16_f32 v31, v138, v139
    v_pk_fma_f32 v[132:133], v[148:149], v[140:141], v[132:133] op_sel_hi:[0,1,1] neg_lo:[0,0,1] neg_hi:[0,0,1]
    v_pk_fma_f32 v[134:135], v[148:149], v[142:143], v[134:135] op_sel_hi:[0,1,1] neg_lo:[0,0,1] neg_hi:[0,0,1]
    v_pk_fma_f32 v[136:137], v[148:149], v[144:145], v[136:137] op_sel_hi:[0,1,1] neg_lo:[0,0,1] neg_hi:[0,0,1]
    v_pk_fma_f32 v[138:139], v[148:149], v[146:147], v[138:139] op_sel_hi:[0,1,1] neg_lo:[0,0,1] neg_hi:[0,0,1]
    v_cvt_pk_bf16_f32 v40, v140, v141
    v_cvt_pk_bf16_f32 v41, v142, v143
    v_cvt_pk_bf16_f32 v42, v144, v145
    v_cvt_pk_bf16_f32 v43, v146, v147
    v_pk_fma_f32 v[140:141], v[148:149], v[132:133], v[140:141] op_sel_hi:[0,1,1] neg_lo:[0,0,1] neg_hi:[0,0,1]
    v_pk_fma_f32 v[142:143], v[148:149], v[134:135], v[142:143] op_sel_hi:[0,1,1] neg_lo:[0,0,1] neg_hi:[0,0,1]
    v_pk_fma_f32 v[144:145], v[148:149], v[136:137], v[144:145] op_sel_hi:[0,1,1] neg_lo:[0,0,1] neg_hi:[0,0,1]
    v_pk_fma_f32 v[146:147], v[148:149], v[138:139], v[146:147] op_sel_hi:[0,1,1] neg_lo:[0,0,1] neg_hi:[0,0,1]
    v_cvt_pk_bf16_f32 v52, v132, v133
    v_cvt_pk_bf16_f32 v53, v134, v135
    v_cvt_pk_bf16_f32 v54, v136, v137
    v_cvt_pk_bf16_f32 v55, v138, v139
    v_pk_fma_f32 v[132:133], v[148:149], v[140:141], v[132:133] op_sel_hi:[0,1,1] neg_lo:[0,0,1] neg_hi:[0,0,1]
    v_pk_fma_f32 v[134:135], v[148:149], v[142:143], v[134:135] op_sel_hi:[0,1,1] neg_lo:[0,0,1] neg_hi:[0,0,1]
    v_pk_fma_f32 v[136:137], v[148:149], v[144:145], v[136:137] op_sel_hi:[0,1,1] neg_lo:[0,0,1] neg_hi:[0,0,1]
    v_pk_fma_f32 v[138:139], v[148:149], v[146:147], v[138:139] op_sel_hi:[0,1,1] neg_lo:[0,0,1] neg_hi:[0,0,1]
    v_cvt_pk_bf16_f32 v64, v140, v141
    v_cvt_pk_bf16_f32 v65, v142, v143
    v_cvt_pk_bf16_f32 v66, v144, v145
    v_cvt_pk_bf16_f32 v67, v146, v147
    v_pk_fma_f32 v[140:141], v[148:149], v[132:133], v[140:141] op_sel_hi:[0,1,1] neg_lo:[0,0,1] neg_hi:[0,0,1]
    v_pk_fma_f32 v[142:143], v[148:149], v[134:135], v[142:143] op_sel_hi:[0,1,1] neg_lo:[0,0,1] neg_hi:[0,0,1]
    v_pk_fma_f32 v[144:145], v[148:149], v[136:137], v[144:145] op_sel_hi:[0,1,1] neg_lo:[0,0,1] neg_hi:[0,0,1]
    v_pk_fma_f32 v[146:147], v[148:149], v[138:139], v[146:147] op_sel_hi:[0,1,1] neg_lo:[0,0,1] neg_hi:[0,0,1]
    v_cvt_pk_bf16_f32 v76, v132, v133
    v_cvt_pk_bf16_f32 v77, v134, v135
    v_cvt_pk_bf16_f32 v78, v136, v137
    v_cvt_pk_bf16_f32 v79, v138, v139
    v_pk_fma_f32 v[132:133], v[148:149], v[140:141], v[132:133] op_sel_hi:[0,1,1] neg_lo:[0,0,1] neg_hi:[0,0,1]
    v_pk_fma_f32 v[134:135], v[148:149], v[142:143], v[134:135] op_sel_hi:[0,1,1] neg_lo:[0,0,1] neg_hi:[0,0,1]
    v_pk_fma_f32 v[136:137], v[148:149], v[144:145], v[136:137] op_sel_hi:[0,1,1] neg_lo:[0,0,1] neg_hi:[0,0,1]
    v_pk_fma_f32 v[138:139], v[148:149], v[146:147], v[138:139] op_sel_hi:[0,1,1] neg_lo:[0,0,1] neg_hi:[0,0,1]
    v_cvt_pk_bf16_f32 v88, v140, v141
    v_cvt_pk_bf16_f32 v89, v142, v143
    v_cvt_pk_bf16_f32 v90, v144, v145
    v_cvt_pk_bf16_f32 v91, v146, v147
    v_pk_fma_f32 v[140:141], v[148:149], v[132:133], v[140:141] op_sel_hi:[0,1,1] neg_lo:[0,0,1] neg_hi:[0,0,1]
    v_pk_fma_f32 v[142:143], v[148:149], v[134:135], v[142:143] op_sel_hi:[0,1,1] neg_lo:[0,0,1] neg_hi:[0,0,1]
    v_pk_fma_f32 v[144:145], v[148:149], v[136:137], v[144:145] op_sel_hi:[0,1,1] neg_lo:[0,0,1] neg_hi:[0,0,1]
    v_pk_fma_f32 v[146:147], v[148:149], v[138:139], v[146:147] op_sel_hi:[0,1,1] neg_lo:[0,0,1] neg_hi:[0,0,1]
    v_cvt_pk_bf16_f32 v100, v132, v133
    v_cvt_pk_bf16_f32 v101, v134, v135
    v_cvt_pk_bf16_f32 v102, v136, v137
    v_cvt_pk_bf16_f32 v103, v138, v139
    v_pk_fma_f32 v[132:133], v[148:149], v[140:141], v[132:133] op_sel_hi:[0,1,1] neg_lo:[0,0,1] neg_hi:[0,0,1]
    v_pk_fma_f32 v[134:135], v[148:149], v[142:143], v[134:135] op_sel_hi:[0,1,1] neg_lo:[0,0,1] neg_hi:[0,0,1]
    v_pk_fma_f32 v[136:137], v[148:149], v[144:145], v[136:137] op_sel_hi:[0,1,1] neg_lo:[0,0,1] neg_hi:[0,0,1]
    v_pk_fma_f32 v[138:139], v[148:149], v[146:147], v[138:139] op_sel_hi:[0,1,1] neg_lo:[0,0,1] neg_hi:[0,0,1]
    v_cvt_pk_bf16_f32 v112, v140, v141
    v_cvt_pk_bf16_f32 v113, v142, v143
    v_cvt_pk_bf16_f32 v114, v144, v145
    v_cvt_pk_bf16_f32 v115, v146, v147
    v_cvt_pk_bf16_f32 v124, v132, v133
    v_cvt_pk_bf16_f32 v125, v134, v135
    v_cvt_pk_bf16_f32 v126, v136, v137
    v_cvt_pk_bf16_f32 v127, v138, v139
    v_add_u32 v3, s33, v1
    v_lshrrev_b32 v4, 1, v3
    v_and_b32 v5, 1, v3
    v_cvt_f32_u32 v149, v5
    v_mul_f32 v149, 0x3e800000, v149
    v_mov_b32 v150, s37
    v_cvt_f32_u32 v148, v4
    v_mul_f32 v148, s36, v148
    v_mul_f32 v153, s40, v148
    v_cos_f32 v153, v153
    v_fma_f32 v151, v152, v148, v149
    v_cos_f32 v132, v151
    v_add_f32 v151, v148, v151
    v_cos_f32 v133, v151
    v_add_f32 v151, v148, v151
    v_cos_f32 v134, v151
    v_add_f32 v151, v148, v151
    v_cos_f32 v135, v151
    v_add_f32 v151, v148, v151
    v_cos_f32 v136, v151
    v_add_f32 v151, v148, v151
    v_cos_f32 v137, v151
    v_add_f32 v151, v148, v151
    v_cos_f32 v138, v151
    v_add_f32 v151, v148, v151
    v_cos_f32 v139, v151
    v_fma_f32 v151, v148, s39, v151
    v_cos_f32 v140, v151
    v_add_f32 v151, v148, v151
    v_cos_f32 v141, v151
    v_add_f32 v151, v148, v151
    v_cos_f32 v142, v151
    v_add_f32 v151, v148, v151
    v_cos_f32 v143, v151
    v_add_f32 v151, v148, v151
    v_cos_f32 v144, v151
    v_add_f32 v151, v148, v151
    v_cos_f32 v145, v151
    v_add_f32 v151, v148, v151
    v_cos_f32 v146, v151
    v_add_f32 v151, v148, v151
    v_cos_f32 v147, v151
    v_pk_mul_f32 v[132:133], v[132:133], v[150:151] op_sel_hi:[1,0]
    v_pk_mul_f32 v[134:135], v[134:135], v[150:151] op_sel_hi:[1,0]
    v_pk_mul_f32 v[136:137], v[136:137], v[150:151] op_sel_hi:[1,0]
    v_pk_mul_f32 v[138:139], v[138:139], v[150:151] op_sel_hi:[1,0]
    v_pk_mul_f32 v[140:141], v[140:141], v[150:151] op_sel_hi:[1,0]
    v_pk_mul_f32 v[142:143], v[142:143], v[150:151] op_sel_hi:[1,0]
    v_pk_mul_f32 v[144:145], v[144:145], v[150:151] op_sel_hi:[1,0]
    v_pk_mul_f32 v[146:147], v[146:147], v[150:151] op_sel_hi:[1,0]
    v_add_f32 v151, v153, v153
    v_mov_b32 v148, v151
    v_cvt_pk_bf16_f32 v32, v132, v133
    v_cvt_pk_bf16_f32 v33, v134, v135
    v_cvt_pk_bf16_f32 v34, v136, v137
    v_cvt_pk_bf16_f32 v35, v138, v139
    v_pk_fma_f32 v[132:133], v[148:149], v[140:141], v[132:133] op_sel_hi:[0,1,1] neg_lo:[0,0,1] neg_hi:[0,0,1]
    v_pk_fma_f32 v[134:135], v[148:149], v[142:143], v[134:135] op_sel_hi:[0,1,1] neg_lo:[0,0,1] neg_hi:[0,0,1]
    v_pk_fma_f32 v[136:137], v[148:149], v[144:145], v[136:137] op_sel_hi:[0,1,1] neg_lo:[0,0,1] neg_hi:[0,0,1]
    v_pk_fma_f32 v[138:139], v[148:149], v[146:147], v[138:139] op_sel_hi:[0,1,1] neg_lo:[0,0,1] neg_hi:[0,0,1]
    v_cvt_pk_bf16_f32 v44, v140, v141
    v_cvt_pk_bf16_f32 v45, v142, v143
    v_cvt_pk_bf16_f32 v46, v144, v145
    v_cvt_pk_bf16_f32 v47, v146, v147
    v_pk_fma_f32 v[140:141], v[148:149], v[132:133], v[140:141] op_sel_hi:[0,1,1] neg_lo:[0,0,1] neg_hi:[0,0,1]
    v_pk_fma_f32 v[142:143], v[148:149], v[134:135], v[142:143] op_sel_hi:[0,1,1] neg_lo:[0,0,1] neg_hi:[0,0,1]
    v_pk_fma_f32 v[144:145], v[148:149], v[136:137], v[144:145] op_sel_hi:[0,1,1] neg_lo:[0,0,1] neg_hi:[0,0,1]
    v_pk_fma_f32 v[146:147], v[148:149], v[138:139], v[146:147] op_sel_hi:[0,1,1] neg_lo:[0,0,1] neg_hi:[0,0,1]
    v_cvt_pk_bf16_f32 v56, v132, v133
    v_cvt_pk_bf16_f32 v57, v134, v135
    v_cvt_pk_bf16_f32 v58, v136, v137
    v_cvt_pk_bf16_f32 v59, v138, v139
    v_pk_fma_f32 v[132:133], v[148:149], v[140:141], v[132:133] op_sel_hi:[0,1,1] neg_lo:[0,0,1] neg_hi:[0,0,1]
    v_pk_fma_f32 v[134:135], v[148:149], v[142:143], v[134:135] op_sel_hi:[0,1,1] neg_lo:[0,0,1] neg_hi:[0,0,1]
    v_pk_fma_f32 v[136:137], v[148:149], v[144:145], v[136:137] op_sel_hi:[0,1,1] neg_lo:[0,0,1] neg_hi:[0,0,1]
    v_pk_fma_f32 v[138:139], v[148:149], v[146:147], v[138:139] op_sel_hi:[0,1,1] neg_lo:[0,0,1] neg_hi:[0,0,1]
    v_cvt_pk_bf16_f32 v68, v140, v141
    v_cvt_pk_bf16_f32 v69, v142, v143
    v_cvt_pk_bf16_f32 v70, v144, v145
    v_cvt_pk_bf16_f32 v71, v146, v147
    v_pk_fma_f32 v[140:141], v[148:149], v[132:133], v[140:141] op_sel_hi:[0,1,1] neg_lo:[0,0,1] neg_hi:[0,0,1]
    v_pk_fma_f32 v[142:143], v[148:149], v[134:135], v[142:143] op_sel_hi:[0,1,1] neg_lo:[0,0,1] neg_hi:[0,0,1]
    v_pk_fma_f32 v[144:145], v[148:149], v[136:137], v[144:145] op_sel_hi:[0,1,1] neg_lo:[0,0,1] neg_hi:[0,0,1]
    v_pk_fma_f32 v[146:147], v[148:149], v[138:139], v[146:147] op_sel_hi:[0,1,1] neg_lo:[0,0,1] neg_hi:[0,0,1]
    v_cvt_pk_bf16_f32 v80, v132, v133
    v_cvt_pk_bf16_f32 v81, v134, v135
    v_cvt_pk_bf16_f32 v82, v136, v137
    v_cvt_pk_bf16_f32 v83, v138, v139
    v_pk_fma_f32 v[132:133], v[148:149], v[140:141], v[132:133] op_sel_hi:[0,1,1] neg_lo:[0,0,1] neg_hi:[0,0,1]
    v_pk_fma_f32 v[134:135], v[148:149], v[142:143], v[134:135] op_sel_hi:[0,1,1] neg_lo:[0,0,1] neg_hi:[0,0,1]
    v_pk_fma_f32 v[136:137], v[148:149], v[144:145], v[136:137] op_sel_hi:[0,1,1] neg_lo:[0,0,1] neg_hi:[0,0,1]
    v_pk_fma_f32 v[138:139], v[148:149], v[146:147], v[138:139] op_sel_hi:[0,1,1] neg_lo:[0,0,1] neg_hi:[0,0,1]
    v_cvt_pk_bf16_f32 v92, v140, v141
    v_cvt_pk_bf16_f32 v93, v142, v143
    v_cvt_pk_bf16_f32 v94, v144, v145
    v_cvt_pk_bf16_f32 v95, v146, v147
    v_pk_fma_f32 v[140:141], v[148:149], v[132:133], v[140:141] op_sel_hi:[0,1,1] neg_lo:[0,0,1] neg_hi:[0,0,1]
    v_pk_fma_f32 v[142:143], v[148:149], v[134:135], v[142:143] op_sel_hi:[0,1,1] neg_lo:[0,0,1] neg_hi:[0,0,1]
    v_pk_fma_f32 v[144:145], v[148:149], v[136:137], v[144:145] op_sel_hi:[0,1,1] neg_lo:[0,0,1] neg_hi:[0,0,1]
    v_pk_fma_f32 v[146:147], v[148:149], v[138:139], v[146:147] op_sel_hi:[0,1,1] neg_lo:[0,0,1] neg_hi:[0,0,1]
    v_cvt_pk_bf16_f32 v104, v132, v133
    v_cvt_pk_bf16_f32 v105, v134, v135
    v_cvt_pk_bf16_f32 v106, v136, v137
    v_cvt_pk_bf16_f32 v107, v138, v139
    v_pk_fma_f32 v[132:133], v[148:149], v[140:141], v[132:133] op_sel_hi:[0,1,1] neg_lo:[0,0,1] neg_hi:[0,0,1]
    v_pk_fma_f32 v[134:135], v[148:149], v[142:143], v[134:135] op_sel_hi:[0,1,1] neg_lo:[0,0,1] neg_hi:[0,0,1]
    v_pk_fma_f32 v[136:137], v[148:149], v[144:145], v[136:137] op_sel_hi:[0,1,1] neg_lo:[0,0,1] neg_hi:[0,0,1]
    v_pk_fma_f32 v[138:139], v[148:149], v[146:147], v[138:139] op_sel_hi:[0,1,1] neg_lo:[0,0,1] neg_hi:[0,0,1]
    v_cvt_pk_bf16_f32 v116, v140, v141
    v_cvt_pk_bf16_f32 v117, v142, v143
    v_cvt_pk_bf16_f32 v118, v144, v145
    v_cvt_pk_bf16_f32 v119, v146, v147
    v_cvt_pk_bf16_f32 v128, v132, v133
    v_cvt_pk_bf16_f32 v129, v134, v135
    v_cvt_pk_bf16_f32 v130, v136, v137
    v_cvt_pk_bf16_f32 v131, v138, v139
    v_and_b32 v3, 6, v1
    v_xor_b32 v3, v3, v2
    v_lshlrev_b32 v6, 7, v1
    v_lshl_add_u32 v6, v3, 4, v6
    s_lshl_b32 s25, s57, 11
    s_add_u32 s25, s25, 81920
    v_add_u32 v12, s25, v6
    v_xor_b32 v13, 64, v12
    s_lshl_b32 s41, s32, 16
    s_lshl_b32 s26, s22, 8
    s_add_u32 s41, s41, s26
    s_lshl_b32 s26, s57, 7
    s_add_u32 s41, s41, s26
    s_add_u32 s42, s41, 0x10000
    s_add_u32 s43, s41, 0x20000
    v_lshlrev_b32 v16, 14, v2
    v_lshl_add_u32 v16, v1, 3, v16
    s_mov_b32 s48, s4
    s_mov_b32 s49, s5
    s_mov_b32 s50, 0x240000
    s_mov_b32 s51, 0x20000
    s_add_u32 s52, s4, 0x1328000
    s_addc_u32 s53, s5, 0
    s_mov_b32 s54, 0x2000
    s_mov_b32 s55, 0x20000
    s_cmp_ge_u32 s22, 9
    s_cbranch_scc1 L_p1_sw
    s_movk_i32 s27, 128
    v_and_b32 v5, 6, v8
    v_xor_b32 v9, v9, v5
    s_mov_b32 s25, s22
    s_lshl_b32 s25, s25, 2
    s_lshr_b32 s26, s56, 1
    s_add_u32 s25, s25, s26
    s_mul_i32 s26, s25, 0x1c72
    s_lshr_b32 s26, s26, 16
    s_mul_i32 s35, s26, 9
    s_sub_u32 s25, s25, s35
    s_lshl_b32 s25, s25, 3
    s_mul_i32 s26, s26, 144
    s_and_b32 s35, s56, 1
    s_mul_i32 s35, s35, 9
    s_add_u32 s26, s26, s35
    v_add_u32 v3, s25, v8
    v_mul_u32_u24 v4, 0x1c72, v3
    v_lshrrev_b32 v4, 16, v4
    v_mad_u32_u24 v3, v4, 9, v3
    v_add_u32 v3, s26, v3
    v_mul_u32_u24 v7, 1152, v3
    v_lshl_add_u32 v7, v9, 4, v7
    s_mov_b32 s28, s18
    s_mov_b32 s29, s19
    s_mov_b32 s30, 663552
    s_branch L_p1_se
L_p1_sw:
    s_mov_b32 s27, 221184
    s_sub_u32 s25, s22, 9
    s_lshl_b32 s25, s25, 7
    s_mul_i32 s26, s56, 27648
    s_add_u32 s25, s25, s26
    s_and_b32 s26, s56, 1
    s_lshl_b32 s26, s26, 2
    v_and_b32 v5, 2, v8
    v_xor_b32 v9, v9, v5
    v_xor_b32 v9, s26, v9
    v_mul_u32_u24 v7, 3456, v8
    v_lshl_add_u32 v7, v9, 4, v7
    v_add_u32 v7, s25, v7
    s_mov_b32 s28, s16
    s_mov_b32 s29, s17
    s_mov_b32 s30, 1990656
L_p1_se:
    s_mul_i32 s30, s30, s45
    s_lshl_b32 s46, s56, 10
    s_waitcnt vmcnt(1) lgkmcnt(0)
    s_barrier
    ds_read_b128 v[132:135], v12 offset:0
    ds_read_b128 v[168:171], v13 offset:16384
    ds_read_b128 v[136:139], v13 offset:0
    ds_read_b128 v[172:175], v12 offset:20480
    ds_read_b128 v[140:143], v12 offset:4096
    ds_read_b128 v[176:179], v13 offset:20480
    ds_read_b128 v[144:147], v13 offset:4096
    ds_read_b128 v[180:183], v12 offset:24576
    ds_read_b128 v[148:151], v12 offset:8192
    ds_read_b128 v[184:187], v13 offset:24576
    ds_read_b128 v[152:155], v13 offset:8192
    ds_read_b128 v[188:191], v12 offset:28672
    ds_read_b128 v[156:159], v12 offset:12288
    ds_read_b128 v[192:195], v13 offset:28672
    ds_read_b128 v[160:163], v13 offset:12288
    ds_read_b128 v[196:199], v12 offset:32768
    ds_read_b128 v[164:167], v12 offset:16384
    ds_read_b128 v[200:203], v13 offset:32768
    s_waitcnt lgkmcnt(15)
    v_mfma_f32_16x16x32_bf16 a[0:3], v[24:27], v[132:135], 0
    v_mfma_f32_16x16x32_bf16 a[4:7], v[28:31], v[132:135], 0
    v_mfma_f32_16x16x32_bf16 a[8:11], v[32:35], v[132:135], 0
    v_mfma_f32_16x16x32_bf16 a[12:15], v[24:27], v[168:171], 0
    v_mfma_f32_16x16x32_bf16 a[16:19], v[28:31], v[168:171], 0
    s_add_u32 m0, s46, 0
    s_mul_i32 s47, s27, 0
    buffer_load_dwordx4 v7, s[28:31], s47 offen lds
    v_mfma_f32_16x16x32_bf16 a[20:23], v[32:35], v[168:171], 0
    v_mfma_f32_16x16x32_bf16 a[0:3], v[36:39], v[136:139], a[0:3]
    v_mfma_f32_16x16x32_bf16 a[4:7], v[40:43], v[136:139], a[4:7]
    v_mfma_f32_16x16x32_bf16 a[8:11], v[44:47], v[136:139], a[8:11]
    s_waitcnt lgkmcnt(14)
    v_mfma_f32_16x16x32_bf16 a[12:15], v[36:39], v[172:175], a[12:15]
    s_add_u32 m0, s46, 8192
    s_mul_i32 s47, s27, 1
    buffer_load_dwordx4 v7, s[28:31], s47 offen lds
    v_mfma_f32_16x16x32_bf16 a[16:19], v[40:43], v[172:175], a[16:19]
    v_mfma_f32_16x16x32_bf16 a[20:23], v[44:47], v[172:175], a[20:23]
    s_waitcnt lgkmcnt(13)
    v_mfma_f32_16x16x32_bf16 a[0:3], v[48:51], v[140:143], a[0:3]
    v_mfma_f32_16x16x32_bf16 a[4:7], v[52:55], v[140:143], a[4:7]
    v_mfma_f32_16x16x32_bf16 a[8:11], v[56:59], v[140:143], a[8:11]
    s_add_u32 m0, s46, 16384
    s_mul_i32 s47, s27, 2
    buffer_load_dwordx4 v7, s[28:31], s47 offen lds
    s_waitcnt lgkmcnt(12)
    v_mfma_f32_16x16x32_bf16 a[12:15], v[48:51], v[176:179], a[12:15]
    v_mfma_f32_16x16x32_bf16 a[16:19], v[52:55], v[176:179], a[16:19]
    v_mfma_f32_16x16x32_bf16 a[20:23], v[56:59], v[176:179], a[20:23]
    s_waitcnt lgkmcnt(11)
    v_mfma_f32_16x16x32_bf16 a[0:3], v[60:63], v[144:147], a[0:3]
    v_mfma_f32_16x16x32_bf16 a[4:7], v[64:67], v[144:147], a[4:7]
    s_add_u32 m0, s46, 24576
    s_mul_i32 s47, s27, 3
    buffer_load_dwordx4 v7, s[28:31], s47 offen lds
    v_mfma_f32_16x16x32_bf16 a[8:11], v[68:71], v[144:147], a[8:11]
    s_waitcnt lgkmcnt(10)
    v_mfma_f32_16x16x32_bf16 a[12:15], v[60:63], v[180:183], a[12:15]
    v_mfma_f32_16x16x32_bf16 a[16:19], v[64:67], v[180:183], a[16:19]
    v_mfma_f32_16x16x32_bf16 a[20:23], v[68:71], v[180:183], a[20:23]
    s_waitcnt lgkmcnt(9)
    v_mfma_f32_16x16x32_bf16 a[0:3], v[72:75], v[148:151], a[0:3]
    s_add_u32 m0, s46, 32768
    s_mul_i32 s47, s27, 4
    buffer_load_dwordx4 v7, s[28:31], s47 offen lds
    v_mfma_f32_16x16x32_bf16 a[4:7], v[76:79], v[148:151], a[4:7]
    v_mfma_f32_16x16x32_bf16 a[8:11], v[80:83], v[148:151], a[8:11]
    s_waitcnt lgkmcnt(8)
    v_mfma_f32_16x16x32_bf16 a[12:15], v[72:75], v[184:187], a[12:15]
    v_mfma_f32_16x16x32_bf16 a[16:19], v[76:79], v[184:187], a[16:19]
    v_mfma_f32_16x16x32_bf16 a[20:23], v[80:83], v[184:187], a[20:23]
    s_add_u32 m0, s46, 40960
    s_mul_i32 s47, s27, 5
    buffer_load_dwordx4 v7, s[28:31], s47 offen lds
    s_waitcnt lgkmcnt(7)
    v_mfma_f32_16x16x32_bf16 a[0:3], v[84:87], v[152:155], a[0:3]
    v_mfma_f32_16x16x32_bf16 a[4:7], v[88:91], v[152:155], a[4:7]
    v_mfma_f32_16x16x32_bf16 a[8:11], v[92:95], v[152:155], a[8:11]
    s_waitcnt lgkmcnt(6)
    v_mfma_f32_16x16x32_bf16 a[12:15], v[84:87], v[188:191], a[12:15]
    v_mfma_f32_16x16x32_bf16 a[16:19], v[88:91], v[188:191], a[16:19]
    s_add_u32 m0, s46, 49152
    s_mul_i32 s47, s27, 6
    buffer_load_dwordx4 v7, s[28:31], s47 offen lds
    v_mfma_f32_16x16x32_bf16 a[20:23], v[92:95], v[188:191], a[20:23]
    s_waitcnt lgkmcnt(5)
    v_mfma_f32_16x16x32_bf16 a[0:3], v[96:99], v[156:159], a[0:3]
    v_mfma_f32_16x16x32_bf16 a[4:7], v[100:103], v[156:159], a[4:7]
    v_mfma_f32_16x16x32_bf16 a[8:11], v[104:107], v[156:159], a[8:11]
    s_waitcnt lgkmcnt(4)
    v_mfma_f32_16x16x32_bf16 a[12:15], v[96:99], v[192:195], a[12:15]
    s_add_u32 m0, s46, 57344
    s_mul_i32 s47, s27, 7
    buffer_load_dwordx4 v7, s[28:31], s47 offen lds
    v_mfma_f32_16x16x32_bf16 a[16:19], v[100:103], v[192:195], a[16:19]
    v_mfma_f32_16x16x32_bf16 a[20:23], v[104:107], v[192:195], a[20:23]
    s_waitcnt lgkmcnt(3)
    v_mfma_f32_16x16x32_bf16 a[0:3], v[108:111], v[160:163], a[0:3]
    v_mfma_f32_16x16x32_bf16 a[4:7], v[112:115], v[160:163], a[4:7]
    v_mfma_f32_16x16x32_bf16 a[8:11], v[116:119], v[160:163], a[8:11]
    s_add_u32 m0, s46, 65536
    s_mul_i32 s47, s27, 8
    buffer_load_dwordx4 v7, s[28:31], s47 offen lds
    s_waitcnt lgkmcnt(2)
    v_mfma_f32_16x16x32_bf16 a[12:15], v[108:111], v[196:199], a[12:15]
    v_mfma_f32_16x16x32_bf16 a[16:19], v[112:115], v[196:199], a[16:19]
    v_mfma_f32_16x16x32_bf16 a[20:23], v[116:119], v[196:199], a[20:23]
    s_waitcnt lgkmcnt(1)
    v_mfma_f32_16x16x32_bf16 a[0:3], v[120:123], v[164:167], a[0:3]
    v_mfma_f32_16x16x32_bf16 a[4:7], v[124:127], v[164:167], a[4:7]
    v_mfma_f32_16x16x32_bf16 a[8:11], v[128:131], v[164:167], a[8:11]
    s_waitcnt lgkmcnt(0)
    v_mfma_f32_16x16x32_bf16 a[12:15], v[120:123], v[200:203], a[12:15]
    v_mfma_f32_16x16x32_bf16 a[16:19], v[124:127], v[200:203], a[16:19]
    v_mfma_f32_16x16x32_bf16 a[20:23], v[128:131], v[200:203], a[20:23]
    s_cmp_lg_u32 s32, 0
    s_cbranch_scc1 L_p1_ng
    v_mfma_f32_16x16x32_bf16 a[24:27], v[132:135], v[132:135], 0
    v_mfma_f32_16x16x32_bf16 a[28:31], v[136:139], v[136:139], 0
    v_mfma_f32_16x16x32_bf16 a[24:27], v[140:143], v[140:143], a[24:27]
    v_mfma_f32_16x16x32_bf16 a[28:31], v[144:147], v[144:147], a[28:31]
    v_mfma_f32_16x16x32_bf16 a[24:27], v[148:151], v[148:151], a[24:27]
    v_mfma_f32_16x16x32_bf16 a[28:31], v[152:155], v[152:155], a[28:31]
    v_mfma_f32_16x16x32_bf16 a[24:27], v[156:159], v[156:159], a[24:27]
    v_mfma_f32_16x16x32_bf16 a[28:31], v[160:163], v[160:163], a[28:31]
    v_mfma_f32_16x16x32_bf16 a[24:27], v[164:167], v[164:167], a[24:27]
    v_mfma_f32_16x16x32_bf16 a[28:31], v[168:171], v[168:171], a[28:31]
    v_mfma_f32_16x16x32_bf16 a[24:27], v[172:175], v[172:175], a[24:27]
    v_mfma_f32_16x16x32_bf16 a[28:31], v[176:179], v[176:179], a[28:31]
    v_mfma_f32_16x16x32_bf16 a[24:27], v[180:183], v[180:183], a[24:27]
    v_mfma_f32_16x16x32_bf16 a[28:31], v[184:187], v[184:187], a[28:31]
    v_mfma_f32_16x16x32_bf16 a[24:27], v[188:191], v[188:191], a[24:27]
    v_mfma_f32_16x16x32_bf16 a[28:31], v[192:195], v[192:195], a[28:31]
    v_mfma_f32_16x16x32_bf16 a[24:27], v[196:199], v[196:199], a[24:27]
    v_mfma_f32_16x16x32_bf16 a[28:31], v[200:203], v[200:203], a[28:31]
L_p1_ng:
    s_nop 6
    v_accvgpr_read_b32 v132, a0
    v_accvgpr_read_b32 v133, a1
    v_accvgpr_read_b32 v134, a2
    v_accvgpr_read_b32 v135, a3
    v_accvgpr_read_b32 v136, a4
    v_accvgpr_read_b32 v137, a5
    v_accvgpr_read_b32 v138, a6
    v_accvgpr_read_b32 v139, a7
    v_accvgpr_read_b32 v140, a8
    v_accvgpr_read_b32 v141, a9
    v_accvgpr_read_b32 v142, a10
    v_accvgpr_read_b32 v143, a11
    v_accvgpr_read_b32 v144, a12
    v_accvgpr_read_b32 v145, a13
    v_accvgpr_read_b32 v146, a14
    v_accvgpr_read_b32 v147, a15
    v_accvgpr_read_b32 v148, a16
    v_accvgpr_read_b32 v149, a17
    v_accvgpr_read_b32 v150, a18
    v_accvgpr_read_b32 v151, a19
    v_accvgpr_read_b32 v152, a20
    v_accvgpr_read_b32 v153, a21
    v_accvgpr_read_b32 v154, a22
    v_accvgpr_read_b32 v155, a23
    v_add_f32 v132, v132, v144
    v_add_f32 v133, v133, v145
    v_sub_f32 v134, v134, v146
    v_sub_f32 v135, v135, v147
    v_add_f32 v136, v136, v148
    v_add_f32 v137, v137, v149
    v_sub_f32 v138, v138, v150
    v_sub_f32 v139, v139, v151
    v_add_f32 v140, v140, v152
    v_add_f32 v141, v141, v153
    v_sub_f32 v142, v142, v154
    v_sub_f32 v143, v143, v155
    v_cvt_pk_bf16_f32 v156, v132, v133
    v_cvt_pk_bf16_f32 v157, v134, v135
    buffer_store_dwordx2 v[156:157], v16, s[48:51], s41 offen sc1
    v_cvt_pk_bf16_f32 v158, v136, v137
    v_cvt_pk_bf16_f32 v159, v138, v139
    buffer_store_dwordx2 v[158:159], v16, s[48:51], s42 offen sc1
    v_cvt_pk_bf16_f32 v160, v140, v141
    v_cvt_pk_bf16_f32 v161, v142, v143
    buffer_store_dwordx2 v[160:161], v16, s[48:51], s43 offen sc1
    s_cmp_lg_u32 s32, 0
    s_cbranch_scc1 L_p1_ns
    v_accvgpr_read_b32 v164, a24
    v_accvgpr_read_b32 v165, a25
    v_accvgpr_read_b32 v166, a26
    v_accvgpr_read_b32 v167, a27
    v_accvgpr_read_b32 v168, a28
    v_accvgpr_read_b32 v169, a29
    v_accvgpr_read_b32 v170, a30
    v_accvgpr_read_b32 v171, a31
    v_add_f32 v164, v164, v168
    v_add_f32 v165, v165, v169
    v_add_f32 v166, v166, v170
    v_add_f32 v167, v167, v171
    v_and_b32 v3, 3, v1
    v_cmp_eq_u32 vcc, 1, v3
    s_nop 1
    v_cndmask_b32 v164, v164, v165, vcc
    v_cmp_eq_u32 vcc, 2, v3
    s_nop 1
    v_cndmask_b32 v164, v164, v166, vcc
    v_cmp_eq_u32 vcc, 3, v3
    s_nop 1
    v_cndmask_b32 v164, v164, v167, vcc
    v_lshrrev_b32 v4, 2, v1
    v_lshl_add_u32 v4, v4, 4, v1
    v_lshlrev_b32 v4, 2, v4
    ds_bpermute_b32 v164, v4, v164
    v_mul_f32 v5, 0x3f7f8040, v133
    s_waitcnt lgkmcnt(0)
    v_fma_f32 v164, -v5, v5, v164
    v_max_f32 v164, 0, v164
    v_lshlrev_b32 v3, 2, v1
    v_mov_b32 v4, 0x40000000
    v_cmp_eq_u32 vcc, 0, v2
    s_nop 1
    v_cndmask_b32 v3, v4, v3, vcc
    s_lshr_b32 s26, s41, 1
    buffer_store_dword v164, v3, s[52:55], s26 offen sc1
L_p1_ns:
L_p1_sig:
    s_waitcnt vmcnt(0)
    s_add_u32 s64, s64, 1
    s_add_u32 s65, s65, 0x9e3779b1
    s_lshl_b32 s3, s2, 7
    s_add_u32 s3, s3, 0x0
    v_mov_b32 v3, s3
    v_mov_b32 v4, s64
    v_mov_b32 v5, s65
    s_cmp_lg_u32 s56, 0
    s_barrier
    s_cbranch_scc1 L_sig0_776
    s_mov_b64 exec, 1
    buffer_store_dwordx2 v[4:5], v3, s[60:63], 0 offen sc1
    s_mov_b64 exec, -1
L_sig0_776:
    s_sub_u32 s20, s2, 144
    s_cmp_ge_u32 s20, 108
    s_cbranch_scc1 L_p1_done
    s_add_u32 s22, s22, 32
    s_cmp_ge_u32 s22, 41
    s_cbranch_scc1 L_p1_W
    s_lshl_b32 s25, s57, 12
    v_add_u32 v12, s25, v6
    v_xor_b32 v13, 64, v12
    v_add_u32 v20, 57344, v12
    v_add_u32 v21, 57344, v13
    s_add_u32 s44, s4, 0x11c0000
    s_addc_u32 s45, s5, 0
    s_mov_b32 s46, 0xa2000
    s_mov_b32 s47, 0x20000
    s_add_u32 s48, s4, 0x1268000
    s_addc_u32 s49, s5, 0
    s_mov_b32 s50, 0xa2000
    s_mov_b32 s51, 0x20000
    s_sub_u32 s25, s22, 32
    s_lshl_b32 s25, s25, 2
    s_lshl_b32 s26, s57, 1
    s_add_u32 s25, s25, s26
    s_lshl_b32 s25, s25, 10
    s_add_u32 s26, s32, 0
    s_mul_i32 s33, s26, 0x2aab
    s_lshr_b32 s33, s33, 16
    s_mul_i32 s35, s33, 6
    s_sub_u32 s35, s26, s35
    s_lshr_b32 s35, s35, 1
    s_mul_i32 s35, s35, 36864
    s_mul_i32 s33, s33, 110592
    s_add_u32 s33, s33, s35
    s_and_b32 s35, s26, 1
    s_lshl_b32 s35, s35, 8
    s_add_u32 s33, s33, s35
    s_add_u32 s41, s33, s25
    s_lshr_b32 s33, s26, 2
    s_lshl_b32 s52, s33, 13
    s_and_b32 s33, s26, 3
    s_lshl_b32 s68, s33, 5
    s_add_u32 s26, s32, 1
    s_mul_i32 s33, s26, 0x2aab
    s_lshr_b32 s33, s33, 16
    s_mul_i32 s35, s33, 6
    s_sub_u32 s35, s26, s35
    s_lshr_b32 s35, s35, 1
    s_mul_i32 s35, s35, 36864
    s_mul_i32 s33, s33, 110592
    s_add_u32 s33, s33, s35
    s_and_b32 s35, s26, 1
    s_lshl_b32 s35, s35, 8
    s_add_u32 s33, s33, s35
    s_add_u32 s42, s33, s25
    s_lshr_b32 s33, s26, 2
    s_lshl_b32 s53, s33, 13
    s_and_b32 s33, s26, 3
    s_lshl_b32 s69, s33, 5
    s_add_u32 s26, s32, 2
    s_mul_i32 s33, s26, 0x2aab
    s_lshr_b32 s33, s33, 16
    s_mul_i32 s35, s33, 6
    s_sub_u32 s35, s26, s35
    s_lshr_b32 s35, s35, 1
    s_mul_i32 s35, s35, 36864
    s_mul_i32 s33, s33, 110592
    s_add_u32 s33, s33, s35
    s_and_b32 s35, s26, 1
    s_lshl_b32 s35, s35, 8
    s_add_u32 s33, s33, s35
    s_add_u32 s43, s33, s25
    s_lshr_b32 s33, s26, 2
    s_lshl_b32 s54, s33, 13
    s_and_b32 s33, s26, 3
    s_lshl_b32 s70, s33, 5
    v_lshrrev_b32 v4, 1, v2
    v_and_b32 v5, 1, v2
    v_lshlrev_b32 v16, 4, v1
    v_lshl_add_u32 v16, v4, 9, v16
    v_lshl_add_u32 v16, v5, 10, v16
    v_lshrrev_b32 v3, 2, v1
    v_lshl_add_u32 v3, v5, 2, v3
    v_lshlrev_b32 v4, 10, v4
    v_lshl_add_u32 v4, v3, 7, v4
    v_and_b32 v3, 6, v3
    v_bfe_u32 v5, v1, 1, 1
    v_xor_b32 v3, v3, v5
    v_lshl_add_u32 v4, v3, 4, v4
    v_and_b32 v3, 1, v1
    v_lshl_add_u32 v4, v3, 3, v4
    s_lshl_b32 s25, s57, 12
    v_add_u32 v4, s25, v4
    v_xor_b32 v17, s68, v4
    v_add_u32 v17, s52, v17
    v_xor_b32 v18, s69, v4
    v_add_u32 v18, s53, v18
    v_xor_b32 v19, s70, v4
    v_add_u32 v19, s54, v19
    v_lshlrev_b32 v5, 31, v5
    v_or_b32 v23, 1.0, v5
    ds_read_b128 v[132:135], v12 offset:0
    ds_read_b128 v[136:139], v12 offset:2048
    ds_read_b128 v[140:143], v13 offset:32768
    ds_read_b128 v[144:147], v13 offset:34816
    ds_read_b128 v[148:151], v13 offset:0
    ds_read_b128 v[152:155], v13 offset:2048
    s_waitcnt lgkmcnt(5)
    v_mfma_f32_16x16x32_bf16 a[0:3], v[132:135], v[24:27], 0
    ds_read_b128 v[156:159], v12 offset:40960
    v_mfma_f32_16x16x32_bf16 a[4:7], v[132:135], v[28:31], 0
    ds_read_b128 v[160:163], v12 offset:43008
    v_mfma_f32_16x16x32_bf16 a[8:11], v[132:135], v[32:35], 0
    s_waitcnt lgkmcnt(6)
    v_mfma_f32_16x16x32_bf16 a[12:15], v[136:139], v[24:27], 0
    v_mfma_f32_16x16x32_bf16 a[16:19], v[136:139], v[28:31], 0
    v_mfma_f32_16x16x32_bf16 a[20:23], v[136:139], v[32:35], 0
    s_waitcnt lgkmcnt(5)
    v_mfma_f32_16x16x32_bf16 a[24:27], v[140:143], v[24:27], 0
    ds_read_b128 v[164:167], v12 offset:8192
    v_mfma_f32_16x16x32_bf16 a[28:31], v[140:143], v[28:31], 0
    ds_read_b128 v[168:171], v12 offset:10240
    v_mfma_f32_16x16x32_bf16 a[32:35], v[140:143], v[32:35], 0
    s_waitcnt lgkmcnt(6)
    v_mfma_f32_16x16x32_bf16 a[36:39], v[144:147], v[24:27], 0
    v_mfma_f32_16x16x32_bf16 a[40:43], v[144:147], v[28:31], 0
    v_mfma_f32_16x16x32_bf16 a[44:47], v[144:147], v[32:35], 0
    s_waitcnt lgkmcnt(5)
    v_mfma_f32_16x16x32_bf16 a[0:3], v[148:151], v[36:39], a[0:3]
    ds_read_b128 v[172:175], v13 offset:40960
    v_mfma_f32_16x16x32_bf16 a[4:7], v[148:151], v[40:43], a[4:7]
    ds_read_b128 v[176:179], v13 offset:43008
    v_mfma_f32_16x16x32_bf16 a[8:11], v[148:151], v[44:47], a[8:11]
    s_waitcnt lgkmcnt(6)
    v_mfma_f32_16x16x32_bf16 a[12:15], v[152:155], v[36:39], a[12:15]
    v_mfma_f32_16x16x32_bf16 a[16:19], v[152:155], v[40:43], a[16:19]
    v_mfma_f32_16x16x32_bf16 a[20:23], v[152:155], v[44:47], a[20:23]
    s_waitcnt lgkmcnt(5)
    v_mfma_f32_16x16x32_bf16 a[24:27], v[156:159], v[36:39], a[24:27]
    ds_read_b128 v[180:183], v13 offset:8192
    v_mfma_f32_16x16x32_bf16 a[28:31], v[156:159], v[40:43], a[28:31]
    ds_read_b128 v[184:187], v13 offset:10240
    v_mfma_f32_16x16x32_bf16 a[32:35], v[156:159], v[44:47], a[32:35]
    s_waitcnt lgkmcnt(6)
    v_mfma_f32_16x16x32_bf16 a[36:39], v[160:163], v[36:39], a[36:39]
    v_mfma_f32_16x16x32_bf16 a[40:43], v[160:163], v[40:43], a[40:43]
    v_mfma_f32_16x16x32_bf16 a[44:47], v[160:163], v[44:47], a[44:47]
    s_waitcnt lgkmcnt(5)
    v_mfma_f32_16x16x32_bf16 a[0:3], v[164:167], v[48:51], a[0:3]
    ds_read_b128 v[188:191], v12 offset:49152
    v_mfma_f32_16x16x32_bf16 a[4:7], v[164:167], v[52:55], a[4:7]
    ds_read_b128 v[192:195], v12 offset:51200
    v_mfma_f32_16x16x32_bf16 a[8:11], v[164:167], v[56:59], a[8:11]
    s_waitcnt lgkmcnt(6)
    v_mfma_f32_16x16x32_bf16 a[12:15], v[168:171], v[48:51], a[12:15]
    v_mfma_f32_16x16x32_bf16 a[16:19], v[168:171], v[52:55], a[16:19]
    v_mfma_f32_16x16x32_bf16 a[20:23], v[168:171], v[56:59], a[20:23]
    s_waitcnt lgkmcnt(5)
    v_mfma_f32_16x16x32_bf16 a[24:27], v[172:175], v[48:51], a[24:27]
    ds_read_b128 v[196:199], v12 offset:16384
    v_mfma_f32_16x16x32_bf16 a[28:31], v[172:175], v[52:55], a[28:31]
    ds_read_b128 v[200:203], v12 offset:18432
    v_mfma_f32_16x16x32_bf16 a[32:35], v[172:175], v[56:59], a[32:35]
    s_waitcnt lgkmcnt(6)
    v_mfma_f32_16x16x32_bf16 a[36:39], v[176:179], v[48:51], a[36:39]
    v_mfma_f32_16x16x32_bf16 a[40:43], v[176:179], v[52:55], a[40:43]
    v_mfma_f32_16x16x32_bf16 a[44:47], v[176:179], v[56:59], a[44:47]
    s_waitcnt lgkmcnt(5)
    v_mfma_f32_16x16x32_bf16 a[0:3], v[180:183], v[60:63], a[0:3]
    ds_read_b128 v[132:135], v13 offset:49152
    v_mfma_f32_16x16x32_bf16 a[4:7], v[180:183], v[64:67], a[4:7]
    ds_read_b128 v[136:139], v13 offset:51200
    v_mfma_f32_16x16x32_bf16 a[8:11], v[180:183], v[68:71], a[8:11]
    s_waitcnt lgkmcnt(6)
    v_mfma_f32_16x16x32_bf16 a[12:15], v[184:187], v[60:63], a[12:15]
    v_mfma_f32_16x16x32_bf16 a[16:19], v[184:187], v[64:67], a[16:19]
    v_mfma_f32_16x16x32_bf16 a[20:23], v[184:187], v[68:71], a[20:23]
    s_waitcnt lgkmcnt(5)
    v_mfma_f32_16x16x32_bf16 a[24:27], v[188:191], v[60:63], a[24:27]
    ds_read_b128 v[140:143], v13 offset:16384
    v_mfma_f32_16x16x32_bf16 a[28:31], v[188:191], v[64:67], a[28:31]
    ds_read_b128 v[144:147], v13 offset:18432
    v_mfma_f32_16x16x32_bf16 a[32:35], v[188:191], v[68:71], a[32:35]
    s_waitcnt lgkmcnt(6)
    v_mfma_f32_16x16x32_bf16 a[36:39], v[192:195], v[60:63], a[36:39]
    v_mfma_f32_16x16x32_bf16 a[40:43], v[192:195], v[64:67], a[40:43]
    v_mfma_f32_16x16x32_bf16 a[44:47], v[192:195], v[68:71], a[44:47]
    s_waitcnt lgkmcnt(5)
    v_mfma_f32_16x16x32_bf16 a[0:3], v[196:199], v[72:75], a[0:3]
    ds_read_b128 v[148:151], v20 offset:0
    v_mfma_f32_16x16x32_bf16 a[4:7], v[196:199], v[76:79], a[4:7]
    ds_read_b128 v[152:155], v20 offset:2048
    v_mfma_f32_16x16x32_bf16 a[8:11], v[196:199], v[80:83], a[8:11]
    s_waitcnt lgkmcnt(6)
    v_mfma_f32_16x16x32_bf16 a[12:15], v[200:203], v[72:75], a[12:15]
    v_mfma_f32_16x16x32_bf16 a[16:19], v[200:203], v[76:79], a[16:19]
    v_mfma_f32_16x16x32_bf16 a[20:23], v[200:203], v[80:83], a[20:23]
    s_waitcnt lgkmcnt(5)
    v_mfma_f32_16x16x32_bf16 a[24:27], v[132:135], v[72:75], a[24:27]
    ds_read_b128 v[156:159], v12 offset:24576
    v_mfma_f32_16x16x32_bf16 a[28:31], v[132:135], v[76:79], a[28:31]
    ds_read_b128 v[160:163], v12 offset:26624
    v_mfma_f32_16x16x32_bf16 a[32:35], v[132:135], v[80:83], a[32:35]
    s_waitcnt lgkmcnt(6)
    v_mfma_f32_16x16x32_bf16 a[36:39], v[136:139], v[72:75], a[36:39]
    v_mfma_f32_16x16x32_bf16 a[40:43], v[136:139], v[76:79], a[40:43]
    v_mfma_f32_16x16x32_bf16 a[44:47], v[136:139], v[80:83], a[44:47]
    s_waitcnt lgkmcnt(5)
    v_mfma_f32_16x16x32_bf16 a[0:3], v[140:143], v[84:87], a[0:3]
    ds_read_b128 v[164:167], v21 offset:0
    v_mfma_f32_16x16x32_bf16 a[4:7], v[140:143], v[88:91], a[4:7]
    ds_read_b128 v[168:171], v21 offset:2048
    v_mfma_f32_16x16x32_bf16 a[8:11], v[140:143], v[92:95], a[8:11]
    s_waitcnt lgkmcnt(6)
    v_mfma_f32_16x16x32_bf16 a[12:15], v[144:147], v[84:87], a[12:15]
    v_mfma_f32_16x16x32_bf16 a[16:19], v[144:147], v[88:91], a[16:19]
    v_mfma_f32_16x16x32_bf16 a[20:23], v[144:147], v[92:95], a[20:23]
    s_waitcnt lgkmcnt(5)
    v_mfma_f32_16x16x32_bf16 a[24:27], v[148:151], v[84:87], a[24:27]
    ds_read_b128 v[172:175], v13 offset:24576
    v_mfma_f32_16x16x32_bf16 a[28:31], v[148:151], v[88:91], a[28:31]
    ds_read_b128 v[176:179], v13 offset:26624
    v_mfma_f32_16x16x32_bf16 a[32:35], v[148:151], v[92:95], a[32:35]
    s_waitcnt lgkmcnt(6)
    v_mfma_f32_16x16x32_bf16 a[36:39], v[152:155], v[84:87], a[36:39]
    v_mfma_f32_16x16x32_bf16 a[40:43], v[152:155], v[88:91], a[40:43]
    v_mfma_f32_16x16x32_bf16 a[44:47], v[152:155], v[92:95], a[44:47]
    s_waitcnt lgkmcnt(5)
    v_mfma_f32_16x16x32_bf16 a[0:3], v[156:159], v[96:99], a[0:3]
    ds_read_b128 v[180:183], v20 offset:8192
    v_mfma_f32_16x16x32_bf16 a[4:7], v[156:159], v[100:103], a[4:7]
    ds_read_b128 v[184:187], v20 offset:10240
    v_mfma_f32_16x16x32_bf16 a[8:11], v[156:159], v[104:107], a[8:11]
    s_waitcnt lgkmcnt(6)
    v_mfma_f32_16x16x32_bf16 a[12:15], v[160:163], v[96:99], a[12:15]
    v_mfma_f32_16x16x32_bf16 a[16:19], v[160:163], v[100:103], a[16:19]
    v_mfma_f32_16x16x32_bf16 a[20:23], v[160:163], v[104:107], a[20:23]
    s_waitcnt lgkmcnt(5)
    v_mfma_f32_16x16x32_bf16 a[24:27], v[164:167], v[96:99], a[24:27]
    ds_read_b128 v[188:191], v12 offset:32768
    v_mfma_f32_16x16x32_bf16 a[28:31], v[164:167], v[100:103], a[28:31]
    ds_read_b128 v[192:195], v12 offset:34816
    v_mfma_f32_16x16x32_bf16 a[32:35], v[164:167], v[104:107], a[32:35]
    s_waitcnt lgkmcnt(6)
    v_mfma_f32_16x16x32_bf16 a[36:39], v[168:171], v[96:99], a[36:39]
    v_mfma_f32_16x16x32_bf16 a[40:43], v[168:171], v[100:103], a[40:43]
    v_mfma_f32_16x16x32_bf16 a[44:47], v[168:171], v[104:107], a[44:47]
    s_waitcnt lgkmcnt(5)
    v_mfma_f32_16x16x32_bf16 a[0:3], v[172:175], v[108:111], a[0:3]
    ds_read_b128 v[196:199], v21 offset:8192
    v_mfma_f32_16x16x32_bf16 a[4:7], v[172:175], v[112:115], a[4:7]
    ds_read_b128 v[200:203], v21 offset:10240
    v_mfma_f32_16x16x32_bf16 a[8:11], v[172:175], v[116:119], a[8:11]
    s_waitcnt lgkmcnt(6)
    v_mfma_f32_16x16x32_bf16 a[12:15], v[176:179], v[108:111], a[12:15]
    v_mfma_f32_16x16x32_bf16 a[16:19], v[176:179], v[112:115], a[16:19]
    v_mfma_f32_16x16x32_bf16 a[20:23], v[176:179], v[116:119], a[20:23]
    s_waitcnt lgkmcnt(5)
    v_mfma_f32_16x16x32_bf16 a[24:27], v[180:183], v[108:111], a[24:27]
    v_mfma_f32_16x16x32_bf16 a[28:31], v[180:183], v[112:115], a[28:31]
    v_mfma_f32_16x16x32_bf16 a[32:35], v[180:183], v[116:119], a[32:35]
    s_waitcnt lgkmcnt(4)
    v_mfma_f32_16x16x32_bf16 a[36:39], v[184:187], v[108:111], a[36:39]
    v_mfma_f32_16x16x32_bf16 a[40:43], v[184:187], v[112:115], a[40:43]
    v_mfma_f32_16x16x32_bf16 a[44:47], v[184:187], v[116:119], a[44:47]
    s_waitcnt lgkmcnt(3)
    v_mfma_f32_16x16x32_bf16 a[0:3], v[188:191], v[120:123], a[0:3]
    v_mfma_f32_16x16x32_bf16 a[4:7], v[188:191], v[124:127], a[4:7]
    v_mfma_f32_16x16x32_bf16 a[8:11], v[188:191], v[128:131], a[8:11]
    s_waitcnt lgkmcnt(2)
    v_mfma_f32_16x16x32_bf16 a[12:15], v[192:195], v[120:123], a[12:15]
    v_mfma_f32_16x16x32_bf16 a[16:19], v[192:195], v[124:127], a[16:19]
    v_mfma_f32_16x16x32_bf16 a[20:23], v[192:195], v[128:131], a[20:23]
    s_waitcnt lgkmcnt(1)
    v_mfma_f32_16x16x32_bf16 a[24:27], v[196:199], v[120:123], a[24:27]
    v_mfma_f32_16x16x32_bf16 a[28:31], v[196:199], v[124:127], a[28:31]
    v_mfma_f32_16x16x32_bf16 a[32:35], v[196:199], v[128:131], a[32:35]
    s_waitcnt lgkmcnt(0)
    v_mfma_f32_16x16x32_bf16 a[36:39], v[200:203], v[120:123], a[36:39]
    v_mfma_f32_16x16x32_bf16 a[40:43], v[200:203], v[124:127], a[40:43]
    v_mfma_f32_16x16x32_bf16 a[44:47], v[200:203], v[128:131], a[44:47]
    v_accvgpr_read_b32 v132, a0
    v_accvgpr_read_b32 v133, a1
    v_accvgpr_read_b32 v134, a2
    v_accvgpr_read_b32 v135, a3
    v_accvgpr_read_b32 v136, a4
    v_accvgpr_read_b32 v137, a5
    v_accvgpr_read_b32 v138, a6
    v_accvgpr_read_b32 v139, a7
    v_accvgpr_read_b32 v140, a8
    v_accvgpr_read_b32 v141, a9
    v_accvgpr_read_b32 v142, a10
    v_accvgpr_read_b32 v143, a11
    v_accvgpr_read_b32 v144, a12
    v_accvgpr_read_b32 v145, a13
    v_accvgpr_read_b32 v146, a14
    v_accvgpr_read_b32 v147, a15
    v_accvgpr_read_b32 v148, a16
    v_accvgpr_read_b32 v149, a17
    v_accvgpr_read_b32 v150, a18
    v_accvgpr_read_b32 v151, a19
    v_accvgpr_read_b32 v152, a20
    v_accvgpr_read_b32 v153, a21
    v_accvgpr_read_b32 v154, a22
    v_accvgpr_read_b32 v155, a23
    v_accvgpr_read_b32 v156, a24
    v_accvgpr_read_b32 v157, a25
    v_accvgpr_read_b32 v158, a26
    v_accvgpr_read_b32 v159, a27
    v_accvgpr_read_b32 v160, a28
    v_accvgpr_read_b32 v161, a29
    v_accvgpr_read_b32 v162, a30
    v_accvgpr_read_b32 v163, a31
    v_accvgpr_read_b32 v164, a32
    v_accvgpr_read_b32 v165, a33
    v_accvgpr_read_b32 v166, a34
    v_accvgpr_read_b32 v167, a35
    v_accvgpr_read_b32 v168, a36
    v_accvgpr_read_b32 v169, a37
    v_accvgpr_read_b32 v170, a38
    v_accvgpr_read_b32 v171, a39
    v_accvgpr_read_b32 v172, a40
    v_accvgpr_read_b32 v173, a41
    v_accvgpr_read_b32 v174, a42
    v_accvgpr_read_b32 v175, a43
    v_accvgpr_read_b32 v176, a44
    v_accvgpr_read_b32 v177, a45
    v_accvgpr_read_b32 v178, a46
    v_accvgpr_read_b32 v179, a47
    v_fmac_f32 v132, v23, v156
    v_fmac_f32 v133, v23, v157
    v_fmac_f32 v134, v23, v158
    v_fmac_f32 v135, v23, v159
    v_fmac_f32 v136, v23, v160
    v_fmac_f32 v137, v23, v161
    v_fmac_f32 v138, v23, v162
    v_fmac_f32 v139, v23, v163
    v_fmac_f32 v140, v23, v164
    v_fmac_f32 v141, v23, v165
    v_fmac_f32 v142, v23, v166
    v_fmac_f32 v143, v23, v167
    v_fmac_f32 v144, v23, v168
    v_fmac_f32 v145, v23, v169
    v_fmac_f32 v146, v23, v170
    v_fmac_f32 v147, v23, v171
    v_fmac_f32 v148, v23, v172
    v_fmac_f32 v149, v23, v173
    v_fmac_f32 v150, v23, v174
    v_fmac_f32 v151, v23, v175
    v_fmac_f32 v152, v23, v176
    v_fmac_f32 v153, v23, v177
    v_fmac_f32 v154, v23, v178
    v_fmac_f32 v155, v23, v179
    ds_read_b64_tr_b16 v[192:193], v17 offset:0
    ds_read_b64_tr_b16 v[194:195], v17 offset:2048
    ds_read_b64_tr_b16 v[196:197], v18 offset:0
    ds_read_b64_tr_b16 v[198:199], v18 offset:2048
    ds_read_b64_tr_b16 v[200:201], v19 offset:0
    ds_read_b64_tr_b16 v[202:203], v19 offset:2048
    v_cvt_pk_bf16_f32 v180, v132, v133
    v_cvt_pk_bf16_f32 v181, v134, v135
    v_cvt_pk_bf16_f32 v182, v144, v145
    v_cvt_pk_bf16_f32 v183, v146, v147
    s_nop 0
    v_permlane16_swap_b32 v180, v182
    v_permlane16_swap_b32 v181, v183
    buffer_store_dwordx4 v[180:183], v16, s[44:47], s41 offen sc1
    v_cvt_pk_bf16_f32 v184, v136, v137
    v_cvt_pk_bf16_f32 v185, v138, v139
    v_cvt_pk_bf16_f32 v186, v148, v149
    v_cvt_pk_bf16_f32 v187, v150, v151
    s_nop 0
    v_permlane16_swap_b32 v184, v186
    v_permlane16_swap_b32 v185, v187
    buffer_store_dwordx4 v[184:187], v16, s[44:47], s42 offen sc1
    v_cvt_pk_bf16_f32 v188, v140, v141
    v_cvt_pk_bf16_f32 v189, v142, v143
    v_cvt_pk_bf16_f32 v190, v152, v153
    v_cvt_pk_bf16_f32 v191, v154, v155
    s_nop 0
    v_permlane16_swap_b32 v188, v190
    v_permlane16_swap_b32 v189, v191
    buffer_store_dwordx4 v[188:191], v16, s[44:47], s43 offen sc1
    s_waitcnt lgkmcnt(4)
    v_permlane16_swap_b32 v192, v194
    v_permlane16_swap_b32 v193, v195
    buffer_store_dwordx4 v[192:195], v16, s[48:51], s41 offen sc1
    s_waitcnt lgkmcnt(2)
    v_permlane16_swap_b32 v196, v198
    v_permlane16_swap_b32 v197, v199
    buffer_store_dwordx4 v[196:199], v16, s[48:51], s42 offen sc1
    s_waitcnt lgkmcnt(0)
    v_permlane16_swap_b32 v200, v202
    v_permlane16_swap_b32 v201, v203
    buffer_store_dwordx4 v[200:203], v16, s[48:51], s43 offen sc1
    s_branch L_p1_done
L_p1_W:
    v_lshrrev_b32 v3, 2, v1
    v_lshl_add_u32 v3, v2, 3, v3
    v_lshlrev_b32 v3, 7, v3
    v_and_b32 v4, 3, v1
    v_lshl_add_u32 v3, v4, 3, v3
    v_lshrrev_b32 v4, 3, v1
    v_and_b32 v5, 1, v2
    v_lshl_add_u32 v4, v5, 1, v4
    s_lshl_b32 s25, s57, 1
    v_xor_b32 v4, s25, v4
    v_xor_b32 v5, 0, v4
    v_lshl_add_u32 v12, v5, 5, v3
    v_xor_b32 v5, 1, v4
    v_lshl_add_u32 v13, v5, 5, v3
    s_add_u32 s44, s4, 0xfc0000
    s_addc_u32 s45, s5, 0
    s_mov_b32 s46, 0x1f8000
    s_mov_b32 s47, 0x20000
    s_sub_u32 s25, s22, 41
    s_mul_i32 s26, s25, 0x1c72
    s_lshr_b32 s26, s26, 16
    s_mul_i32 s33, s26, 9
    s_sub_u32 s25, s25, s33
    s_lshl_b32 s25, s25, 6
    s_lshl_b32 s33, s57, 5
    s_add_u32 s25, s25, s33
    s_cmp_eq_u32 s26, 0
    s_cselect_b32 s33, 3, s26
    s_cselect_b32 s52, 2, 5
    s_cselect_b32 s48, 88064, 0
    s_lshl_b32 s52, s52, 10
    s_sub_u32 s33, s33, 1
    s_lshl_b32 s35, s33, 11
    s_add_u32 s35, s35, s48
    s_lshl_b32 s49, s33, 6
    s_add_u32 s49, s49, 3840
    s_mov_b32 s50, 129024
    v_and_b32 v5, 1, v2
    v_lshl_add_u32 v3, v5, 4, v1
    v_add_u32 v3, s25, v3
    v_mul_u32_u24 v19, 0xe39, v3
    v_lshrrev_b32 v19, 16, v19
    v_mul_u32_u24 v20, 18, v19
    v_sub_u32 v20, v3, v20
    v_and_b32 v21, 1, v19
    v_lshrrev_b32 v19, 1, v19
    v_lshlrev_b32 v4, 10, v21
    v_add_u32 v4, s35, v4
    v_lshlrev_b32 v5, 5, v21
    v_add_u32 v5, s49, v5
    v_cmp_gt_u32 vcc, 16, v20
    s_nop 1
    v_cndmask_b32 v4, v5, v4, vcc
    v_mov_b32 v5, 5120
    v_mov_b32 v22, s52
    v_cndmask_b32 v22, v5, v22, vcc
    v_lshl_add_u32 v4, v20, 4, v4
    v_mul_lo_u32 v19, v19, s50
    v_lshrrev_b32 v5, 1, v2
    v_lshlrev_b32 v5, 8, v5
    v_add3_u32 v4, v19, v4, v5
    s_add_u32 s26, s32, 0
    s_lshr_b32 s33, s26, 1
    s_and_b32 s26, s26, 1
    s_lshl_b32 s41, s26, 9
    v_mad_u32_u24 v16, v22, s33, v4
    s_add_u32 s26, s32, 1
    s_lshr_b32 s33, s26, 1
    s_and_b32 s26, s26, 1
    s_lshl_b32 s42, s26, 9
    v_mad_u32_u24 v17, v22, s33, v4
    s_add_u32 s26, s32, 2
    s_lshr_b32 s33, s26, 1
    s_and_b32 s26, s26, 1
    s_lshl_b32 s43, s26, 9
    v_mad_u32_u24 v18, v22, s33, v4
    v_add_u32 v22, 61440, v12
    v_add_u32 v23, 61440, v13
    ds_read_b64_tr_b16 v[132:133], v12 offset:0
    ds_read_b64_tr_b16 v[134:135], v12 offset:512
    ds_read_b64_tr_b16 v[136:137], v13 offset:0
    ds_read_b64_tr_b16 v[138:139], v13 offset:512
    ds_read_b64_tr_b16 v[140:141], v12 offset:36864
    ds_read_b64_tr_b16 v[142:143], v12 offset:37376
    ds_read_b64_tr_b16 v[144:145], v13 offset:36864
    ds_read_b64_tr_b16 v[146:147], v13 offset:37376
    ds_read_b64_tr_b16 v[148:149], v12 offset:4096
    ds_read_b64_tr_b16 v[150:151], v12 offset:4608
    ds_read_b64_tr_b16 v[152:153], v13 offset:4096
    ds_read_b64_tr_b16 v[154:155], v13 offset:4608
    s_waitcnt lgkmcnt(10)
    v_mfma_f32_16x16x32_bf16 a[0:3], v[24:27], v[132:135], 0
    ds_read_b64_tr_b16 v[156:157], v12 offset:40960
    v_mfma_f32_16x16x32_bf16 a[4:7], v[28:31], v[132:135], 0
    ds_read_b64_tr_b16 v[158:159], v12 offset:41472
    v_mfma_f32_16x16x32_bf16 a[8:11], v[32:35], v[132:135], 0
    ds_read_b64_tr_b16 v[160:161], v13 offset:40960
    s_waitcnt lgkmcnt(11)
    v_mfma_f32_16x16x32_bf16 a[12:15], v[24:27], v[136:139], 0
    ds_read_b64_tr_b16 v[162:163], v13 offset:41472
    v_mfma_f32_16x16x32_bf16 a[16:19], v[28:31], v[136:139], 0
    v_mfma_f32_16x16x32_bf16 a[20:23], v[32:35], v[136:139], 0
    s_waitcnt lgkmcnt(10)
    v_mfma_f32_16x16x32_bf16 a[24:27], v[24:27], v[140:143], 0
    ds_read_b64_tr_b16 v[164:165], v12 offset:8192
    v_mfma_f32_16x16x32_bf16 a[28:31], v[28:31], v[140:143], 0
    ds_read_b64_tr_b16 v[166:167], v12 offset:8704
    v_mfma_f32_16x16x32_bf16 a[32:35], v[32:35], v[140:143], 0
    ds_read_b64_tr_b16 v[168:169], v13 offset:8192
    s_waitcnt lgkmcnt(11)
    v_mfma_f32_16x16x32_bf16 a[36:39], v[24:27], v[144:147], 0
    ds_read_b64_tr_b16 v[170:171], v13 offset:8704
    v_mfma_f32_16x16x32_bf16 a[40:43], v[28:31], v[144:147], 0
    v_mfma_f32_16x16x32_bf16 a[44:47], v[32:35], v[144:147], 0
    s_waitcnt lgkmcnt(10)
    v_mfma_f32_16x16x32_bf16 a[0:3], v[36:39], v[148:151], a[0:3]
    ds_read_b64_tr_b16 v[172:173], v12 offset:45056
    v_mfma_f32_16x16x32_bf16 a[4:7], v[40:43], v[148:151], a[4:7]
    ds_read_b64_tr_b16 v[174:175], v12 offset:45568
    v_mfma_f32_16x16x32_bf16 a[8:11], v[44:47], v[148:151], a[8:11]
    ds_read_b64_tr_b16 v[176:177], v13 offset:45056
    s_waitcnt lgkmcnt(11)
    v_mfma_f32_16x16x32_bf16 a[12:15], v[36:39], v[152:155], a[12:15]
    ds_read_b64_tr_b16 v[178:179], v13 offset:45568
    v_mfma_f32_16x16x32_bf16 a[16:19], v[40:43], v[152:155], a[16:19]
    v_mfma_f32_16x16x32_bf16 a[20:23], v[44:47], v[152:155], a[20:23]
    s_waitcnt lgkmcnt(10)
    v_mfma_f32_16x16x32_bf16 a[24:27], v[36:39], v[156:159], a[24:27]
    ds_read_b64_tr_b16 v[180:181], v12 offset:12288
    v_mfma_f32_16x16x32_bf16 a[28:31], v[40:43], v[156:159], a[28:31]
    ds_read_b64_tr_b16 v[182:183], v12 offset:12800
    v_mfma_f32_16x16x32_bf16 a[32:35], v[44:47], v[156:159], a[32:35]
    ds_read_b64_tr_b16 v[184:185], v13 offset:12288
    s_waitcnt lgkmcnt(11)
    v_mfma_f32_16x16x32_bf16 a[36:39], v[36:39], v[160:163], a[36:39]
    ds_read_b64_tr_b16 v[186:187], v13 offset:12800
    v_mfma_f32_16x16x32_bf16 a[40:43], v[40:43], v[160:163], a[40:43]
    v_mfma_f32_16x16x32_bf16 a[44:47], v[44:47], v[160:163], a[44:47]
    s_waitcnt lgkmcnt(10)
    v_mfma_f32_16x16x32_bf16 a[0:3], v[48:51], v[164:167], a[0:3]
    ds_read_b64_tr_b16 v[188:189], v12 offset:49152
    v_mfma_f32_16x16x32_bf16 a[4:7], v[52:55], v[164:167], a[4:7]
    ds_read_b64_tr_b16 v[190:191], v12 offset:49664
    v_mfma_f32_16x16x32_bf16 a[8:11], v[56:59], v[164:167], a[8:11]
    ds_read_b64_tr_b16 v[192:193], v13 offset:49152
    s_waitcnt lgkmcnt(11)
    v_mfma_f32_16x16x32_bf16 a[12:15], v[48:51], v[168:171], a[12:15]
    ds_read_b64_tr_b16 v[194:195], v13 offset:49664
    v_mfma_f32_16x16x32_bf16 a[16:19], v[52:55], v[168:171], a[16:19]
    v_mfma_f32_16x16x32_bf16 a[20:23], v[56:59], v[168:171], a[20:23]
    s_waitcnt lgkmcnt(10)
    v_mfma_f32_16x16x32_bf16 a[24:27], v[48:51], v[172:175], a[24:27]
    ds_read_b64_tr_b16 v[196:197], v12 offset:16384
    v_mfma_f32_16x16x32_bf16 a[28:31], v[52:55], v[172:175], a[28:31]
    ds_read_b64_tr_b16 v[198:199], v12 offset:16896
    v_mfma_f32_16x16x32_bf16 a[32:35], v[56:59], v[172:175], a[32:35]
    ds_read_b64_tr_b16 v[200:201], v13 offset:16384
    s_waitcnt lgkmcnt(11)
    v_mfma_f32_16x16x32_bf16 a[36:39], v[48:51], v[176:179], a[36:39]
    ds_read_b64_tr_b16 v[202:203], v13 offset:16896
    v_mfma_f32_16x16x32_bf16 a[40:43], v[52:55], v[176:179], a[40:43]
    v_mfma_f32_16x16x32_bf16 a[44:47], v[56:59], v[176:179], a[44:47]
    s_waitcnt lgkmcnt(10)
    v_mfma_f32_16x16x32_bf16 a[0:3], v[60:63], v[180:183], a[0:3]
    ds_read_b64_tr_b16 v[132:133], v12 offset:53248
    v_mfma_f32_16x16x32_bf16 a[4:7], v[64:67], v[180:183], a[4:7]
    ds_read_b64_tr_b16 v[134:135], v12 offset:53760
    v_mfma_f32_16x16x32_bf16 a[8:11], v[68:71], v[180:183], a[8:11]
    ds_read_b64_tr_b16 v[136:137], v13 offset:53248
    s_waitcnt lgkmcnt(11)
    v_mfma_f32_16x16x32_bf16 a[12:15], v[60:63], v[184:187], a[12:15]
    ds_read_b64_tr_b16 v[138:139], v13 offset:53760
    v_mfma_f32_16x16x32_bf16 a[16:19], v[64:67], v[184:187], a[16:19]
    v_mfma_f32_16x16x32_bf16 a[20:23], v[68:71], v[184:187], a[20:23]
    s_waitcnt lgkmcnt(10)
    v_mfma_f32_16x16x32_bf16 a[24:27], v[60:63], v[188:191], a[24:27]
    ds_read_b64_tr_b16 v[140:141], v12 offset:20480
    v_mfma_f32_16x16x32_bf16 a[28:31], v[64:67], v[188:191], a[28:31]
    ds_read_b64_tr_b16 v[142:143], v12 offset:20992
    v_mfma_f32_16x16x32_bf16 a[32:35], v[68:71], v[188:191], a[32:35]
    ds_read_b64_tr_b16 v[144:145], v13 offset:20480
    s_waitcnt lgkmcnt(11)
    v_mfma_f32_16x16x32_bf16 a[36:39], v[60:63], v[192:195], a[36:39]
    ds_read_b64_tr_b16 v[146:147], v13 offset:20992
    v_mfma_f32_16x16x32_bf16 a[40:43], v[64:67], v[192:195], a[40:43]
    v_mfma_f32_16x16x32_bf16 a[44:47], v[68:71], v[192:195], a[44:47]
    s_waitcnt lgkmcnt(10)
    v_mfma_f32_16x16x32_bf16 a[0:3], v[72:75], v[196:199], a[0:3]
    ds_read_b64_tr_b16 v[148:149], v12 offset:57344
    v_mfma_f32_16x16x32_bf16 a[4:7], v[76:79], v[196:199], a[4:7]
    ds_read_b64_tr_b16 v[150:151], v12 offset:57856
    v_mfma_f32_16x16x32_bf16 a[8:11], v[80:83], v[196:199], a[8:11]
    ds_read_b64_tr_b16 v[152:153], v13 offset:57344
    s_waitcnt lgkmcnt(11)
    v_mfma_f32_16x16x32_bf16 a[12:15], v[72:75], v[200:203], a[12:15]
    ds_read_b64_tr_b16 v[154:155], v13 offset:57856
    v_mfma_f32_16x16x32_bf16 a[16:19], v[76:79], v[200:203], a[16:19]
    v_mfma_f32_16x16x32_bf16 a[20:23], v[80:83], v[200:203], a[20:23]
    s_waitcnt lgkmcnt(10)
    v_mfma_f32_16x16x32_bf16 a[24:27], v[72:75], v[132:135], a[24:27]
    ds_read_b64_tr_b16 v[156:157], v12 offset:24576
    v_mfma_f32_16x16x32_bf16 a[28:31], v[76:79], v[132:135], a[28:31]
    ds_read_b64_tr_b16 v[158:159], v12 offset:25088
    v_mfma_f32_16x16x32_bf16 a[32:35], v[80:83], v[132:135], a[32:35]
    ds_read_b64_tr_b16 v[160:161], v13 offset:24576
    s_waitcnt lgkmcnt(11)
    v_mfma_f32_16x16x32_bf16 a[36:39], v[72:75], v[136:139], a[36:39]
    ds_read_b64_tr_b16 v[162:163], v13 offset:25088
    v_mfma_f32_16x16x32_bf16 a[40:43], v[76:79], v[136:139], a[40:43]
    v_mfma_f32_16x16x32_bf16 a[44:47], v[80:83], v[136:139], a[44:47]
    s_waitcnt lgkmcnt(10)
    v_mfma_f32_16x16x32_bf16 a[0:3], v[84:87], v[140:143], a[0:3]
    ds_read_b64_tr_b16 v[164:165], v22 offset:0
    v_mfma_f32_16x16x32_bf16 a[4:7], v[88:91], v[140:143], a[4:7]
    ds_read_b64_tr_b16 v[166:167], v22 offset:512
    v_mfma_f32_16x16x32_bf16 a[8:11], v[92:95], v[140:143], a[8:11]
    ds_read_b64_tr_b16 v[168:169], v23 offset:0
    s_waitcnt lgkmcnt(11)
    v_mfma_f32_16x16x32_bf16 a[12:15], v[84:87], v[144:147], a[12:15]
    ds_read_b64_tr_b16 v[170:171], v23 offset:512
    v_mfma_f32_16x16x32_bf16 a[16:19], v[88:91], v[144:147], a[16:19]
    v_mfma_f32_16x16x32_bf16 a[20:23], v[92:95], v[144:147], a[20:23]
    s_waitcnt lgkmcnt(10)
    v_mfma_f32_16x16x32_bf16 a[24:27], v[84:87], v[148:151], a[24:27]
    ds_read_b64_tr_b16 v[172:173], v12 offset:28672
    v_mfma_f32_16x16x32_bf16 a[28:31], v[88:91], v[148:151], a[28:31]
    ds_read_b64_tr_b16 v[174:175], v12 offset:29184
    v_mfma_f32_16x16x32_bf16 a[32:35], v[92:95], v[148:151], a[32:35]
    ds_read_b64_tr_b16 v[176:177], v13 offset:28672
    s_waitcnt lgkmcnt(11)
    v_mfma_f32_16x16x32_bf16 a[36:39], v[84:87], v[152:155], a[36:39]
    ds_read_b64_tr_b16 v[178:179], v13 offset:29184
    v_mfma_f32_16x16x32_bf16 a[40:43], v[88:91], v[152:155], a[40:43]
    v_mfma_f32_16x16x32_bf16 a[44:47], v[92:95], v[152:155], a[44:47]
    s_waitcnt lgkmcnt(10)
    v_mfma_f32_16x16x32_bf16 a[0:3], v[96:99], v[156:159], a[0:3]
    ds_read_b64_tr_b16 v[180:181], v22 offset:4096
    v_mfma_f32_16x16x32_bf16 a[4:7], v[100:103], v[156:159], a[4:7]
    ds_read_b64_tr_b16 v[182:183], v22 offset:4608
    v_mfma_f32_16x16x32_bf16 a[8:11], v[104:107], v[156:159], a[8:11]
    ds_read_b64_tr_b16 v[184:185], v23 offset:4096
    s_waitcnt lgkmcnt(11)
    v_mfma_f32_16x16x32_bf16 a[12:15], v[96:99], v[160:163], a[12:15]
    ds_read_b64_tr_b16 v[186:187], v23 offset:4608
    v_mfma_f32_16x16x32_bf16 a[16:19], v[100:103], v[160:163], a[16:19]
    v_mfma_f32_16x16x32_bf16 a[20:23], v[104:107], v[160:163], a[20:23]
    s_waitcnt lgkmcnt(10)
    v_mfma_f32_16x16x32_bf16 a[24:27], v[96:99], v[164:167], a[24:27]
    ds_read_b64_tr_b16 v[188:189], v12 offset:32768
    v_mfma_f32_16x16x32_bf16 a[28:31], v[100:103], v[164:167], a[28:31]
    ds_read_b64_tr_b16 v[190:191], v12 offset:33280
    v_mfma_f32_16x16x32_bf16 a[32:35], v[104:107], v[164:167], a[32:35]
    ds_read_b64_tr_b16 v[192:193], v13 offset:32768
    s_waitcnt lgkmcnt(11)
    v_mfma_f32_16x16x32_bf16 a[36:39], v[96:99], v[168:171], a[36:39]
    ds_read_b64_tr_b16 v[194:195], v13 offset:33280
    v_mfma_f32_16x16x32_bf16 a[40:43], v[100:103], v[168:171], a[40:43]
    v_mfma_f32_16x16x32_bf16 a[44:47], v[104:107], v[168:171], a[44:47]
    s_waitcnt lgkmcnt(10)
    v_mfma_f32_16x16x32_bf16 a[0:3], v[108:111], v[172:175], a[0:3]
    ds_read_b64_tr_b16 v[196:197], v22 offset:8192
    v_mfma_f32_16x16x32_bf16 a[4:7], v[112:115], v[172:175], a[4:7]
    ds_read_b64_tr_b16 v[198:199], v22 offset:8704
    v_mfma_f32_16x16x32_bf16 a[8:11], v[116:119], v[172:175], a[8:11]
    ds_read_b64_tr_b16 v[200:201], v23 offset:8192
    s_waitcnt lgkmcnt(11)
    v_mfma_f32_16x16x32_bf16 a[12:15], v[108:111], v[176:179], a[12:15]
    ds_read_b64_tr_b16 v[202:203], v23 offset:8704
    v_mfma_f32_16x16x32_bf16 a[16:19], v[112:115], v[176:179], a[16:19]
    v_mfma_f32_16x16x32_bf16 a[20:23], v[116:119], v[176:179], a[20:23]
    s_waitcnt lgkmcnt(10)
    v_mfma_f32_16x16x32_bf16 a[24:27], v[108:111], v[180:183], a[24:27]
    v_mfma_f32_16x16x32_bf16 a[28:31], v[112:115], v[180:183], a[28:31]
    v_mfma_f32_16x16x32_bf16 a[32:35], v[116:119], v[180:183], a[32:35]
    s_waitcnt lgkmcnt(8)
    v_mfma_f32_16x16x32_bf16 a[36:39], v[108:111], v[184:187], a[36:39]
    v_mfma_f32_16x16x32_bf16 a[40:43], v[112:115], v[184:187], a[40:43]
    v_mfma_f32_16x16x32_bf16 a[44:47], v[116:119], v[184:187], a[44:47]
    s_waitcnt lgkmcnt(6)
    v_mfma_f32_16x16x32_bf16 a[0:3], v[120:123], v[188:191], a[0:3]
    v_mfma_f32_16x16x32_bf16 a[4:7], v[124:127], v[188:191], a[4:7]
    v_mfma_f32_16x16x32_bf16 a[8:11], v[128:131], v[188:191], a[8:11]
    s_waitcnt lgkmcnt(4)
    v_mfma_f32_16x16x32_bf16 a[12:15], v[120:123], v[192:195], a[12:15]
    v_mfma_f32_16x16x32_bf16 a[16:19], v[124:127], v[192:195], a[16:19]
    v_mfma_f32_16x16x32_bf16 a[20:23], v[128:131], v[192:195], a[20:23]
    s_waitcnt lgkmcnt(2)
    v_mfma_f32_16x16x32_bf16 a[24:27], v[120:123], v[196:199], a[24:27]
    v_mfma_f32_16x16x32_bf16 a[28:31], v[124:127], v[196:199], a[28:31]
    v_mfma_f32_16x16x32_bf16 a[32:35], v[128:131], v[196:199], a[32:35]
    s_waitcnt lgkmcnt(0)
    v_mfma_f32_16x16x32_bf16 a[36:39], v[120:123], v[200:203], a[36:39]
    v_mfma_f32_16x16x32_bf16 a[40:43], v[124:127], v[200:203], a[40:43]
    v_mfma_f32_16x16x32_bf16 a[44:47], v[128:131], v[200:203], a[44:47]
    v_accvgpr_read_b32 v132, a0
    v_accvgpr_read_b32 v133, a1
    v_accvgpr_read_b32 v134, a2
    v_accvgpr_read_b32 v135, a3
    v_accvgpr_read_b32 v136, a4
    v_accvgpr_read_b32 v137, a5
    v_accvgpr_read_b32 v138, a6
    v_accvgpr_read_b32 v139, a7
    v_accvgpr_read_b32 v140, a8
    v_accvgpr_read_b32 v141, a9
    v_accvgpr_read_b32 v142, a10
    v_accvgpr_read_b32 v143, a11
    v_accvgpr_read_b32 v144, a12
    v_accvgpr_read_b32 v145, a13
    v_accvgpr_read_b32 v146, a14
    v_accvgpr_read_b32 v147, a15
    v_accvgpr_read_b32 v148, a16
    v_accvgpr_read_b32 v149, a17
    v_accvgpr_read_b32 v150, a18
    v_accvgpr_read_b32 v151, a19
    v_accvgpr_read_b32 v152, a20
    v_accvgpr_read_b32 v153, a21
    v_accvgpr_read_b32 v154, a22
    v_accvgpr_read_b32 v155, a23
    v_accvgpr_read_b32 v156, a24
    v_accvgpr_read_b32 v157, a25
    v_accvgpr_read_b32 v158, a26
    v_accvgpr_read_b32 v159, a27
    v_accvgpr_read_b32 v160, a28
    v_accvgpr_read_b32 v161, a29
    v_accvgpr_read_b32 v162, a30
    v_accvgpr_read_b32 v163, a31
    v_accvgpr_read_b32 v164, a32
    v_accvgpr_read_b32 v165, a33
    v_accvgpr_read_b32 v166, a34
    v_accvgpr_read_b32 v167, a35
    v_accvgpr_read_b32 v168, a36
    v_accvgpr_read_b32 v169, a37
    v_accvgpr_read_b32 v170, a38
    v_accvgpr_read_b32 v171, a39
    v_accvgpr_read_b32 v172, a40
    v_accvgpr_read_b32 v173, a41
    v_accvgpr_read_b32 v174, a42
    v_accvgpr_read_b32 v175, a43
    v_accvgpr_read_b32 v176, a44
    v_accvgpr_read_b32 v177, a45
    v_accvgpr_read_b32 v178, a46
    v_accvgpr_read_b32 v179, a47
    v_add_f32 v132, v132, v156
    v_add_f32 v133, v133, v157
    v_sub_f32 v134, v134, v158
    v_sub_f32 v135, v135, v159
    v_add_f32 v136, v136, v160
    v_add_f32 v137, v137, v161
    v_sub_f32 v138, v138, v162
    v_sub_f32 v139, v139, v163
    v_add_f32 v140, v140, v164
    v_add_f32 v141, v141, v165
    v_sub_f32 v142, v142, v166
    v_sub_f32 v143, v143, v167
    v_add_f32 v144, v144, v168
    v_add_f32 v145, v145, v169
    v_sub_f32 v146, v146, v170
    v_sub_f32 v147, v147, v171
    v_add_f32 v148, v148, v172
    v_add_f32 v149, v149, v173
    v_sub_f32 v150, v150, v174
    v_sub_f32 v151, v151, v175
    v_add_f32 v152, v152, v176
    v_add_f32 v153, v153, v177
    v_sub_f32 v154, v154, v178
    v_sub_f32 v155, v155, v179
    v_cvt_pk_bf16_f32 v180, v132, v133
    v_cvt_pk_bf16_f32 v181, v134, v135
    v_cvt_pk_bf16_f32 v182, v144, v145
    v_cvt_pk_bf16_f32 v183, v146, v147
    s_nop 0
    v_permlane16_swap_b32 v180, v182
    v_permlane16_swap_b32 v181, v183
    buffer_store_dwordx4 v[180:183], v16, s[44:47], s41 offen sc1
    v_cvt_pk_bf16_f32 v184, v136, v137
    v_cvt_pk_bf16_f32 v185, v138, v139
    v_cvt_pk_bf16_f32 v186, v148, v149
    v_cvt_pk_bf16_f32 v187, v150, v151
    s_nop 0
    v_permlane16_swap_b32 v184, v186
    v_permlane16_swap_b32 v185, v187
    buffer_store_dwordx4 v[184:187], v17, s[44:47], s42 offen sc1
    v_cvt_pk_bf16_f32 v188, v140, v141
    v_cvt_pk_bf16_f32 v189, v142, v143
    v_cvt_pk_bf16_f32 v190, v152, v153
    v_cvt_pk_bf16_f32 v191, v154, v155
    s_nop 0
    v_permlane16_swap_b32 v188, v190
    v_permlane16_swap_b32 v189, v191
    buffer_store_dwordx4 v[188:191], v18, s[44:47], s43 offen sc1
    s_branch L_p1_done
L_p1_wft:
    v_and_b32 v6, 63, v0
    v_lshlrev_b32 v6, 4, v6
    s_mul_i32 s26, s20, 18496
    s_and_b32 s25, s56, 3
    s_mul_i32 s25, s25, 5120
    s_add_u32 s26, s26, s25
    v_add_u32 v5, s26, v6
    s_mov_b32 s30, 1183744
    s_mov_b32 s31, 0x20000
    s_waitcnt lgkmcnt(0)
    s_cmp_lt_u32 s56, 4
    s_cselect_b32 s28, s10, s12
    s_cselect_b32 s29, s11, s13
    s_mul_i32 s25, s56, 5120
    s_mov_b32 m0, s25
    s_nop 0
    buffer_load_dwordx4 v5, s[28:31], 0 offen offset:0 lds
    buffer_load_dwordx4 v5, s[28:31], 0 offen offset:1024 lds
    buffer_load_dwordx4 v5, s[28:31], 0 offen offset:2048 lds
    buffer_load_dwordx4 v5, s[28:31], 0 offen offset:3072 lds
    s_add_u32 m0, m0, 4096
    v_add_u32 v5, 0x1000, v5
    buffer_load_dwordx4 v5, s[28:31], 0 offen lds
    s_add_u32 s60, s4, 0x1380000
    s_addc_u32 s61, s5, 0
    s_load_dwordx2 s[64:65], s[60:61], 0x28000
    s_add_u32 s32, s4, 0xd80000
    s_addc_u32 s33, s5, 0
    s_mov_b32 s34, 0x240000
    s_mov_b32 s35, 0x20000
    s_add_u32 s36, s4, 0x132e000
    s_addc_u32 s37, s5, 0
    s_mov_b32 s38, 0x25000
    s_mov_b32 s39, 0x20000
    v_mov_b32 v16, 0
    v_mov_b32 v17, 0
    v_mov_b32 v18, 0
    v_mov_b32 v19, 0
    s_lshl_b32 s26, s20, 13
    v_lshlrev_b32 v3, 4, v0
    v_add_u32 v3, s26, v3
    buffer_store_dwordx4 v[16:19], v3, s[36:39], 0 offen sc1
    s_lshl_b32 s25, s56, 3
    v_add_u32 v3, s25, v8
    v_mul_u32_u24 v12, 2312, v9
    v_lshl_add_u32 v12, v3, 1, v12
    v_add_u32 v4, 576, v12
    v_cmp_eq_u32 vcc, 0, v3
    s_nop 1
    v_cndmask_b32 v13, v12, v4, vcc
    v_lshlrev_b32 v14, 13, v3
    v_lshl_add_u32 v14, v9, 4, v14
    s_lshl_b32 s26, s20, 7
    v_add_u32 v14, s26, v14
    s_waitcnt vmcnt(1) lgkmcnt(0)
    s_barrier
    ds_read_u16 v20, v13 offset:0
    ds_read_u16 v40, v13 offset:20480
    ds_read_u16 v21, v13 offset:578
    ds_read_u16 v41, v13 offset:21058
    ds_read_u16 v22, v13 offset:1156
    ds_read_u16 v42, v13 offset:21636
    ds_read_u16 v23, v13 offset:1734
    ds_read_u16 v43, v13 offset:22214
    ds_read_u16 v24, v12 offset:128
    ds_read_u16 v44, v12 offset:20608
    ds_read_u16 v25, v12 offset:706
    ds_read_u16 v45, v12 offset:21186
    ds_read_u16 v26, v12 offset:1284
    ds_read_u16 v46, v12 offset:21764
    ds_read_u16 v27, v12 offset:1862
    ds_read_u16 v47, v12 offset:22342
    ds_read_u16 v28, v12 offset:256
    ds_read_u16 v48, v12 offset:20736
    ds_read_u16 v29, v12 offset:834
    ds_read_u16 v49, v12 offset:21314
    ds_read_u16 v30, v12 offset:1412
    ds_read_u16 v50, v12 offset:21892
    ds_read_u16 v31, v12 offset:1990
    ds_read_u16 v51, v12 offset:22470
    ds_read_u16 v32, v12 offset:384
    ds_read_u16 v52, v12 offset:20864
    ds_read_u16 v33, v12 offset:962
    ds_read_u16 v53, v12 offset:21442
    ds_read_u16 v34, v12 offset:1540
    ds_read_u16 v54, v12 offset:22020
    ds_read_u16 v35, v12 offset:2118
    ds_read_u16 v55, v12 offset:22598
    ds_read_u16 v36, v12 offset:512
    ds_read_u16 v56, v12 offset:20992
    ds_read_u16 v37, v12 offset:1090
    ds_read_u16 v57, v12 offset:21570
    ds_read_u16 v38, v12 offset:1668
    ds_read_u16 v58, v12 offset:22148
    ds_read_u16 v39, v12 offset:2246
    ds_read_u16 v59, v12 offset:22726
    s_waitcnt lgkmcnt(15)
    v_lshl_or_b32 v20, v40, 16, v20
    v_lshl_or_b32 v21, v41, 16, v21
    v_lshl_or_b32 v22, v42, 16, v22
    v_lshl_or_b32 v23, v43, 16, v23
    buffer_store_dwordx4 v[20:23], v14, s[32:35], 0 offen sc1
    v_add_u32 v14, 0x80000, v14
    v_lshl_or_b32 v24, v44, 16, v24
    v_lshl_or_b32 v25, v45, 16, v25
    v_lshl_or_b32 v26, v46, 16, v26
    v_lshl_or_b32 v27, v47, 16, v27
    buffer_store_dwordx4 v[24:27], v14, s[32:35], 0 offen sc1
    v_add_u32 v14, 0x80000, v14
    v_lshl_or_b32 v28, v48, 16, v28
    v_lshl_or_b32 v29, v49, 16, v29
    v_lshl_or_b32 v30, v50, 16, v30
    v_lshl_or_b32 v31, v51, 16, v31
    buffer_store_dwordx4 v[28:31], v14, s[32:35], 0 offen sc1
    v_add_u32 v14, 0x80000, v14
    s_waitcnt lgkmcnt(14)
    v_lshl_or_b32 v32, v52, 16, v32
    s_waitcnt lgkmcnt(12)
    v_lshl_or_b32 v33, v53, 16, v33
    s_waitcnt lgkmcnt(10)
    v_lshl_or_b32 v34, v54, 16, v34
    s_waitcnt lgkmcnt(8)
    v_lshl_or_b32 v35, v55, 16, v35
    buffer_store_dwordx4 v[32:35], v14, s[32:35], 0 offen sc1
    v_add_u32 v14, 0x80000, v14
    s_waitcnt lgkmcnt(6)
    v_lshl_or_b32 v36, v56, 16, v36
    s_waitcnt lgkmcnt(4)
    v_lshl_or_b32 v37, v57, 16, v37
    s_waitcnt lgkmcnt(2)
    v_lshl_or_b32 v38, v58, 16, v38
    s_waitcnt lgkmcnt(0)
    v_lshl_or_b32 v39, v59, 16, v39
    buffer_store_dwordx4 v[36:39], v14, s[32:35], 0 offen sc1
    s_branch L_p1_sig
L_p1_done:
    s_cmp_ge_u32 s2, 144
    s_cbranch_scc1 L_a2_skip
    s_lshl_b32 s3, s2, 14
    s_add_u32 s8, s4, s3
    s_addc_u32 s9, s5, 0
    s_mov_b32 s10, 0x4000
    s_mov_b32 s11, 0x20000
    s_add_u32 s12, s4, 0x240000
    s_addc_u32 s13, s5, 0
    s_add_u32 s12, s12, s3
    s_addc_u32 s13, s13, 0
    s_mov_b32 s14, 0x4000
    s_mov_b32 s15, 0x20000
    s_add_u32 s16, s4, 0x1328000
    s_addc_u32 s17, s5, 0
    s_mov_b32 s18, 0x2000
    s_mov_b32 s19, 0x20000
    s_add_u32 s20, s4, 0xd80000
    s_addc_u32 s21, s5, 0
    s_add_u32 s20, s20, s3
    s_addc_u32 s21, s21, 0
    s_mov_b32 s22, 0x4000
    s_mov_b32 s23, 0x20000
    s_lshr_b32 s3, s3, 1
    s_add_u32 s48, s4, 0x1500000
    s_addc_u32 s49, s5, 0
    s_add_u32 s48, s48, s3
    s_addc_u32 s49, s49, 0
    s_mov_b32 s50, 0x2000
    s_mov_b32 s51, 0x20000
    v_and_b32 v1, 15, v0
    v_bfe_u32 v2, v0, 4, 2
    s_and_b32 s25, s56, 3
    s_lshr_b32 s26, s56, 2
    s_lshl_b32 s28, s25, 4
    v_and_b32 v9, 63, v0
    s_lshl_b32 s27, s56, 11
    v_lshlrev_b32 v5, 4, v9
    v_add_u32 v5, s27, v5
    v_lshrrev_b32 v6, 1, v5
    s_lshl_b32 s27, s26, 10
    s_add_u32 s27, s27, s28
    v_lshl_add_u32 v8, v2, 8, v1
    v_add_u32 v8, s27, v8
    v_lshlrev_b32 v8, 3, v8
    v_add_u32 v10, s28, v1
    s_lshl_b32 s29, s26, 13
    v_lshlrev_b32 v7, 2, v10
    v_lshl_add_u32 v7, v2, 10, v7
    v_add_u32 v7, s29, v7
    s_movk_i32 s30, 0x1000
    v_lshlrev_b32 v40, 4, v9
    s_and_b32 s3, s2, 1
    s_lshl_b32 s3, s3, 3
    s_lshr_b32 s44, s2, 5
    s_add_u32 s3, s3, s44
    s_mul_i32 s3, s3, 129024
    s_add_u32 s40, s4, 0xfc0000
    s_addc_u32 s41, s5, 0
    s_add_u32 s40, s40, s3
    s_addc_u32 s41, s41, 0
    s_mov_b32 s42, 0x1f800
    s_mov_b32 s43, 0x20000
    s_cmp_eq_u32 s2, 0
    s_cselect_b32 s31, 0, 1.0
    s_cselect_b64 s[38:39], -1, 0
    v_cvt_f32_u32 v172, v10
    v_cvt_f32_u32 v173, v1
    v_cvt_f32_u32 v174, v2
    v_mul_f32 v3, 0x3c800000, v172
    v_mul_f32 v4, 0x41000000, v174
    v_mul_f32 v4, v4, v3
    v_cos_f32 v124, v4
    v_sin_f32 v132, v4
    v_add_f32 v4, v4, v3
    v_cos_f32 v125, v4
    v_sin_f32 v133, v4
    v_add_f32 v4, v4, v3
    v_cos_f32 v126, v4
    v_sin_f32 v134, v4
    v_add_f32 v4, v4, v3
    v_cos_f32 v127, v4
    v_sin_f32 v135, v4
    v_add_f32 v4, v4, v3
    v_cos_f32 v128, v4
    v_sin_f32 v136, v4
    v_add_f32 v4, v4, v3
    v_cos_f32 v129, v4
    v_sin_f32 v137, v4
    v_add_f32 v4, v4, v3
    v_cos_f32 v130, v4
    v_sin_f32 v138, v4
    v_add_f32 v4, v4, v3
    v_cos_f32 v131, v4
    v_sin_f32 v139, v4
    v_and_b32 v175, 1, v1
    s_mov_b32 s32, 0x80008000
    v_mul_lo_u32 v175, v175, s32
    v_cvt_pk_bf16_f32 v44, v124, v125
    v_cvt_pk_bf16_f32 v52, v132, v133
    v_cvt_pk_bf16_f32 v45, v126, v127
    v_cvt_pk_bf16_f32 v53, v134, v135
    v_cvt_pk_bf16_f32 v46, v128, v129
    v_cvt_pk_bf16_f32 v54, v136, v137
    v_cvt_pk_bf16_f32 v47, v130, v131
    v_cvt_pk_bf16_f32 v55, v138, v139
    v_xor_b32 v60, s32, v52
    v_xor_b32 v48, v175, v44
    v_xor_b32 v56, v175, v52
    v_xor_b32 v64, v175, v60
    v_xor_b32 v61, s32, v53
    v_xor_b32 v49, v175, v45
    v_xor_b32 v57, v175, v53
    v_xor_b32 v65, v175, v61
    v_xor_b32 v62, s32, v54
    v_xor_b32 v50, v175, v46
    v_xor_b32 v58, v175, v54
    v_xor_b32 v66, v175, v62
    v_xor_b32 v63, s32, v55
    v_xor_b32 v51, v175, v47
    v_xor_b32 v59, v175, v55
    v_xor_b32 v67, v175, v63
    v_mul_f32 v3, 0x3a000000, v172
    v_mul_f32 v4, 4.0, v174
    v_mul_f32 v4, v4, v3
    s_mov_b32 s33, 0x41500000
    v_cos_f32 v92, v4
    v_sin_f32 v100, v4
    v_add_f32 v4, v4, v3
    v_cos_f32 v93, v4
    v_sin_f32 v101, v4
    v_add_f32 v4, v4, v3
    v_cos_f32 v94, v4
    v_sin_f32 v102, v4
    v_add_f32 v4, v4, v3
    v_cos_f32 v95, v4
    v_sin_f32 v103, v4
    v_fma_f32 v4, v3, s33, v4
    v_cos_f32 v96, v4
    v_sin_f32 v104, v4
    v_add_f32 v4, v4, v3
    v_cos_f32 v97, v4
    v_sin_f32 v105, v4
    v_add_f32 v4, v4, v3
    v_cos_f32 v98, v4
    v_sin_f32 v106, v4
    v_add_f32 v4, v4, v3
    v_cos_f32 v99, v4
    v_sin_f32 v107, v4
    s_mul_i32 s27, s56, 640
    s_add_u32 s27, s27, 122880
    v_lshrrev_b32 v3, 5, v9
    v_and_b32 v4, 31, v9
    v_mul_u32_u24 v188, 160, v3
    v_lshl_add_u32 v188, v4, 2, v188
    v_add_u32 v188, s27, v188
    s_mul_i32 s27, s26, 10240
    s_add_u32 s27, s27, 122880
    s_lshl_b32 s29, s25, 5
    s_add_u32 s29, s29, s27
    v_mul_u32_u24 v3, 160, v1
    v_lshl_add_u32 v189, v2, 3, v3
    v_add_u32 v189, s29, v189
    v_lshl_add_u32 v191, v2, 4, v3
    v_add_u32 v190, s27, v191
    s_mul_i32 s27, s26, 2560
    s_add_u32 s27, s27, 122880
    v_add_u32 v191, s27, v191
    s_mov_b32 s36, 0x3ae38e39
    v_mul_f32 v3, 0x3d000000, v173
    v_mul_f32 v4, 4.0, v174
    v_mul_f32 v4, v4, v3
    v_cos_f32 v124, v4
    v_sin_f32 v132, v4
    v_add_f32 v4, v4, v3
    v_cos_f32 v125, v4
    v_sin_f32 v133, v4
    v_add_f32 v4, v4, v3
    v_cos_f32 v126, v4
    v_sin_f32 v134, v4
    v_add_f32 v4, v4, v3
    v_cos_f32 v127, v4
    v_sin_f32 v135, v4
    v_fma_f32 v4, v3, s33, v4
    v_cos_f32 v128, v4
    v_sin_f32 v136, v4
    v_add_f32 v4, v4, v3
    v_cos_f32 v129, v4
    v_sin_f32 v137, v4
    v_add_f32 v4, v4, v3
    v_cos_f32 v130, v4
    v_sin_f32 v138, v4
    v_add_f32 v4, v4, v3
    v_cos_f32 v131, v4
    v_sin_f32 v139, v4
    v_cvt_pk_bf16_f32 v68, v124, v125
    v_cvt_pk_bf16_f32 v76, v132, v133
    v_cvt_pk_bf16_f32 v69, v126, v127
    v_cvt_pk_bf16_f32 v77, v134, v135
    v_cvt_pk_bf16_f32 v70, v128, v129
    v_cvt_pk_bf16_f32 v78, v136, v137
    v_cvt_pk_bf16_f32 v71, v130, v131
    v_cvt_pk_bf16_f32 v79, v138, v139
    s_mov_b32 s34, 0x80000000
    v_xor_b32 v84, s32, v76
    v_xor_b32 v72, s34, v68
    v_xor_b32 v80, s34, v76
    v_xor_b32 v88, s34, v84
    v_xor_b32 v85, s32, v77
    v_xor_b32 v73, s34, v69
    v_xor_b32 v81, s34, v77
    v_xor_b32 v89, s34, v85
    v_xor_b32 v86, s32, v78
    v_xor_b32 v74, s34, v70
    v_xor_b32 v82, s34, v78
    v_xor_b32 v90, s34, v86
    v_xor_b32 v87, s32, v79
    v_xor_b32 v75, s34, v71
    v_xor_b32 v83, s34, v79
    v_xor_b32 v91, s34, v87
    s_cmp_ge_u32 s56, 4
    s_cbranch_scc1 L_wait0_1833_d
    v_min_u32 v156, 255, v0
    v_lshlrev_b32 v156, 7, v156
    v_add_u32 v156, 0x0, v156
    s_mov_b32 s3, 0
L_wait0_1833_p:
    buffer_load_dwordx2 v[160:161], v156, s[60:63], 0 offen sc1
    s_waitcnt vmcnt(0)
    v_cmp_ne_u64 vcc, s[64:65], v[160:161]
    s_nop 0
    s_mov_b64 exec, vcc
    s_add_u32 s3, s3, 1
    s_cmp_gt_u32 s3, 0x30d40
    s_cbranch_scc1 L_wait0_1833_x
    s_cmp_eq_u64 vcc, 0
    s_cbranch_scc1 L_wait0_1833_x
    s_sleep 1
    s_branch L_wait0_1833_p
L_wait0_1833_x:
    s_mov_b64 exec, -1
L_wait0_1833_d:
    s_barrier
    buffer_load_dwordx4 v[12:15], v5, s[8:11], 0 offen sc1
    buffer_load_dwordx4 v[16:19], v5, s[8:11], 0 offen offset:1024 sc1
    buffer_load_dwordx2 v[20:21], v6, s[16:19], 0 offen sc1
    buffer_load_dwordx2 v[22:23], v6, s[16:19], 0 offen offset:512 sc1
    v_cvt_f32_u32 v176, s28
    v_fma_f32 v176, v174, 4.0, v176
    s_mov_b32 s35, 0x3a000000
    v_mul_f32 v3, s35, v173
    v_mul_f32 v4, v176, v3
    v_cos_f32 v108, v4
    v_sin_f32 v116, v4
    v_add_f32 v4, v4, v3
    v_cos_f32 v109, v4
    v_sin_f32 v117, v4
    v_add_f32 v4, v4, v3
    v_cos_f32 v110, v4
    v_sin_f32 v118, v4
    v_add_f32 v4, v4, v3
    v_cos_f32 v111, v4
    v_sin_f32 v119, v4
    v_add_f32 v3, 0x3c000000, v3
    v_mul_f32 v4, v176, v3
    v_cos_f32 v112, v4
    v_sin_f32 v120, v4
    v_add_f32 v4, v4, v3
    v_cos_f32 v113, v4
    v_sin_f32 v121, v4
    v_add_f32 v4, v4, v3
    v_cos_f32 v114, v4
    v_sin_f32 v122, v4
    v_add_f32 v4, v4, v3
    v_cos_f32 v115, v4
    v_sin_f32 v123, v4
    v_mul_f32 v108, s35, v108
    v_mul_f32 v116, s35, v116
    v_mul_f32 v109, s35, v109
    v_mul_f32 v117, s35, v117
    v_mul_f32 v110, s35, v110
    v_mul_f32 v118, s35, v118
    v_mul_f32 v111, s35, v111
    v_mul_f32 v119, s35, v119
    v_mul_f32 v112, s35, v112
    v_mul_f32 v120, s35, v120
    v_mul_f32 v113, s35, v113
    v_mul_f32 v121, s35, v121
    v_mul_f32 v114, s35, v114
    v_mul_f32 v122, s35, v122
    v_mul_f32 v115, s35, v115
    v_mul_f32 v123, s35, v123
    v_mov_b32 v3, 0x3727c5ac
    s_waitcnt vmcnt(3)
    v_lshlrev_b32 v156, 16, v12
    v_and_b32 v157, 0xffff0000, v12
    v_lshlrev_b32 v158, 16, v13
    v_and_b32 v159, 0xffff0000, v13
    v_lshlrev_b32 v160, 16, v14
    v_and_b32 v161, 0xffff0000, v14
    v_lshlrev_b32 v162, 16, v15
    v_and_b32 v163, 0xffff0000, v15
    s_waitcnt vmcnt(2)
    v_lshlrev_b32 v164, 16, v16
    v_and_b32 v165, 0xffff0000, v16
    v_lshlrev_b32 v166, 16, v17
    v_and_b32 v167, 0xffff0000, v17
    v_lshlrev_b32 v168, 16, v18
    v_and_b32 v169, 0xffff0000, v18
    v_lshlrev_b32 v170, 16, v19
    v_and_b32 v171, 0xffff0000, v19
    v_mul_f32 v157, s31, v157
    v_mul_f32 v161, s31, v161
    v_mul_f32 v165, s31, v165
    v_mul_f32 v169, s31, v169
    s_waitcnt vmcnt(1)
    v_fma_f32 v20, v20, s36, v3
    v_fma_f32 v21, v21, s36, v3
    s_waitcnt vmcnt(0)
    v_fma_f32 v22, v22, s36, v3
    v_fma_f32 v23, v23, s36, v3
    v_rsq_f32 v20, v20
    v_rsq_f32 v21, v21
    v_rsq_f32 v22, v22
    v_rsq_f32 v23, v23
    v_mul_f32 v124, v156, v20
    v_mul_f32 v125, v160, v21
    v_mul_f32 v126, v164, v22
    v_mul_f32 v127, v168, v23
    v_cvt_pk_bf16_f32 v140, v124, v125
    ds_write_b32 v188, v140 offset:0
    v_cvt_pk_bf16_f32 v141, v126, v127
    ds_write_b32 v188, v141 offset:320
    v_mul_f32 v128, v157, v20
    v_mul_f32 v129, v161, v21
    v_mul_f32 v130, v165, v22
    v_mul_f32 v131, v169, v23
    v_cvt_pk_bf16_f32 v142, v128, v129
    ds_write_b32 v188, v142 offset:5120
    v_cvt_pk_bf16_f32 v143, v130, v131
    ds_write_b32 v188, v143 offset:5440
    v_mul_f32 v132, v158, v20
    v_mul_f32 v133, v162, v21
    v_mul_f32 v134, v166, v22
    v_mul_f32 v135, v170, v23
    v_cvt_pk_bf16_f32 v144, v132, v133
    ds_write_b32 v188, v144 offset:10240
    v_cvt_pk_bf16_f32 v145, v134, v135
    ds_write_b32 v188, v145 offset:10560
    v_mul_f32 v136, v159, v20
    v_mul_f32 v137, v163, v21
    v_mul_f32 v138, v167, v22
    v_mul_f32 v139, v171, v23
    v_cvt_pk_bf16_f32 v146, v136, v137
    ds_write_b32 v188, v146 offset:15360
    v_cvt_pk_bf16_f32 v147, v138, v139
    ds_write_b32 v188, v147 offset:15680
    buffer_load_dword v32, v7, s[20:23], 0 offen offset:0 sc1
    buffer_load_dword v33, v7, s[20:23], 0 offen offset:256 sc1
    buffer_load_dword v34, v7, s[20:23], 0 offen offset:512 sc1
    buffer_load_dword v35, v7, s[20:23], 0 offen offset:768 sc1
    buffer_load_dword v36, v7, s[20:23], s30 offen offset:0 sc1
    buffer_load_dword v37, v7, s[20:23], s30 offen offset:256 sc1
    buffer_load_dword v38, v7, s[20:23], s30 offen offset:512 sc1
    buffer_load_dword v39, v7, s[20:23], s30 offen offset:768 sc1
    buffer_load_dwordx2 v[24:25], v8, s[8:11], 0 offen offset:0 sc1
    buffer_load_dwordx2 v[26:27], v8, s[8:11], 0 offen offset:512 sc1
    buffer_load_dwordx2 v[28:29], v8, s[8:11], 0 offen offset:1024 sc1
    buffer_load_dwordx2 v[30:31], v8, s[8:11], 0 offen offset:1536 sc1
    s_waitcnt lgkmcnt(0)
    s_barrier
    ds_read_b128 v[156:159], v190 offset:0
    ds_read_b128 v[160:163], v190 offset:5120
    ds_read_b128 v[164:167], v190 offset:64
    ds_read_b128 v[168:171], v190 offset:5184
    ds_read_b128 v[172:175], v190 offset:2560
    ds_read_b128 v[176:179], v190 offset:7680
    ds_read_b128 v[180:183], v190 offset:2624
    ds_read_b128 v[184:187], v190 offset:7744
    s_waitcnt lgkmcnt(7)
    v_mfma_f32_16x16x32_bf16 v[124:127], v[156:159], v[44:47], 0
    s_waitcnt lgkmcnt(6)
    v_mfma_f32_16x16x32_bf16 v[128:131], v[160:163], v[44:47], 0
    v_mfma_f32_16x16x32_bf16 v[124:127], v[160:163], v[52:55], v[124:127]
    v_mfma_f32_16x16x32_bf16 v[128:131], v[156:159], v[60:63], v[128:131]
    s_waitcnt lgkmcnt(5)
    v_mfma_f32_16x16x32_bf16 v[124:127], v[164:167], v[48:51], v[124:127]
    s_waitcnt lgkmcnt(4)
    v_mfma_f32_16x16x32_bf16 v[128:131], v[168:171], v[48:51], v[128:131]
    v_mfma_f32_16x16x32_bf16 v[124:127], v[168:171], v[56:59], v[124:127]
    v_mfma_f32_16x16x32_bf16 v[128:131], v[164:167], v[64:67], v[128:131]
    s_waitcnt lgkmcnt(3)
    v_mfma_f32_16x16x32_bf16 v[132:135], v[172:175], v[44:47], 0
    s_waitcnt vmcnt(11)
    v_lshlrev_b32 v156, 16, v32
    v_and_b32 v164, 0xffff0000, v32
    s_waitcnt vmcnt(10)
    v_lshlrev_b32 v157, 16, v33
    s_waitcnt lgkmcnt(2)
    v_mfma_f32_16x16x32_bf16 v[136:139], v[176:179], v[44:47], 0
    v_and_b32 v165, 0xffff0000, v33
    s_waitcnt vmcnt(9)
    v_lshlrev_b32 v158, 16, v34
    v_and_b32 v166, 0xffff0000, v34
    v_mfma_f32_16x16x32_bf16 v[132:135], v[176:179], v[52:55], v[132:135]
    v_mul_f32 v140, v128, v100
    v_mul_f32 v141, v129, v101
    v_mul_f32 v142, v130, v102
    v_mfma_f32_16x16x32_bf16 v[136:139], v[172:175], v[60:63], v[136:139]
    v_mul_f32 v143, v131, v103
    v_mul_f32 v148, v124, v100
    v_mul_f32 v149, v125, v101
    s_waitcnt lgkmcnt(1)
    v_mfma_f32_16x16x32_bf16 v[132:135], v[180:183], v[48:51], v[132:135]
    v_mul_f32 v150, v126, v102
    v_mul_f32 v151, v127, v103
    v_fma_f32 v140, v124, v92, v140
    s_waitcnt lgkmcnt(0)
    v_mfma_f32_16x16x32_bf16 v[136:139], v[184:187], v[48:51], v[136:139]
    v_fma_f32 v141, v125, v93, v141
    v_fma_f32 v142, v126, v94, v142
    v_fma_f32 v143, v127, v95, v143
    v_mfma_f32_16x16x32_bf16 v[132:135], v[184:187], v[56:59], v[132:135]
    v_fma_f32 v148, v128, v92, -v148
    v_fma_f32 v149, v129, v93, -v149
    v_fma_f32 v150, v130, v94, -v150
    v_mfma_f32_16x16x32_bf16 v[136:139], v[180:183], v[64:67], v[136:139]
    v_fma_f32 v151, v131, v95, -v151
    v_cvt_pk_bf16_f32 v12, v140, v141
    v_cvt_pk_bf16_f32 v16, v148, v149
    v_cvt_pk_bf16_f32 v13, v142, v143
    v_cvt_pk_bf16_f32 v17, v150, v151
    s_waitcnt vmcnt(8)
    v_lshlrev_b32 v159, 16, v35
    v_and_b32 v167, 0xffff0000, v35
    s_waitcnt vmcnt(7)
    v_lshlrev_b32 v160, 16, v36
    v_and_b32 v168, 0xffff0000, v36
    s_waitcnt vmcnt(6)
    v_lshlrev_b32 v161, 16, v37
    v_and_b32 v169, 0xffff0000, v37
    s_waitcnt vmcnt(5)
    v_lshlrev_b32 v162, 16, v38
    v_and_b32 v170, 0xffff0000, v38
    s_waitcnt vmcnt(4)
    v_lshlrev_b32 v163, 16, v39
    v_and_b32 v171, 0xffff0000, v39
    v_mul_f32 v144, v136, v104
    v_mul_f32 v145, v137, v105
    v_mul_f32 v146, v138, v106
    v_mul_f32 v147, v139, v107
    v_mul_f32 v152, v132, v104
    v_mul_f32 v153, v133, v105
    v_mul_f32 v154, v134, v106
    v_mul_f32 v155, v135, v107
    v_fma_f32 v144, v132, v96, v144
    v_fma_f32 v145, v133, v97, v145
    v_fma_f32 v146, v134, v98, v146
    v_fma_f32 v147, v135, v99, v147
    v_fma_f32 v152, v136, v96, -v152
    v_fma_f32 v153, v137, v97, -v153
    v_fma_f32 v154, v138, v98, -v154
    v_fma_f32 v155, v139, v99, -v155
    v_cvt_pk_bf16_f32 v14, v144, v145
    v_cvt_pk_bf16_f32 v18, v152, v153
    v_cvt_pk_bf16_f32 v15, v146, v147
    v_cvt_pk_bf16_f32 v19, v154, v155
    s_nop 0
    v_mfma_f32_16x16x32_bf16 v[124:127], v[68:71], v[12:15], 0
    s_waitcnt vmcnt(3)
    v_lshlrev_b32 v92, 16, v24
    v_and_b32 v96, 0xffff0000, v24
    v_mfma_f32_16x16x32_bf16 v[128:131], v[68:71], v[16:19], 0
    v_lshlrev_b32 v100, 16, v25
    v_and_b32 v104, 0xffff0000, v25
    v_mfma_f32_16x16x32_bf16 v[124:127], v[76:79], v[16:19], v[124:127]
    s_waitcnt vmcnt(2)
    v_lshlrev_b32 v93, 16, v26
    v_and_b32 v97, 0xffff0000, v26
    v_mfma_f32_16x16x32_bf16 v[128:131], v[84:87], v[12:15], v[128:131]
    v_lshlrev_b32 v101, 16, v27
    v_and_b32 v105, 0xffff0000, v27
    v_mfma_f32_16x16x32_bf16 v[132:135], v[72:75], v[12:15], 0
    v_mfma_f32_16x16x32_bf16 v[136:139], v[72:75], v[16:19], 0
    v_mfma_f32_16x16x32_bf16 v[132:135], v[80:83], v[16:19], v[132:135]
    s_nop 2
    v_mul_f32 v140, v128, v164
    v_mul_f32 v141, v129, v165
    v_mul_f32 v142, v130, v166
    v_mfma_f32_16x16x32_bf16 v[136:139], v[88:91], v[12:15], v[136:139]
    v_mul_f32 v143, v131, v167
    v_mul_f32 v148, v124, v164
    v_mul_f32 v149, v125, v165
    v_mul_f32 v150, v126, v166
    v_mul_f32 v151, v127, v167
    v_fma_f32 v140, v124, v156, -v140
    v_fma_f32 v141, v125, v157, -v141
    v_fma_f32 v142, v126, v158, -v142
    v_fma_f32 v143, v127, v159, -v143
    v_fma_f32 v148, v128, v156, v148
    v_fma_f32 v149, v129, v157, v149
    v_fma_f32 v150, v130, v158, v150
    v_fma_f32 v151, v131, v159, v151
    v_cvt_pk_bf16_f32 v180, v140, v141
    v_cvt_pk_bf16_f32 v184, v148, v149
    v_cvt_pk_bf16_f32 v181, v142, v143
    v_cvt_pk_bf16_f32 v185, v150, v151
    v_mul_f32 v144, v136, v168
    v_mul_f32 v145, v137, v169
    v_mul_f32 v146, v138, v170
    v_mul_f32 v147, v139, v171
    v_mul_f32 v152, v132, v168
    v_mul_f32 v153, v133, v169
    v_mul_f32 v154, v134, v170
    v_mul_f32 v155, v135, v171
    v_fma_f32 v144, v132, v160, -v144
    v_fma_f32 v145, v133, v161, -v145
    v_fma_f32 v146, v134, v162, -v146
    v_fma_f32 v147, v135, v163, -v147
    v_fma_f32 v152, v136, v160, v152
    v_fma_f32 v153, v137, v161, v153
    v_fma_f32 v154, v138, v162, v154
    v_fma_f32 v155, v139, v163, v155
    v_cvt_pk_bf16_f32 v182, v144, v145
    v_cvt_pk_bf16_f32 v186, v152, v153
    v_cvt_pk_bf16_f32 v183, v146, v147
    v_cvt_pk_bf16_f32 v187, v154, v155
    s_nop 0
    v_mfma_f32_16x16x32_bf16 v[124:127], v[180:183], v[68:71], 0
    s_waitcnt vmcnt(1)
    v_lshlrev_b32 v94, 16, v28
    v_and_b32 v98, 0xffff0000, v28
    v_mfma_f32_16x16x32_bf16 v[128:131], v[180:183], v[76:79], 0
    v_lshlrev_b32 v102, 16, v29
    v_and_b32 v106, 0xffff0000, v29
    v_mfma_f32_16x16x32_bf16 v[124:127], v[184:187], v[84:87], v[124:127]
    s_waitcnt vmcnt(0)
    v_lshlrev_b32 v95, 16, v30
    v_and_b32 v99, 0xffff0000, v30
    v_mfma_f32_16x16x32_bf16 v[128:131], v[184:187], v[68:71], v[128:131]
    v_lshlrev_b32 v103, 16, v31
    v_and_b32 v107, 0xffff0000, v31
    v_mfma_f32_16x16x32_bf16 v[132:135], v[180:183], v[72:75], 0
    v_mfma_f32_16x16x32_bf16 v[136:139], v[180:183], v[80:83], 0
    v_mfma_f32_16x16x32_bf16 v[132:135], v[184:187], v[88:91], v[132:135]
    s_nop 2
    v_mul_f32 v140, v128, v116
    v_mul_f32 v141, v129, v117
    v_mul_f32 v142, v130, v118
    v_mfma_f32_16x16x32_bf16 v[136:139], v[184:187], v[72:75], v[136:139]
    v_mul_f32 v143, v131, v119
    v_mul_f32 v148, v124, v116
    v_mul_f32 v149, v125, v117
    v_mul_f32 v150, v126, v118
    v_mul_f32 v151, v127, v119
    v_fma_f32 v140, v124, v108, -v140
    v_fma_f32 v141, v125, v109, -v141
    v_fma_f32 v142, v126, v110, -v142
    v_fma_f32 v143, v127, v111, -v143
    v_fma_f32 v148, v128, v108, v148
    v_fma_f32 v149, v129, v109, v149
    v_fma_f32 v150, v130, v110, v150
    v_fma_f32 v151, v131, v111, v151
    v_cvt_pk_bf16_f32 v172, v140, v141
    v_cvt_pk_bf16_f32 v173, v142, v143
    ds_write_b64 v189, v[172:173] offset:20480
    v_cvt_pk_bf16_f32 v174, v148, v149
    v_cvt_pk_bf16_f32 v175, v150, v151
    ds_write_b64 v189, v[174:175] offset:25600
    v_mul_f32 v144, v136, v120
    v_mul_f32 v145, v137, v121
    v_mul_f32 v146, v138, v122
    v_mul_f32 v147, v139, v123
    v_mul_f32 v152, v132, v120
    v_mul_f32 v153, v133, v121
    v_mul_f32 v154, v134, v122
    v_mul_f32 v155, v135, v123
    v_fma_f32 v144, v132, v112, -v144
    v_fma_f32 v145, v133, v113, -v145
    v_fma_f32 v146, v134, v114, -v146
    v_fma_f32 v147, v135, v115, -v147
    v_fma_f32 v152, v136, v112, v152
    v_fma_f32 v153, v137, v113, v153
    v_fma_f32 v154, v138, v114, v154
    v_fma_f32 v155, v139, v115, v155
    v_cvt_pk_bf16_f32 v176, v144, v145
    v_cvt_pk_bf16_f32 v177, v146, v147
    ds_write_b64 v189, v[176:177] offset:23040
    v_cvt_pk_bf16_f32 v178, v152, v153
    v_cvt_pk_bf16_f32 v179, v154, v155
    ds_write_b64 v189, v[178:179] offset:28160
    s_waitcnt lgkmcnt(0)
    s_barrier
    ds_read_b128 v[156:159], v191 offset:20480
    ds_read_b128 v[160:163], v191 offset:25600
    ds_read_b128 v[164:167], v191 offset:20544
    ds_read_b128 v[168:171], v191 offset:25664
    ds_read_b128 v[172:175], v191 offset:30720
    ds_read_b128 v[176:179], v191 offset:35840
    ds_read_b128 v[180:183], v191 offset:30784
    ds_read_b128 v[184:187], v191 offset:35904
    s_waitcnt lgkmcnt(7)
    v_mfma_f32_16x16x32_bf16 v[124:127], v[156:159], v[44:47], v[92:95]
    v_mfma_f32_16x16x32_bf16 v[128:131], v[156:159], v[52:55], v[96:99]
    s_waitcnt lgkmcnt(6)
    v_mfma_f32_16x16x32_bf16 v[124:127], v[160:163], v[60:63], v[124:127]
    v_mfma_f32_16x16x32_bf16 v[128:131], v[160:163], v[44:47], v[128:131]
    s_waitcnt lgkmcnt(5)
    v_mfma_f32_16x16x32_bf16 v[124:127], v[164:167], v[48:51], v[124:127]
    v_mfma_f32_16x16x32_bf16 v[128:131], v[164:167], v[56:59], v[128:131]
    s_waitcnt lgkmcnt(4)
    v_mfma_f32_16x16x32_bf16 v[124:127], v[168:171], v[64:67], v[124:127]
    v_mfma_f32_16x16x32_bf16 v[128:131], v[168:171], v[48:51], v[128:131]
    s_waitcnt lgkmcnt(3)
    v_mfma_f32_16x16x32_bf16 v[132:135], v[172:175], v[44:47], v[100:103]
    v_mfma_f32_16x16x32_bf16 v[136:139], v[172:175], v[52:55], v[104:107]
    s_waitcnt lgkmcnt(2)
    v_mfma_f32_16x16x32_bf16 v[132:135], v[176:179], v[60:63], v[132:135]
    v_mfma_f32_16x16x32_bf16 v[136:139], v[176:179], v[44:47], v[136:139]
    s_nop 1
    v_cndmask_b32 v128, v128, v96, s[38:39]
    v_cndmask_b32 v129, v129, v97, s[38:39]
    v_cndmask_b32 v130, v130, v98, s[38:39]
    s_waitcnt lgkmcnt(1)
    v_mfma_f32_16x16x32_bf16 v[132:135], v[180:183], v[48:51], v[132:135]
    v_cndmask_b32 v131, v131, v99, s[38:39]
    v_cvt_pk_bf16_f32 v12, v124, v128
    v_cvt_pk_bf16_f32 v14, v125, v129
    v_mfma_f32_16x16x32_bf16 v[136:139], v[180:183], v[56:59], v[136:139]
    v_cvt_pk_bf16_f32 v16, v126, v130
    v_cvt_pk_bf16_f32 v18, v127, v131
    s_waitcnt lgkmcnt(0)
    v_mfma_f32_16x16x32_bf16 v[132:135], v[184:187], v[64:67], v[132:135]
    v_mfma_f32_16x16x32_bf16 v[136:139], v[184:187], v[48:51], v[136:139]
    s_nop 7
    v_cvt_pk_bf16_f32 v13, v132, v136
    buffer_store_dwordx2 v[12:13], v8, s[12:15], 0 offen offset:0 sc1
    v_cvt_pk_bf16_f32 v15, v133, v137
    buffer_store_dwordx2 v[14:15], v8, s[12:15], 0 offen offset:512 sc1
    v_cvt_pk_bf16_f32 v17, v134, v138
    buffer_store_dwordx2 v[16:17], v8, s[12:15], 0 offen offset:1024 sc1
    v_cvt_pk_bf16_f32 v19, v135, v139
    buffer_store_dwordx2 v[18:19], v8, s[12:15], 0 offen offset:1536 sc1
    s_lshl_b32 s3, s2, 7
    s_add_u32 s3, s3, 0x8000
    v_mov_b32 v1, s3
    v_mov_b32 v2, s64
    v_mov_b32 v3, s65
    s_cmp_lg_u32 s56, 0
    s_waitcnt vmcnt(0)
    s_barrier
    s_cbranch_scc1 L_sig1_2225
    s_mov_b64 exec, 1
    buffer_store_dwordx2 v[2:3], v1, s[60:63], 0 offen sc1
    s_mov_b64 exec, -1
L_sig1_2225:
    s_branch L_a2_end
L_a2_skip:
    s_lshl_b32 s3, s2, 7
    s_add_u32 s3, s3, 0x38000
    v_mov_b32 v1, s3
    v_mov_b32 v2, s64
    v_mov_b32 v3, s65
    s_cmp_lg_u32 s56, 0
    s_waitcnt vmcnt(0)
    s_barrier
    s_cbranch_scc1 L_sig7_2240
    s_mov_b64 exec, 1
    buffer_store_dwordx2 v[2:3], v1, s[60:63], 0 offen sc1
    s_mov_b64 exec, -1
L_sig7_2240:
    s_cmp_lt_u32 s2, 192
    s_cbranch_scc1 L_pfa_np
    s_cmp_lg_u32 s56, 7
    s_cbranch_scc1 L_pfa_np
    s_getpc_b64 s[68:69]
L_pfa_pc:
    s_add_u32 s68, s68, L_a2_end - L_pfa_pc
    s_addc_u32 s69, s69, 0
    s_bfe_u32 s3, s2, 0x30003
    s_lshl_b32 s3, s3, 5
    v_and_b32 v205, 31, v0
    v_add_u32 v205, s3, v205
    v_lshlrev_b32 v205, 7, v205
    v_min_u32 v205, L_a4_skip - L_a2_end - 4, v205
    global_load_dword v206, v205, s[68:69]
    s_waitcnt vmcnt(0)
L_pfa_np:
    v_and_b32 v1, 63, v0
    v_lshlrev_b32 v1, 4, v1
    s_and_b32 s3, s2, 1
    s_lshl_b32 s3, s3, 3
    s_lshr_b32 s44, s2, 5
    s_add_u32 s3, s3, s44
    s_mul_i32 s3, s3, 129024
    s_add_u32 s40, s4, 0xfc0000
    s_addc_u32 s41, s5, 0
    s_add_u32 s40, s40, s3
    s_addc_u32 s41, s41, 0
    s_mov_b32 s42, 0x1f800
    s_mov_b32 s43, 0x20000
L_a2_end:
    s_cmp_ge_u32 s56, 2
    s_cbranch_scc1 L_wait7_2276_d
    v_min_u32 v8, 107, v0
    v_lshlrev_b32 v8, 7, v8
    v_add_u32 v8, 0x3c800, v8
    s_mov_b32 s3, 0
L_wait7_2276_p:
    buffer_load_dwordx2 v[12:13], v8, s[60:63], 0 offen sc1
    s_waitcnt vmcnt(0)
    v_cmp_ne_u64 vcc, s[64:65], v[12:13]
    s_nop 0
    s_mov_b64 exec, vcc
    s_add_u32 s3, s3, 1
    s_cmp_gt_u32 s3, 0x30d40
    s_cbranch_scc1 L_wait7_2276_x
    s_cmp_eq_u64 vcc, 0
    s_cbranch_scc1 L_wait7_2276_x
    s_sleep 1
    s_branch L_wait7_2276_p
L_wait7_2276_x:
    s_mov_b64 exec, -1
L_wait7_2276_d:
    s_barrier
    s_and_b32 s20, s2, 7
    s_lshr_b32 s21, s2, 3
    s_lshr_b32 s22, s20, 1
    s_lshl_b32 s22, s22, 2
    s_and_b32 s23, s21, 3
    s_add_u32 s22, s22, s23
    s_and_b32 s23, s20, 1
    s_lshl_b32 s23, s23, 3
    s_lshr_b32 s21, s21, 2
    s_add_u32 s23, s23, s21
    v_and_b32 v5, 63, v0
    v_lshlrev_b32 v5, 4, v5
    s_sub_u32 s44, s56, 0
    s_cmp_ge_u32 s44, 8
    s_cbranch_scc1 L_a3b_nd
    s_mul_i32 s44, s56, 16384
    s_mov_b32 m0, s44
    s_nop 0
    buffer_load_dwordx4 v5, s[40:43], s44 offen offset:0 sc1 lds
    buffer_load_dwordx4 v5, s[40:43], s44 offen offset:1024 sc1 lds
    buffer_load_dwordx4 v5, s[40:43], s44 offen offset:2048 sc1 lds
    buffer_load_dwordx4 v5, s[40:43], s44 offen offset:3072 sc1 lds
    s_add_u32 s44, s44, 0x1000
    s_mov_b32 m0, s44
    s_nop 0
    buffer_load_dwordx4 v5, s[40:43], s44 offen offset:0 sc1 lds
    buffer_load_dwordx4 v5, s[40:43], s44 offen offset:1024 sc1 lds
    buffer_load_dwordx4 v5, s[40:43], s44 offen offset:2048 sc1 lds
    buffer_load_dwordx4 v5, s[40:43], s44 offen offset:3072 sc1 lds
    s_add_u32 s44, s44, 0x1000
    s_mov_b32 m0, s44
    s_nop 0
    buffer_load_dwordx4 v5, s[40:43], s44 offen offset:0 sc1 lds
    buffer_load_dwordx4 v5, s[40:43], s44 offen offset:1024 sc1 lds
    buffer_load_dwordx4 v5, s[40:43], s44 offen offset:2048 sc1 lds
    buffer_load_dwordx4 v5, s[40:43], s44 offen offset:3072 sc1 lds
    s_add_u32 s44, s44, 0x1000
    s_mov_b32 m0, s44
    s_nop 0
    buffer_load_dwordx4 v5, s[40:43], s44 offen offset:0 sc1 lds
    buffer_load_dwordx4 v5, s[40:43], s44 offen offset:1024 sc1 lds
    buffer_load_dwordx4 v5, s[40:43], s44 offen offset:2048 sc1 lds
    buffer_load_dwordx4 v5, s[40:43], s44 offen offset:3072 sc1 lds
    s_add_u32 s44, s44, 0x1000
L_a3b_nd:
    v_and_b32 v1, 15, v0
    v_bfe_u32 v2, v0, 4, 2
    s_and_b32 s24, s56, 3
    s_and_b32 s30, s24, 1
    v_cmp_eq_u32 s[58:59], 1, v2
    v_cmp_eq_u32 s[68:69], 3, v2
    s_cmp_ge_u32 s56, 4
    s_cbranch_scc1 L_a3_help
    s_lshl_b32 s25, s22, 10
    s_lshl_b32 s26, s24, 8
    s_add_u32 s25, s25, s26
    v_lshlrev_b32 v6, 15, v2
    v_lshl_add_u32 v6, v1, 4, v6
    v_add_u32 v6, s25, v6
    v_add_u32 v7, 0x4000, v6
    s_mov_b32 s28, 0
    s_add_u32 s8, s4, 0x240000
    s_addc_u32 s9, s5, 0
    s_mov_b32 s10, 0x240000
    s_mov_b32 s11, 0x20000
    s_add_u32 s16, s4, 0x900000
    s_addc_u32 s17, s5, 0
    s_mov_b32 s18, 0x240000
    s_mov_b32 s19, 0x20000
    v_add_u32 v8, 0x10000, v5
    v_cmp_eq_u32 vcc, 0, v2
    v_mov_b32 v3, 0xffff
    s_nop 0
    v_cndmask_b32 v9, -1, v3, vcc
    s_mov_b32 s37, 0x3fb8aa3b
    s_mov_b32 s36, 0x3ae38e39
    v_mov_b32 v198, 0x358637bd
    v_cndmask_b32 v199, v198, 0, s[58:59]
    v_mov_b32 v3, 0xff800000
    v_cndmask_b32 v200, v198, v3, s[58:59]
    v_mov_b32 v3, 1.0
    v_cndmask_b32 v201, v3, 0, s[58:59]
    v_and_b32 v3, 3, v1
    v_cmp_eq_u32 s[32:33], 1, v3
    v_cmp_eq_u32 s[34:35], 2, v3
    v_cmp_eq_u32 s[46:47], 3, v3
    s_lshl_b32 s29, s22, 2
    s_add_u32 s29, s29, s24
    s_mul_i32 s29, s29, 36
    s_lshr_b32 s31, s23, 2
    s_mul_i32 s31, s31, 9
    s_add_u32 s29, s29, s31
    s_lshl_b32 s29, s29, 10
    s_and_b32 s31, s23, 3
    s_lshl_b32 s48, s31, 11
    s_add_u32 s48, s48, s29
    s_add_u32 s49, s48, 256
    s_lshr_b32 s50, s31, 1
    s_lshl_b32 s50, s50, 9
    s_and_b32 s51, s31, 1
    s_lshl_b32 s51, s51, 3
    s_add_u32 s50, s50, s51
    s_add_u32 s50, s50, s29
    s_add_u32 s50, s50, 8192
    s_add_u32 s51, s50, 256
    s_lshl_b32 s52, s24, 10
    s_add_u32 s52, s52, 147456
    s_lshl_b32 s53, s24, 12
    s_add_u32 s53, s53, 131072
    s_waitcnt vmcnt(0)
    s_cmp_ge_u32 s56, 3
    s_cbranch_scc1 L_wait1_2403_d
    v_min_u32 v12, 143, v0
    v_lshlrev_b32 v12, 7, v12
    v_add_u32 v12, 0x8000, v12
    s_mov_b32 s3, 0
L_wait1_2403_p:
    buffer_load_dwordx2 v[16:17], v12, s[60:63], 0 offen sc1
    s_waitcnt vmcnt(0)
    v_cmp_ne_u64 vcc, s[64:65], v[16:17]
    s_nop 0
    s_mov_b64 exec, vcc
    s_add_u32 s3, s3, 1
    s_cmp_gt_u32 s3, 0x30d40
    s_cbranch_scc1 L_wait1_2403_x
    s_cmp_eq_u64 vcc, 0
    s_cbranch_scc1 L_wait1_2403_x
    s_sleep 1
    s_branch L_wait1_2403_p
L_wait1_2403_x:
    s_mov_b64 exec, -1
L_wait1_2403_d:
    s_barrier
    buffer_load_dwordx4 v[12:15], v6, s[8:11], s28 offen sc1
    buffer_load_dwordx4 v[16:19], v7, s[8:11], s28 offen sc1
    s_add_u32 s28, s28, 0x20000
    buffer_load_dwordx4 v[20:23], v6, s[8:11], s28 offen sc1
    buffer_load_dwordx4 v[24:27], v7, s[8:11], s28 offen sc1
    s_add_u32 s28, s28, 0x20000
    buffer_load_dwordx4 v[28:31], v6, s[8:11], s28 offen sc1
    buffer_load_dwordx4 v[32:35], v7, s[8:11], s28 offen sc1
    s_add_u32 s28, s28, 0x20000
    buffer_load_dwordx4 v[36:39], v6, s[8:11], s28 offen sc1
    buffer_load_dwordx4 v[40:43], v7, s[8:11], s28 offen sc1
    s_add_u32 s28, s28, 0x20000
    ds_read_b128 a[0:3], v5 offset:0
    ds_read_b128 a[4:7], v5 offset:1024
    ds_read_b128 a[8:11], v5 offset:2048
    ds_read_b128 a[12:15], v5 offset:3072
    ds_read_b128 a[16:19], v5 offset:4096
    s_waitcnt vmcnt(6)
    v_swap_b32 v14, v16
    v_swap_b32 v15, v17
    v_and_b32 v12, v9, v12
    v_and_b32 v16, v9, v16
    s_waitcnt lgkmcnt(4)
    v_mfma_f32_16x16x32_bf16 v[156:159], v[12:15], a[0:3], 0
    ds_read_b128 a[20:23], v5 offset:5120
    v_mfma_f32_16x16x32_bf16 v[160:163], v[16:19], a[0:3], 0
    buffer_load_dwordx4 v[44:47], v6, s[8:11], s28 offen sc1
    s_waitcnt lgkmcnt(4)
    v_mfma_f32_16x16x32_bf16 v[164:167], v[12:15], a[4:7], 0
    ds_read_b128 a[24:27], v5 offset:6144
    v_mfma_f32_16x16x32_bf16 v[168:171], v[16:19], a[4:7], 0
    ds_read_b128 a[28:31], v5 offset:7168
    s_waitcnt lgkmcnt(5)
    v_mfma_f32_16x16x32_bf16 v[172:175], v[12:15], a[8:11], 0
    ds_read_b128 a[32:35], v5 offset:8192
    v_mfma_f32_16x16x32_bf16 v[176:179], v[16:19], a[8:11], 0
    buffer_load_dwordx4 v[48:51], v7, s[8:11], s28 offen sc1
    s_add_u32 s28, s28, 0x20000
    s_waitcnt lgkmcnt(5)
    v_mfma_f32_16x16x32_bf16 v[180:183], v[12:15], a[12:15], 0
    ds_read_b128 a[36:39], v5 offset:9216
    v_mfma_f32_16x16x32_bf16 v[184:187], v[16:19], a[12:15], 0
    s_waitcnt vmcnt(6)
    v_swap_b32 v22, v24
    s_waitcnt lgkmcnt(5)
    v_mfma_f32_16x16x32_bf16 v[188:191], a[16:19], v[12:15], 0
    v_swap_b32 v23, v25
    v_mfma_f32_16x16x32_bf16 v[192:195], a[16:19], v[16:19], 0
    v_mfma_f32_16x16x32_bf16 a[40:43], v[12:15], v[12:15], 0
    v_mfma_f32_16x16x32_bf16 a[44:47], v[16:19], v[16:19], 0
    s_waitcnt lgkmcnt(4)
    v_mfma_f32_16x16x32_bf16 v[156:159], v[20:23], a[20:23], v[156:159]
    ds_read_b128 a[0:3], v5 offset:10240
    v_mfma_f32_16x16x32_bf16 v[160:163], v[24:27], a[20:23], v[160:163]
    buffer_load_dwordx4 v[52:55], v6, s[8:11], s28 offen sc1
    s_waitcnt lgkmcnt(4)
    v_mfma_f32_16x16x32_bf16 v[164:167], v[20:23], a[24:27], v[164:167]
    ds_read_b128 a[4:7], v5 offset:11264
    v_mfma_f32_16x16x32_bf16 v[168:171], v[24:27], a[24:27], v[168:171]
    ds_read_b128 a[8:11], v5 offset:12288
    s_waitcnt lgkmcnt(5)
    v_mfma_f32_16x16x32_bf16 v[172:175], v[20:23], a[28:31], v[172:175]
    ds_read_b128 a[12:15], v5 offset:13312
    v_mfma_f32_16x16x32_bf16 v[176:179], v[24:27], a[28:31], v[176:179]
    buffer_load_dwordx4 v[56:59], v7, s[8:11], s28 offen sc1
    s_add_u32 s28, s28, 0x20000
    s_waitcnt lgkmcnt(5)
    v_mfma_f32_16x16x32_bf16 v[180:183], v[20:23], a[32:35], v[180:183]
    ds_read_b128 a[16:19], v5 offset:14336
    v_mfma_f32_16x16x32_bf16 v[184:187], v[24:27], a[32:35], v[184:187]
    s_waitcnt vmcnt(6)
    v_swap_b32 v30, v32
    s_waitcnt lgkmcnt(5)
    v_mfma_f32_16x16x32_bf16 v[188:191], a[36:39], v[20:23], v[188:191]
    v_swap_b32 v31, v33
    v_mfma_f32_16x16x32_bf16 v[192:195], a[36:39], v[24:27], v[192:195]
    v_mfma_f32_16x16x32_bf16 a[40:43], v[20:23], v[20:23], a[40:43]
    v_mfma_f32_16x16x32_bf16 a[44:47], v[24:27], v[24:27], a[44:47]
    s_waitcnt lgkmcnt(4)
    v_mfma_f32_16x16x32_bf16 v[156:159], v[28:31], a[0:3], v[156:159]
    ds_read_b128 a[20:23], v5 offset:15360
    v_mfma_f32_16x16x32_bf16 v[160:163], v[32:35], a[0:3], v[160:163]
    buffer_load_dwordx4 v[60:63], v6, s[8:11], s28 offen sc1
    s_waitcnt lgkmcnt(4)
    v_mfma_f32_16x16x32_bf16 v[164:167], v[28:31], a[4:7], v[164:167]
    ds_read_b128 a[24:27], v5 offset:16384
    v_mfma_f32_16x16x32_bf16 v[168:171], v[32:35], a[4:7], v[168:171]
    ds_read_b128 a[28:31], v5 offset:17408
    s_waitcnt lgkmcnt(5)
    v_mfma_f32_16x16x32_bf16 v[172:175], v[28:31], a[8:11], v[172:175]
    ds_read_b128 a[32:35], v5 offset:18432
    v_mfma_f32_16x16x32_bf16 v[176:179], v[32:35], a[8:11], v[176:179]
    buffer_load_dwordx4 v[64:67], v7, s[8:11], s28 offen sc1
    s_add_u32 s28, s28, 0x20000
    s_waitcnt lgkmcnt(5)
    v_mfma_f32_16x16x32_bf16 v[180:183], v[28:31], a[12:15], v[180:183]
    ds_read_b128 a[36:39], v5 offset:19456
    v_mfma_f32_16x16x32_bf16 v[184:187], v[32:35], a[12:15], v[184:187]
    s_waitcnt vmcnt(6)
    v_swap_b32 v38, v40
    s_waitcnt lgkmcnt(5)
    v_mfma_f32_16x16x32_bf16 v[188:191], a[16:19], v[28:31], v[188:191]
    v_swap_b32 v39, v41
    v_mfma_f32_16x16x32_bf16 v[192:195], a[16:19], v[32:35], v[192:195]
    v_mfma_f32_16x16x32_bf16 a[40:43], v[28:31], v[28:31], a[40:43]
    v_mfma_f32_16x16x32_bf16 a[44:47], v[32:35], v[32:35], a[44:47]
    s_waitcnt lgkmcnt(4)
    v_mfma_f32_16x16x32_bf16 v[156:159], v[36:39], a[20:23], v[156:159]
    ds_read_b128 a[0:3], v5 offset:20480
    v_mfma_f32_16x16x32_bf16 v[160:163], v[40:43], a[20:23], v[160:163]
    buffer_load_dwordx4 v[68:71], v6, s[8:11], s28 offen sc1
    s_waitcnt lgkmcnt(4)
    v_mfma_f32_16x16x32_bf16 v[164:167], v[36:39], a[24:27], v[164:167]
    ds_read_b128 a[4:7], v5 offset:21504
    v_mfma_f32_16x16x32_bf16 v[168:171], v[40:43], a[24:27], v[168:171]
    ds_read_b128 a[8:11], v5 offset:22528
    s_waitcnt lgkmcnt(5)
    v_mfma_f32_16x16x32_bf16 v[172:175], v[36:39], a[28:31], v[172:175]
    ds_read_b128 a[12:15], v5 offset:23552
    v_mfma_f32_16x16x32_bf16 v[176:179], v[40:43], a[28:31], v[176:179]
    buffer_load_dwordx4 v[72:75], v7, s[8:11], s28 offen sc1
    s_add_u32 s28, s28, 0x20000
    s_waitcnt lgkmcnt(5)
    v_mfma_f32_16x16x32_bf16 v[180:183], v[36:39], a[32:35], v[180:183]
    ds_read_b128 a[16:19], v5 offset:24576
    v_mfma_f32_16x16x32_bf16 v[184:187], v[40:43], a[32:35], v[184:187]
    s_waitcnt vmcnt(6)
    v_swap_b32 v46, v48
    s_waitcnt lgkmcnt(5)
    v_mfma_f32_16x16x32_bf16 v[188:191], a[36:39], v[36:39], v[188:191]
    v_swap_b32 v47, v49
    v_mfma_f32_16x16x32_bf16 v[192:195], a[36:39], v[40:43], v[192:195]
    v_mfma_f32_16x16x32_bf16 a[40:43], v[36:39], v[36:39], a[40:43]
    v_mfma_f32_16x16x32_bf16 a[44:47], v[40:43], v[40:43], a[44:47]
    s_waitcnt lgkmcnt(4)
    v_mfma_f32_16x16x32_bf16 v[156:159], v[44:47], a[0:3], v[156:159]
    ds_read_b128 a[20:23], v5 offset:25600
    v_mfma_f32_16x16x32_bf16 v[160:163], v[48:51], a[0:3], v[160:163]
    buffer_load_dwordx4 v[76:79], v6, s[8:11], s28 offen sc1
    s_waitcnt lgkmcnt(4)
    v_mfma_f32_16x16x32_bf16 v[164:167], v[44:47], a[4:7], v[164:167]
    ds_read_b128 a[24:27], v5 offset:26624
    v_mfma_f32_16x16x32_bf16 v[168:171], v[48:51], a[4:7], v[168:171]
    ds_read_b128 a[28:31], v5 offset:27648
    s_waitcnt lgkmcnt(5)
    v_mfma_f32_16x16x32_bf16 v[172:175], v[44:47], a[8:11], v[172:175]
    ds_read_b128 a[32:35], v5 offset:28672
    v_mfma_f32_16x16x32_bf16 v[176:179], v[48:51], a[8:11], v[176:179]
    buffer_load_dwordx4 v[80:83], v7, s[8:11], s28 offen sc1
    s_add_u32 s28, s28, 0x20000
    s_waitcnt lgkmcnt(5)
    v_mfma_f32_16x16x32_bf16 v[180:183], v[44:47], a[12:15], v[180:183]
    ds_read_b128 a[36:39], v5 offset:29696
    v_mfma_f32_16x16x32_bf16 v[184:187], v[48:51], a[12:15], v[184:187]
    s_waitcnt vmcnt(6)
    v_swap_b32 v54, v56
    s_waitcnt lgkmcnt(5)
    v_mfma_f32_16x16x32_bf16 v[188:191], a[16:19], v[44:47], v[188:191]
    v_swap_b32 v55, v57
    v_mfma_f32_16x16x32_bf16 v[192:195], a[16:19], v[48:51], v[192:195]
    v_mfma_f32_16x16x32_bf16 a[40:43], v[44:47], v[44:47], a[40:43]
    v_mfma_f32_16x16x32_bf16 a[44:47], v[48:51], v[48:51], a[44:47]
    s_waitcnt lgkmcnt(4)
    v_mfma_f32_16x16x32_bf16 v[156:159], v[52:55], a[20:23], v[156:159]
    ds_read_b128 a[0:3], v5 offset:30720
    v_mfma_f32_16x16x32_bf16 v[160:163], v[56:59], a[20:23], v[160:163]
    buffer_load_dwordx4 v[84:87], v6, s[8:11], s28 offen sc1
    s_waitcnt lgkmcnt(4)
    v_mfma_f32_16x16x32_bf16 v[164:167], v[52:55], a[24:27], v[164:167]
    ds_read_b128 a[4:7], v5 offset:31744
    v_mfma_f32_16x16x32_bf16 v[168:171], v[56:59], a[24:27], v[168:171]
    ds_read_b128 a[8:11], v5 offset:32768
    s_waitcnt lgkmcnt(5)
    v_mfma_f32_16x16x32_bf16 v[172:175], v[52:55], a[28:31], v[172:175]
    ds_read_b128 a[12:15], v5 offset:33792
    v_mfma_f32_16x16x32_bf16 v[176:179], v[56:59], a[28:31], v[176:179]
    buffer_load_dwordx4 v[88:91], v7, s[8:11], s28 offen sc1
    s_add_u32 s28, s28, 0x20000
    s_waitcnt lgkmcnt(5)
    v_mfma_f32_16x16x32_bf16 v[180:183], v[52:55], a[32:35], v[180:183]
    ds_read_b128 a[16:19], v5 offset:34816
    v_mfma_f32_16x16x32_bf16 v[184:187], v[56:59], a[32:35], v[184:187]
    s_waitcnt vmcnt(6)
    v_swap_b32 v62, v64
    s_waitcnt lgkmcnt(5)
    v_mfma_f32_16x16x32_bf16 v[188:191], a[36:39], v[52:55], v[188:191]
    v_swap_b32 v63, v65
    v_mfma_f32_16x16x32_bf16 v[192:195], a[36:39], v[56:59], v[192:195]
    v_mfma_f32_16x16x32_bf16 a[40:43], v[52:55], v[52:55], a[40:43]
    v_mfma_f32_16x16x32_bf16 a[44:47], v[56:59], v[56:59], a[44:47]
    s_waitcnt lgkmcnt(4)
    v_mfma_f32_16x16x32_bf16 v[156:159], v[60:63], a[0:3], v[156:159]
    ds_read_b128 a[20:23], v5 offset:35840
    v_mfma_f32_16x16x32_bf16 v[160:163], v[64:67], a[0:3], v[160:163]
    buffer_load_dwordx4 v[92:95], v6, s[8:11], s28 offen sc1
    s_waitcnt lgkmcnt(4)
    v_mfma_f32_16x16x32_bf16 v[164:167], v[60:63], a[4:7], v[164:167]
    ds_read_b128 a[24:27], v5 offset:36864
    v_mfma_f32_16x16x32_bf16 v[168:171], v[64:67], a[4:7], v[168:171]
    ds_read_b128 a[28:31], v5 offset:37888
    s_waitcnt lgkmcnt(5)
    v_mfma_f32_16x16x32_bf16 v[172:175], v[60:63], a[8:11], v[172:175]
    ds_read_b128 a[32:35], v5 offset:38912
    v_mfma_f32_16x16x32_bf16 v[176:179], v[64:67], a[8:11], v[176:179]
    buffer_load_dwordx4 v[96:99], v7, s[8:11], s28 offen sc1
    s_add_u32 s28, s28, 0x20000
    s_waitcnt lgkmcnt(5)
    v_mfma_f32_16x16x32_bf16 v[180:183], v[60:63], a[12:15], v[180:183]
    ds_read_b128 a[36:39], v5 offset:39936
    v_mfma_f32_16x16x32_bf16 v[184:187], v[64:67], a[12:15], v[184:187]
    s_waitcnt vmcnt(6)
    v_swap_b32 v70, v72
    s_waitcnt lgkmcnt(5)
    v_mfma_f32_16x16x32_bf16 v[188:191], a[16:19], v[60:63], v[188:191]
    v_swap_b32 v71, v73
    v_mfma_f32_16x16x32_bf16 v[192:195], a[16:19], v[64:67], v[192:195]
    v_mfma_f32_16x16x32_bf16 a[40:43], v[60:63], v[60:63], a[40:43]
    v_mfma_f32_16x16x32_bf16 a[44:47], v[64:67], v[64:67], a[44:47]
    s_waitcnt lgkmcnt(4)
    v_mfma_f32_16x16x32_bf16 v[156:159], v[68:71], a[20:23], v[156:159]
    ds_read_b128 a[0:3], v5 offset:40960
    v_mfma_f32_16x16x32_bf16 v[160:163], v[72:75], a[20:23], v[160:163]
    buffer_load_dwordx4 v[100:103], v6, s[8:11], s28 offen sc1
    s_waitcnt lgkmcnt(4)
    v_mfma_f32_16x16x32_bf16 v[164:167], v[68:71], a[24:27], v[164:167]
    ds_read_b128 a[4:7], v5 offset:41984
    v_mfma_f32_16x16x32_bf16 v[168:171], v[72:75], a[24:27], v[168:171]
    ds_read_b128 a[8:11], v5 offset:43008
    s_waitcnt lgkmcnt(5)
    v_mfma_f32_16x16x32_bf16 v[172:175], v[68:71], a[28:31], v[172:175]
    ds_read_b128 a[12:15], v5 offset:44032
    v_mfma_f32_16x16x32_bf16 v[176:179], v[72:75], a[28:31], v[176:179]
    buffer_load_dwordx4 v[104:107], v7, s[8:11], s28 offen sc1
    s_add_u32 s28, s28, 0x20000
    s_waitcnt lgkmcnt(5)
    v_mfma_f32_16x16x32_bf16 v[180:183], v[68:71], a[32:35], v[180:183]
    ds_read_b128 a[16:19], v5 offset:45056
    v_mfma_f32_16x16x32_bf16 v[184:187], v[72:75], a[32:35], v[184:187]
    s_waitcnt vmcnt(6)
    v_swap_b32 v78, v80
    s_waitcnt lgkmcnt(5)
    v_mfma_f32_16x16x32_bf16 v[188:191], a[36:39], v[68:71], v[188:191]
    v_swap_b32 v79, v81
    v_mfma_f32_16x16x32_bf16 v[192:195], a[36:39], v[72:75], v[192:195]
    v_mfma_f32_16x16x32_bf16 a[40:43], v[68:71], v[68:71], a[40:43]
    v_mfma_f32_16x16x32_bf16 a[44:47], v[72:75], v[72:75], a[44:47]
    s_waitcnt lgkmcnt(4)
    v_mfma_f32_16x16x32_bf16 v[156:159], v[76:79], a[0:3], v[156:159]
    ds_read_b128 a[20:23], v5 offset:46080
    v_mfma_f32_16x16x32_bf16 v[160:163], v[80:83], a[0:3], v[160:163]
    buffer_load_dwordx4 v[108:111], v6, s[8:11], s28 offen sc1
    s_waitcnt lgkmcnt(4)
    v_mfma_f32_16x16x32_bf16 v[164:167], v[76:79], a[4:7], v[164:167]
    ds_read_b128 a[24:27], v5 offset:47104
    v_mfma_f32_16x16x32_bf16 v[168:171], v[80:83], a[4:7], v[168:171]
    ds_read_b128 a[28:31], v5 offset:48128
    s_waitcnt lgkmcnt(5)
    v_mfma_f32_16x16x32_bf16 v[172:175], v[76:79], a[8:11], v[172:175]
    ds_read_b128 a[32:35], v5 offset:49152
    v_mfma_f32_16x16x32_bf16 v[176:179], v[80:83], a[8:11], v[176:179]
    buffer_load_dwordx4 v[112:115], v7, s[8:11], s28 offen sc1
    s_add_u32 s28, s28, 0x20000
    s_waitcnt lgkmcnt(5)
    v_mfma_f32_16x16x32_bf16 v[180:183], v[76:79], a[12:15], v[180:183]
    ds_read_b128 a[36:39], v5 offset:50176
    v_mfma_f32_16x16x32_bf16 v[184:187], v[80:83], a[12:15], v[184:187]
    s_waitcnt vmcnt(6)
    v_swap_b32 v86, v88
    s_waitcnt lgkmcnt(5)
    v_mfma_f32_16x16x32_bf16 v[188:191], a[16:19], v[76:79], v[188:191]
    v_swap_b32 v87, v89
    v_mfma_f32_16x16x32_bf16 v[192:195], a[16:19], v[80:83], v[192:195]
    v_mfma_f32_16x16x32_bf16 a[40:43], v[76:79], v[76:79], a[40:43]
    v_mfma_f32_16x16x32_bf16 a[44:47], v[80:83], v[80:83], a[44:47]
    s_waitcnt lgkmcnt(4)
    v_mfma_f32_16x16x32_bf16 v[156:159], v[84:87], a[20:23], v[156:159]
    ds_read_b128 a[0:3], v5 offset:51200
    v_mfma_f32_16x16x32_bf16 v[160:163], v[88:91], a[20:23], v[160:163]
    buffer_load_dwordx4 v[116:119], v6, s[8:11], s28 offen sc1
    s_waitcnt lgkmcnt(4)
    v_mfma_f32_16x16x32_bf16 v[164:167], v[84:87], a[24:27], v[164:167]
    ds_read_b128 a[4:7], v5 offset:52224
    v_mfma_f32_16x16x32_bf16 v[168:171], v[88:91], a[24:27], v[168:171]
    ds_read_b128 a[8:11], v5 offset:53248
    s_waitcnt lgkmcnt(5)
    v_mfma_f32_16x16x32_bf16 v[172:175], v[84:87], a[28:31], v[172:175]
    ds_read_b128 a[12:15], v5 offset:54272
    v_mfma_f32_16x16x32_bf16 v[176:179], v[88:91], a[28:31], v[176:179]
    buffer_load_dwordx4 v[120:123], v7, s[8:11], s28 offen sc1
    s_add_u32 s28, s28, 0x20000
    s_waitcnt lgkmcnt(5)
    v_mfma_f32_16x16x32_bf16 v[180:183], v[84:87], a[32:35], v[180:183]
    ds_read_b128 a[16:19], v5 offset:55296
    v_mfma_f32_16x16x32_bf16 v[184:187], v[88:91], a[32:35], v[184:187]
    s_waitcnt vmcnt(6)
    v_swap_b32 v94, v96
    s_waitcnt lgkmcnt(5)
    v_mfma_f32_16x16x32_bf16 v[188:191], a[36:39], v[84:87], v[188:191]
    v_swap_b32 v95, v97
    v_mfma_f32_16x16x32_bf16 v[192:195], a[36:39], v[88:91], v[192:195]
    v_mfma_f32_16x16x32_bf16 a[40:43], v[84:87], v[84:87], a[40:43]
    v_mfma_f32_16x16x32_bf16 a[44:47], v[88:91], v[88:91], a[44:47]
    s_waitcnt lgkmcnt(4)
    v_mfma_f32_16x16x32_bf16 v[156:159], v[92:95], a[0:3], v[156:159]
    ds_read_b128 a[20:23], v5 offset:56320
    v_mfma_f32_16x16x32_bf16 v[160:163], v[96:99], a[0:3], v[160:163]
    buffer_load_dwordx4 v[124:127], v6, s[8:11], s28 offen sc1
    s_waitcnt lgkmcnt(4)
    v_mfma_f32_16x16x32_bf16 v[164:167], v[92:95], a[4:7], v[164:167]
    ds_read_b128 a[24:27], v5 offset:57344
    v_mfma_f32_16x16x32_bf16 v[168:171], v[96:99], a[4:7], v[168:171]
    ds_read_b128 a[28:31], v5 offset:58368
    s_waitcnt lgkmcnt(5)
    v_mfma_f32_16x16x32_bf16 v[172:175], v[92:95], a[8:11], v[172:175]
    ds_read_b128 a[32:35], v5 offset:59392
    v_mfma_f32_16x16x32_bf16 v[176:179], v[96:99], a[8:11], v[176:179]
    buffer_load_dwordx4 v[128:131], v7, s[8:11], s28 offen sc1
    s_add_u32 s28, s28, 0x20000
    s_waitcnt lgkmcnt(5)
    v_mfma_f32_16x16x32_bf16 v[180:183], v[92:95], a[12:15], v[180:183]
    ds_read_b128 a[36:39], v5 offset:60416
    v_mfma_f32_16x16x32_bf16 v[184:187], v[96:99], a[12:15], v[184:187]
    s_waitcnt vmcnt(6)
    v_swap_b32 v102, v104
    s_waitcnt lgkmcnt(5)
    v_mfma_f32_16x16x32_bf16 v[188:191], a[16:19], v[92:95], v[188:191]
    v_swap_b32 v103, v105
    v_mfma_f32_16x16x32_bf16 v[192:195], a[16:19], v[96:99], v[192:195]
    v_mfma_f32_16x16x32_bf16 a[40:43], v[92:95], v[92:95], a[40:43]
    v_mfma_f32_16x16x32_bf16 a[44:47], v[96:99], v[96:99], a[44:47]
    s_waitcnt lgkmcnt(4)
    v_mfma_f32_16x16x32_bf16 v[156:159], v[100:103], a[20:23], v[156:159]
    ds_read_b128 a[0:3], v5 offset:61440
    v_mfma_f32_16x16x32_bf16 v[160:163], v[104:107], a[20:23], v[160:163]
    buffer_load_dwordx4 v[132:135], v6, s[8:11], s28 offen sc1
    s_waitcnt lgkmcnt(4)
    v_mfma_f32_16x16x32_bf16 v[164:167], v[100:103], a[24:27], v[164:167]
    ds_read_b128 a[4:7], v5 offset:62464
    v_mfma_f32_16x16x32_bf16 v[168:171], v[104:107], a[24:27], v[168:171]
    ds_read_b128 a[8:11], v5 offset:63488
    s_waitcnt lgkmcnt(5)
    v_mfma_f32_16x16x32_bf16 v[172:175], v[100:103], a[28:31], v[172:175]
    ds_read_b128 a[12:15], v5 offset:64512
    v_mfma_f32_16x16x32_bf16 v[176:179], v[104:107], a[28:31], v[176:179]
    buffer_load_dwordx4 v[136:139], v7, s[8:11], s28 offen sc1
    s_add_u32 s28, s28, 0x20000
    s_waitcnt lgkmcnt(5)
    v_mfma_f32_16x16x32_bf16 v[180:183], v[100:103], a[32:35], v[180:183]
    ds_read_b128 a[16:19], v8 offset:0
    v_mfma_f32_16x16x32_bf16 v[184:187], v[104:107], a[32:35], v[184:187]
    s_waitcnt vmcnt(6)
    v_swap_b32 v110, v112
    s_waitcnt lgkmcnt(5)
    v_mfma_f32_16x16x32_bf16 v[188:191], a[36:39], v[100:103], v[188:191]
    v_swap_b32 v111, v113
    v_mfma_f32_16x16x32_bf16 v[192:195], a[36:39], v[104:107], v[192:195]
    v_mfma_f32_16x16x32_bf16 a[40:43], v[100:103], v[100:103], a[40:43]
    v_mfma_f32_16x16x32_bf16 a[44:47], v[104:107], v[104:107], a[44:47]
    s_waitcnt lgkmcnt(4)
    v_mfma_f32_16x16x32_bf16 v[156:159], v[108:111], a[0:3], v[156:159]
    ds_read_b128 a[20:23], v8 offset:1024
    v_mfma_f32_16x16x32_bf16 v[160:163], v[112:115], a[0:3], v[160:163]
    buffer_load_dwordx4 v[140:143], v6, s[8:11], s28 offen sc1
    s_waitcnt lgkmcnt(4)
    v_mfma_f32_16x16x32_bf16 v[164:167], v[108:111], a[4:7], v[164:167]
    ds_read_b128 a[24:27], v8 offset:2048
    v_mfma_f32_16x16x32_bf16 v[168:171], v[112:115], a[4:7], v[168:171]
    ds_read_b128 a[28:31], v8 offset:3072
    s_waitcnt lgkmcnt(5)
    v_mfma_f32_16x16x32_bf16 v[172:175], v[108:111], a[8:11], v[172:175]
    ds_read_b128 a[32:35], v8 offset:4096
    v_mfma_f32_16x16x32_bf16 v[176:179], v[112:115], a[8:11], v[176:179]
    buffer_load_dwordx4 v[144:147], v7, s[8:11], s28 offen sc1
    s_add_u32 s28, s28, 0x20000
    s_waitcnt lgkmcnt(5)
    v_mfma_f32_16x16x32_bf16 v[180:183], v[108:111], a[12:15], v[180:183]
    ds_read_b128 a[36:39], v8 offset:5120
    v_mfma_f32_16x16x32_bf16 v[184:187], v[112:115], a[12:15], v[184:187]
    s_waitcnt vmcnt(6)
    v_swap_b32 v118, v120
    s_waitcnt lgkmcnt(5)
    v_mfma_f32_16x16x32_bf16 v[188:191], a[16:19], v[108:111], v[188:191]
    v_swap_b32 v119, v121
    v_mfma_f32_16x16x32_bf16 v[192:195], a[16:19], v[112:115], v[192:195]
    v_mfma_f32_16x16x32_bf16 a[40:43], v[108:111], v[108:111], a[40:43]
    v_mfma_f32_16x16x32_bf16 a[44:47], v[112:115], v[112:115], a[44:47]
    s_waitcnt lgkmcnt(4)
    v_mfma_f32_16x16x32_bf16 v[156:159], v[116:119], a[20:23], v[156:159]
    ds_read_b128 a[0:3], v8 offset:6144
    v_mfma_f32_16x16x32_bf16 v[160:163], v[120:123], a[20:23], v[160:163]
    buffer_load_dwordx4 v[148:151], v6, s[8:11], s28 offen sc1
    s_waitcnt lgkmcnt(4)
    v_mfma_f32_16x16x32_bf16 v[164:167], v[116:119], a[24:27], v[164:167]
    ds_read_b128 a[4:7], v8 offset:7168
    v_mfma_f32_16x16x32_bf16 v[168:171], v[120:123], a[24:27], v[168:171]
    ds_read_b128 a[8:11], v8 offset:8192
    s_waitcnt lgkmcnt(5)
    v_mfma_f32_16x16x32_bf16 v[172:175], v[116:119], a[28:31], v[172:175]
    ds_read_b128 a[12:15], v8 offset:9216
    v_mfma_f32_16x16x32_bf16 v[176:179], v[120:123], a[28:31], v[176:179]
    buffer_load_dwordx4 v[152:155], v7, s[8:11], s28 offen sc1
    s_add_u32 s28, s28, 0x20000
    s_waitcnt lgkmcnt(5)
    v_mfma_f32_16x16x32_bf16 v[180:183], v[116:119], a[32:35], v[180:183]
    ds_read_b128 a[16:19], v8 offset:10240
    v_mfma_f32_16x16x32_bf16 v[184:187], v[120:123], a[32:35], v[184:187]
    s_waitcnt vmcnt(6)
    v_swap_b32 v126, v128
    s_waitcnt lgkmcnt(5)
    v_mfma_f32_16x16x32_bf16 v[188:191], a[36:39], v[116:119], v[188:191]
    v_swap_b32 v127, v129
    v_mfma_f32_16x16x32_bf16 v[192:195], a[36:39], v[120:123], v[192:195]
    v_mfma_f32_16x16x32_bf16 a[40:43], v[116:119], v[116:119], a[40:43]
    v_mfma_f32_16x16x32_bf16 a[44:47], v[120:123], v[120:123], a[44:47]
    s_waitcnt lgkmcnt(4)
    v_mfma_f32_16x16x32_bf16 v[156:159], v[124:127], a[0:3], v[156:159]
    ds_read_b128 a[20:23], v8 offset:11264
    v_mfma_f32_16x16x32_bf16 v[160:163], v[128:131], a[0:3], v[160:163]
    ds_read_b128 a[24:27], v8 offset:12288
    s_waitcnt lgkmcnt(5)
    v_mfma_f32_16x16x32_bf16 v[164:167], v[124:127], a[4:7], v[164:167]
    ds_read_b128 a[28:31], v8 offset:13312
    v_mfma_f32_16x16x32_bf16 v[168:171], v[128:131], a[4:7], v[168:171]
    ds_read_b128 a[32:35], v8 offset:14336
    s_waitcnt lgkmcnt(6)
    v_mfma_f32_16x16x32_bf16 v[172:175], v[124:127], a[8:11], v[172:175]
    ds_read_b128 a[36:39], v8 offset:15360
    v_mfma_f32_16x16x32_bf16 v[176:179], v[128:131], a[8:11], v[176:179]
    s_waitcnt vmcnt(4)
    v_swap_b32 v134, v136
    s_waitcnt lgkmcnt(6)
    v_mfma_f32_16x16x32_bf16 v[180:183], v[124:127], a[12:15], v[180:183]
    v_swap_b32 v135, v137
    v_mfma_f32_16x16x32_bf16 v[184:187], v[128:131], a[12:15], v[184:187]
    s_waitcnt lgkmcnt(5)
    v_mfma_f32_16x16x32_bf16 v[188:191], a[16:19], v[124:127], v[188:191]
    v_mfma_f32_16x16x32_bf16 v[192:195], a[16:19], v[128:131], v[192:195]
    v_mfma_f32_16x16x32_bf16 a[40:43], v[124:127], v[124:127], a[40:43]
    v_mfma_f32_16x16x32_bf16 a[44:47], v[128:131], v[128:131], a[44:47]
    s_waitcnt lgkmcnt(4)
    v_mfma_f32_16x16x32_bf16 v[156:159], v[132:135], a[20:23], v[156:159]
    ds_read_b128 a[0:3], v8 offset:16384
    v_mfma_f32_16x16x32_bf16 v[160:163], v[136:139], a[20:23], v[160:163]
    ds_read_b128 a[4:7], v8 offset:17408
    s_waitcnt lgkmcnt(5)
    v_mfma_f32_16x16x32_bf16 v[164:167], v[132:135], a[24:27], v[164:167]
    ds_read_b128 a[8:11], v8 offset:18432
    v_mfma_f32_16x16x32_bf16 v[168:171], v[136:139], a[24:27], v[168:171]
    ds_read_b128 a[12:15], v8 offset:19456
    s_waitcnt lgkmcnt(6)
    v_mfma_f32_16x16x32_bf16 v[172:175], v[132:135], a[28:31], v[172:175]
    ds_read_b128 a[16:19], v8 offset:20480
    v_mfma_f32_16x16x32_bf16 v[176:179], v[136:139], a[28:31], v[176:179]
    s_waitcnt vmcnt(2)
    v_swap_b32 v142, v144
    s_waitcnt lgkmcnt(6)
    v_mfma_f32_16x16x32_bf16 v[180:183], v[132:135], a[32:35], v[180:183]
    v_swap_b32 v143, v145
    v_mfma_f32_16x16x32_bf16 v[184:187], v[136:139], a[32:35], v[184:187]
    s_waitcnt lgkmcnt(5)
    v_mfma_f32_16x16x32_bf16 v[188:191], a[36:39], v[132:135], v[188:191]
    v_mfma_f32_16x16x32_bf16 v[192:195], a[36:39], v[136:139], v[192:195]
    v_mfma_f32_16x16x32_bf16 a[40:43], v[132:135], v[132:135], a[40:43]
    v_mfma_f32_16x16x32_bf16 a[44:47], v[136:139], v[136:139], a[44:47]
    s_waitcnt lgkmcnt(4)
    v_mfma_f32_16x16x32_bf16 v[156:159], v[140:143], a[0:3], v[156:159]
    ds_read_b128 a[20:23], v8 offset:21504
    v_mfma_f32_16x16x32_bf16 v[160:163], v[144:147], a[0:3], v[160:163]
    ds_read_b128 a[24:27], v8 offset:22528
    s_waitcnt lgkmcnt(5)
    v_mfma_f32_16x16x32_bf16 v[164:167], v[140:143], a[4:7], v[164:167]
    ds_read_b128 a[28:31], v8 offset:23552
    v_mfma_f32_16x16x32_bf16 v[168:171], v[144:147], a[4:7], v[168:171]
    ds_read_b128 a[32:35], v8 offset:24576
    s_waitcnt lgkmcnt(6)
    v_mfma_f32_16x16x32_bf16 v[172:175], v[140:143], a[8:11], v[172:175]
    ds_read_b128 a[36:39], v8 offset:25600
    v_mfma_f32_16x16x32_bf16 v[176:179], v[144:147], a[8:11], v[176:179]
    s_waitcnt vmcnt(0)
    v_swap_b32 v150, v152
    s_waitcnt lgkmcnt(6)
    v_mfma_f32_16x16x32_bf16 v[180:183], v[140:143], a[12:15], v[180:183]
    v_swap_b32 v151, v153
    v_mfma_f32_16x16x32_bf16 v[184:187], v[144:147], a[12:15], v[184:187]
    s_waitcnt lgkmcnt(5)
    v_mfma_f32_16x16x32_bf16 v[188:191], a[16:19], v[140:143], v[188:191]
    v_mfma_f32_16x16x32_bf16 v[192:195], a[16:19], v[144:147], v[192:195]
    v_mfma_f32_16x16x32_bf16 a[40:43], v[140:143], v[140:143], a[40:43]
    v_mfma_f32_16x16x32_bf16 a[44:47], v[144:147], v[144:147], a[44:47]
    s_waitcnt lgkmcnt(4)
    v_mfma_f32_16x16x32_bf16 v[156:159], v[148:151], a[20:23], v[156:159]
    v_mfma_f32_16x16x32_bf16 v[160:163], v[152:155], a[20:23], v[160:163]
    s_waitcnt lgkmcnt(3)
    v_mfma_f32_16x16x32_bf16 v[164:167], v[148:151], a[24:27], v[164:167]
    v_mfma_f32_16x16x32_bf16 v[168:171], v[152:155], a[24:27], v[168:171]
    s_waitcnt lgkmcnt(2)
    v_mfma_f32_16x16x32_bf16 v[172:175], v[148:151], a[28:31], v[172:175]
    v_mfma_f32_16x16x32_bf16 v[176:179], v[152:155], a[28:31], v[176:179]
    s_waitcnt lgkmcnt(1)
    v_mfma_f32_16x16x32_bf16 v[180:183], v[148:151], a[32:35], v[180:183]
    v_mfma_f32_16x16x32_bf16 v[184:187], v[152:155], a[32:35], v[184:187]
    s_waitcnt lgkmcnt(0)
    v_mfma_f32_16x16x32_bf16 v[188:191], a[36:39], v[148:151], v[188:191]
    v_mfma_f32_16x16x32_bf16 v[192:195], a[36:39], v[152:155], v[192:195]
    v_mfma_f32_16x16x32_bf16 a[40:43], v[148:151], v[148:151], a[40:43]
    v_mfma_f32_16x16x32_bf16 a[44:47], v[152:155], v[152:155], a[44:47]
    ds_read_b128 a[16:19], v8 offset:26624
    ds_read_b128 a[20:23], v8 offset:27648
    ds_read_b128 a[24:27], v8 offset:28672
    ds_read_b128 a[28:31], v8 offset:29696
    ds_read_b128 a[32:35], v8 offset:30720
    ds_read_b128 a[36:39], v8 offset:31744
    s_nop 0
    v_accvgpr_read_b32 v204, a40
    v_accvgpr_read_b32 v205, a41
    v_accvgpr_read_b32 v206, a42
    v_accvgpr_read_b32 v207, a43
    v_cndmask_b32 v196, v204, v205, s[32:33]
    v_cndmask_b32 v196, v196, v206, s[34:35]
    v_cndmask_b32 v196, v196, v207, s[46:47]
    v_accvgpr_read_b32 v204, a44
    v_accvgpr_read_b32 v205, a45
    v_accvgpr_read_b32 v206, a46
    v_accvgpr_read_b32 v207, a47
    v_cndmask_b32 v197, v204, v205, s[32:33]
    v_cndmask_b32 v197, v197, v206, s[34:35]
    v_cndmask_b32 v197, v197, v207, s[46:47]
    v_mov_b32 v3, 0x3727c5ac
    v_lshrrev_b32 v10, 2, v1
    v_lshl_add_u32 v10, v10, 4, v1
    v_lshlrev_b32 v10, 2, v10
    v_mul_u32_u24 v4, 80, v2
    v_fma_f32 v196, v196, s36, v3
    v_fma_f32 v197, v197, s36, v3
    v_rsq_f32 v196, v196
    v_rsq_f32 v197, v197
    s_waitcnt lgkmcnt(5)
    v_mfma_f32_16x16x32_bf16 a[0:3], a[16:19], v[12:15], 0
    v_mfma_f32_16x16x32_bf16 a[4:7], a[16:19], v[16:19], 0
    ds_read_b128 a[16:19], v8 offset:32768
    s_waitcnt lgkmcnt(5)
    v_mfma_f32_16x16x32_bf16 a[8:11], a[20:23], v[12:15], 0
    v_mfma_f32_16x16x32_bf16 a[12:15], a[20:23], v[16:19], 0
    ds_read_b128 a[20:23], v8 offset:33792
    ds_bpermute_b32 v12, v4, v196 offset:0
    ds_bpermute_b32 v13, v4, v196 offset:4
    ds_bpermute_b32 v14, v4, v196 offset:8
    ds_bpermute_b32 v15, v4, v196 offset:12
    ds_bpermute_b32 v16, v4, v197 offset:0
    ds_bpermute_b32 v17, v4, v197 offset:4
    ds_bpermute_b32 v18, v4, v197 offset:8
    ds_bpermute_b32 v19, v4, v197 offset:12
    ds_bpermute_b32 v196, v10, v196
    ds_bpermute_b32 v197, v10, v197
    v_lshlrev_b32 v6, 5, v1
    v_lshl_add_u32 v6, v2, 3, v6
    v_add_u32 v6, s52, v6
    s_waitcnt lgkmcnt(15)
    v_mfma_f32_16x16x32_bf16 a[0:3], a[24:27], v[20:23], a[0:3]
    v_add_u32 v7, s53, v5
    v_mov_b32 v3, 0x3f803f80
    s_waitcnt lgkmcnt(1)
    v_fma_f32 v188, v188, v196, v199
    v_fma_f32 v189, v189, v196, v199
    v_fma_f32 v190, v190, v196, v199
    v_fma_f32 v191, v191, v196, v199
    v_mfma_f32_16x16x32_bf16 a[4:7], a[24:27], v[24:27], a[4:7]
    ds_read_b128 a[24:27], v8 offset:34816
    v_mul_f32 v204, s37, v188
    v_mul_f32 v205, s37, v189
    v_mul_f32 v206, s37, v190
    v_mul_f32 v207, s37, v191
    v_exp_f32 v204, v204 clamp
    v_exp_f32 v205, v205 clamp
    v_mfma_f32_16x16x32_bf16 a[8:11], a[28:31], v[20:23], a[8:11]
    v_exp_f32 v206, v206 clamp
    v_exp_f32 v207, v207 clamp
    v_max_f32 v188, v188, v200
    v_max_f32 v189, v189, v200
    v_max_f32 v190, v190, v200
    v_max_f32 v191, v191, v200
    v_mfma_f32_16x16x32_bf16 a[12:15], a[28:31], v[24:27], a[12:15]
    ds_read_b128 a[28:31], v8 offset:35840
    v_fmac_f32 v188, v204, v201
    v_fmac_f32 v189, v205, v201
    v_fmac_f32 v190, v206, v201
    v_fmac_f32 v191, v207, v201
    v_cvt_pk_bf16_f32 v188, v188, v189
    v_cvt_pk_bf16_f32 v189, v190, v191
    v_mfma_f32_16x16x32_bf16 a[0:3], a[32:35], v[28:31], a[0:3]
    v_cndmask_b32 v188, v188, v3, s[68:69]
    v_cndmask_b32 v189, v189, v3, s[68:69]
    ds_write_b64 v6, v[188:189] offset:0
    s_waitcnt lgkmcnt(3)
    v_fma_f32 v192, v192, v197, v199
    v_fma_f32 v193, v193, v197, v199
    v_fma_f32 v194, v194, v197, v199
    v_mfma_f32_16x16x32_bf16 a[4:7], a[32:35], v[32:35], a[4:7]
    ds_read_b128 a[32:35], v8 offset:36864
    v_fma_f32 v195, v195, v197, v199
    v_mul_f32 v204, s37, v192
    v_mul_f32 v205, s37, v193
    v_mul_f32 v206, s37, v194
    v_mul_f32 v207, s37, v195
    v_exp_f32 v204, v204 clamp
    v_mfma_f32_16x16x32_bf16 a[8:11], a[36:39], v[28:31], a[8:11]
    v_exp_f32 v205, v205 clamp
    v_exp_f32 v206, v206 clamp
    v_exp_f32 v207, v207 clamp
    v_max_f32 v192, v192, v200
    v_max_f32 v193, v193, v200
    v_max_f32 v194, v194, v200
    v_mfma_f32_16x16x32_bf16 a[12:15], a[36:39], v[32:35], a[12:15]
    ds_read_b128 a[36:39], v8 offset:37888
    v_max_f32 v195, v195, v200
    v_fmac_f32 v192, v204, v201
    v_fmac_f32 v193, v205, v201
    v_fmac_f32 v194, v206, v201
    v_fmac_f32 v195, v207, v201
    v_cvt_pk_bf16_f32 v190, v192, v193
    v_mfma_f32_16x16x32_bf16 a[0:3], a[16:19], v[36:39], a[0:3]
    v_cvt_pk_bf16_f32 v191, v194, v195
    v_cndmask_b32 v190, v190, v3, s[68:69]
    v_cndmask_b32 v191, v191, v3, s[68:69]
    ds_write_b64 v6, v[190:191] offset:512
    v_mul_f32 v172, v172, v12
    v_mul_f32 v173, v173, v13
    v_mfma_f32_16x16x32_bf16 a[4:7], a[16:19], v[40:43], a[4:7]
    ds_read_b128 a[16:19], v8 offset:38912
    v_mul_f32 v174, v174, v14
    v_mul_f32 v175, v175, v15
    v_cvt_pk_bf16_f32 v172, v172, v173
    v_cvt_pk_bf16_f32 v173, v174, v175
    v_mul_f32 v176, v176, v16
    v_mul_f32 v177, v177, v17
    v_mfma_f32_16x16x32_bf16 a[8:11], a[20:23], v[36:39], a[8:11]
    v_mul_f32 v178, v178, v18
    v_mul_f32 v179, v179, v19
    v_cvt_pk_bf16_f32 v174, v176, v177
    v_cvt_pk_bf16_f32 v175, v178, v179
    ds_write_b128 v7, v[172:175] offset:2048
    v_mul_f32 v180, v180, v12
    v_mfma_f32_16x16x32_bf16 a[12:15], a[20:23], v[40:43], a[12:15]
    ds_read_b128 a[20:23], v8 offset:39936
    v_mul_f32 v181, v181, v13
    v_mul_f32 v182, v182, v14
    v_mul_f32 v183, v183, v15
    v_cvt_pk_bf16_f32 v180, v180, v181
    v_cvt_pk_bf16_f32 v181, v182, v183
    v_mul_f32 v184, v184, v16
    s_waitcnt lgkmcnt(8)
    v_mfma_f32_16x16x32_bf16 a[0:3], a[24:27], v[44:47], a[0:3]
    v_mul_f32 v185, v185, v17
    v_mul_f32 v186, v186, v18
    v_mul_f32 v187, v187, v19
    v_cvt_pk_bf16_f32 v182, v184, v185
    v_cvt_pk_bf16_f32 v183, v186, v187
    ds_write_b128 v7, v[180:183] offset:3072
    v_mfma_f32_16x16x32_bf16 a[4:7], a[24:27], v[48:51], a[4:7]
    ds_read_b128 a[24:27], v8 offset:40960
    v_fma_f32 v156, v156, v12, v198
    v_fma_f32 v157, v157, v13, v198
    v_fma_f32 v158, v158, v14, v198
    v_fma_f32 v159, v159, v15, v198
    v_mul_f32 v204, s37, v156
    v_mul_f32 v205, s37, v157
    s_waitcnt lgkmcnt(9)
    v_mfma_f32_16x16x32_bf16 a[8:11], a[28:31], v[44:47], a[8:11]
    v_mul_f32 v206, s37, v158
    v_mul_f32 v207, s37, v159
    v_exp_f32 v204, v204 clamp
    v_exp_f32 v205, v205 clamp
    v_exp_f32 v206, v206 clamp
    v_exp_f32 v207, v207 clamp
    v_mfma_f32_16x16x32_bf16 a[12:15], a[28:31], v[48:51], a[12:15]
    ds_read_b128 a[28:31], v8 offset:41984
    v_max_f32 v156, v156, v198
    v_max_f32 v157, v157, v198
    v_max_f32 v158, v158, v198
    v_max_f32 v159, v159, v198
    v_add_f32 v156, v156, v204
    v_add_f32 v157, v157, v205
    s_waitcnt lgkmcnt(8)
    v_mfma_f32_16x16x32_bf16 a[0:3], a[32:35], v[52:55], a[0:3]
    v_add_f32 v158, v158, v206
    v_add_f32 v159, v159, v207
    v_cvt_pk_bf16_f32 v156, v156, v157
    v_cvt_pk_bf16_f32 v157, v158, v159
    v_fma_f32 v160, v160, v16, v198
    v_fma_f32 v161, v161, v17, v198
    v_mfma_f32_16x16x32_bf16 a[4:7], a[32:35], v[56:59], a[4:7]
    ds_read_b128 a[32:35], v8 offset:43008
    v_fma_f32 v162, v162, v18, v198
    v_fma_f32 v163, v163, v19, v198
    v_mul_f32 v204, s37, v160
    v_mul_f32 v205, s37, v161
    v_mul_f32 v206, s37, v162
    v_mul_f32 v207, s37, v163
    s_waitcnt lgkmcnt(8)
    v_mfma_f32_16x16x32_bf16 a[8:11], a[36:39], v[52:55], a[8:11]
    v_exp_f32 v204, v204 clamp
    v_exp_f32 v205, v205 clamp
    v_exp_f32 v206, v206 clamp
    v_exp_f32 v207, v207 clamp
    v_max_f32 v160, v160, v198
    v_max_f32 v161, v161, v198
    v_mfma_f32_16x16x32_bf16 a[12:15], a[36:39], v[56:59], a[12:15]
    ds_read_b128 a[36:39], v8 offset:44032
    v_max_f32 v162, v162, v198
    v_max_f32 v163, v163, v198
    v_add_f32 v160, v160, v204
    v_add_f32 v161, v161, v205
    v_add_f32 v162, v162, v206
    v_add_f32 v163, v163, v207
    s_waitcnt lgkmcnt(7)
    v_mfma_f32_16x16x32_bf16 a[0:3], a[16:19], v[60:63], a[0:3]
    v_cvt_pk_bf16_f32 v158, v160, v161
    v_cvt_pk_bf16_f32 v159, v162, v163
    ds_write_b128 v7, v[156:159] offset:0
    v_fma_f32 v164, v164, v12, v198
    v_fma_f32 v165, v165, v13, v198
    v_fma_f32 v166, v166, v14, v198
    v_mfma_f32_16x16x32_bf16 a[4:7], a[16:19], v[64:67], a[4:7]
    ds_read_b128 a[16:19], v8 offset:45056
    v_fma_f32 v167, v167, v15, v198
    v_mul_f32 v204, s37, v164
    v_mul_f32 v205, s37, v165
    v_mul_f32 v206, s37, v166
    v_mul_f32 v207, s37, v167
    v_exp_f32 v204, v204 clamp
    s_waitcnt lgkmcnt(7)
    v_mfma_f32_16x16x32_bf16 a[8:11], a[20:23], v[60:63], a[8:11]
    v_exp_f32 v205, v205 clamp
    v_exp_f32 v206, v206 clamp
    v_exp_f32 v207, v207 clamp
    v_max_f32 v164, v164, v198
    v_max_f32 v165, v165, v198
    v_max_f32 v166, v166, v198
    v_mfma_f32_16x16x32_bf16 a[12:15], a[20:23], v[64:67], a[12:15]
    ds_read_b128 a[20:23], v8 offset:46080
    v_max_f32 v167, v167, v198
    v_add_f32 v164, v164, v204
    v_add_f32 v165, v165, v205
    v_add_f32 v166, v166, v206
    v_add_f32 v167, v167, v207
    v_cvt_pk_bf16_f32 v164, v164, v165
    s_waitcnt lgkmcnt(6)
    v_mfma_f32_16x16x32_bf16 a[0:3], a[24:27], v[68:71], a[0:3]
    v_cvt_pk_bf16_f32 v165, v166, v167
    v_fma_f32 v168, v168, v16, v198
    v_fma_f32 v169, v169, v17, v198
    v_fma_f32 v170, v170, v18, v198
    v_fma_f32 v171, v171, v19, v198
    v_mul_f32 v204, s37, v168
    v_mfma_f32_16x16x32_bf16 a[4:7], a[24:27], v[72:75], a[4:7]
    ds_read_b128 a[24:27], v8 offset:47104
    v_mul_f32 v205, s37, v169
    v_mul_f32 v206, s37, v170
    v_mul_f32 v207, s37, v171
    v_exp_f32 v204, v204 clamp
    v_exp_f32 v205, v205 clamp
    v_exp_f32 v206, v206 clamp
    s_waitcnt lgkmcnt(6)
    v_mfma_f32_16x16x32_bf16 a[8:11], a[28:31], v[68:71], a[8:11]
    v_exp_f32 v207, v207 clamp
    v_max_f32 v168, v168, v198
    v_max_f32 v169, v169, v198
    v_max_f32 v170, v170, v198
    v_max_f32 v171, v171, v198
    v_add_f32 v168, v168, v204
    v_mfma_f32_16x16x32_bf16 a[12:15], a[28:31], v[72:75], a[12:15]
    ds_read_b128 a[28:31], v8 offset:48128
    v_add_f32 v169, v169, v205
    v_add_f32 v170, v170, v206
    v_add_f32 v171, v171, v207
    v_cvt_pk_bf16_f32 v166, v168, v169
    v_cvt_pk_bf16_f32 v167, v170, v171
    ds_write_b128 v7, v[164:167] offset:1024
    s_waitcnt lgkmcnt(7)
    v_mfma_f32_16x16x32_bf16 a[0:3], a[32:35], v[76:79], a[0:3]
    s_waitcnt lgkmcnt(0)
    s_barrier
    v_and_b32 v3, 1, v2
    v_mfma_f32_16x16x32_bf16 a[4:7], a[32:35], v[80:83], a[4:7]
    ds_read_b128 a[32:35], v8 offset:49152
    v_lshrrev_b32 v10, 1, v2
    v_mfma_f32_16x16x32_bf16 a[8:11], a[36:39], v[76:79], a[8:11]
    v_lshlrev_b32 v7, 4, v1
    v_mfma_f32_16x16x32_bf16 a[12:15], a[36:39], v[80:83], a[12:15]
    ds_read_b128 a[36:39], v8 offset:50176
    v_lshl_add_u32 v3, v3, 10, v7
    v_mfma_f32_16x16x32_bf16 a[0:3], a[16:19], v[84:87], a[0:3]
    v_lshl_add_u32 v6, v10, 9, v3
    v_mfma_f32_16x16x32_bf16 a[4:7], a[16:19], v[88:91], a[4:7]
    ds_read_b128 a[16:19], v8 offset:51200
    v_mov_b32 v4, 0x40000000
    v_mfma_f32_16x16x32_bf16 a[8:11], a[20:23], v[84:87], a[8:11]
    v_cmp_eq_u32 vcc, 2, v2
    v_mfma_f32_16x16x32_bf16 a[12:15], a[20:23], v[88:91], a[12:15]
    ds_read_b128 a[20:23], v8 offset:52224
    v_cndmask_b32 v7, v4, v7, vcc
    v_mfma_f32_16x16x32_bf16 a[0:3], a[24:27], v[92:95], a[0:3]
    buffer_store_dwordx2 v[188:189], v7, s[16:19], s50 offen sc1
    buffer_store_dwordx2 v[190:191], v7, s[16:19], s51 offen sc1
    v_mfma_f32_16x16x32_bf16 a[4:7], a[24:27], v[96:99], a[4:7]
    ds_read_b128 a[24:27], v8 offset:53248
    v_mfma_f32_16x16x32_bf16 a[8:11], a[28:31], v[92:95], a[8:11]
    v_mfma_f32_16x16x32_bf16 a[12:15], a[28:31], v[96:99], a[12:15]
    ds_read_b128 a[28:31], v8 offset:54272
    s_waitcnt lgkmcnt(5)
    v_mfma_f32_16x16x32_bf16 a[0:3], a[32:35], v[100:103], a[0:3]
    v_mfma_f32_16x16x32_bf16 a[4:7], a[32:35], v[104:107], a[4:7]
    ds_read_b128 a[32:35], v8 offset:55296
    s_waitcnt lgkmcnt(5)
    v_mfma_f32_16x16x32_bf16 a[8:11], a[36:39], v[100:103], a[8:11]
    v_mfma_f32_16x16x32_bf16 a[12:15], a[36:39], v[104:107], a[12:15]
    ds_read_b128 a[36:39], v8 offset:56320
    s_waitcnt lgkmcnt(5)
    v_mfma_f32_16x16x32_bf16 a[0:3], a[16:19], v[108:111], a[0:3]
    v_mfma_f32_16x16x32_bf16 a[4:7], a[16:19], v[112:115], a[4:7]
    ds_read_b128 a[16:19], v8 offset:57344
    s_waitcnt lgkmcnt(5)
    v_mfma_f32_16x16x32_bf16 a[8:11], a[20:23], v[108:111], a[8:11]
    v_mfma_f32_16x16x32_bf16 a[12:15], a[20:23], v[112:115], a[12:15]
    ds_read_b128 a[20:23], v8 offset:58368
    s_waitcnt lgkmcnt(5)
    v_mfma_f32_16x16x32_bf16 a[0:3], a[24:27], v[116:119], a[0:3]
    v_mfma_f32_16x16x32_bf16 a[4:7], a[24:27], v[120:123], a[4:7]
    ds_read_b128 a[24:27], v8 offset:59392
    s_waitcnt lgkmcnt(5)
    v_mfma_f32_16x16x32_bf16 a[8:11], a[28:31], v[116:119], a[8:11]
    v_mfma_f32_16x16x32_bf16 a[12:15], a[28:31], v[120:123], a[12:15]
    ds_read_b128 a[28:31], v8 offset:60416
    s_waitcnt lgkmcnt(5)
    v_mfma_f32_16x16x32_bf16 a[0:3], a[32:35], v[124:127], a[0:3]
    v_mfma_f32_16x16x32_bf16 a[4:7], a[32:35], v[128:131], a[4:7]
    ds_read_b128 a[32:35], v8 offset:61440
    s_waitcnt lgkmcnt(5)
    v_mfma_f32_16x16x32_bf16 a[8:11], a[36:39], v[124:127], a[8:11]
    v_mfma_f32_16x16x32_bf16 a[12:15], a[36:39], v[128:131], a[12:15]
    ds_read_b128 a[36:39], v8 offset:62464
    s_waitcnt lgkmcnt(5)
    v_mfma_f32_16x16x32_bf16 a[0:3], a[16:19], v[132:135], a[0:3]
    v_mfma_f32_16x16x32_bf16 a[4:7], a[16:19], v[136:139], a[4:7]
    s_waitcnt lgkmcnt(4)
    v_mfma_f32_16x16x32_bf16 a[8:11], a[20:23], v[132:135], a[8:11]
    v_mfma_f32_16x16x32_bf16 a[12:15], a[20:23], v[136:139], a[12:15]
    s_waitcnt lgkmcnt(3)
    v_mfma_f32_16x16x32_bf16 a[0:3], a[24:27], v[140:143], a[0:3]
    v_mfma_f32_16x16x32_bf16 a[4:7], a[24:27], v[144:147], a[4:7]
    s_waitcnt lgkmcnt(2)
    v_mfma_f32_16x16x32_bf16 a[8:11], a[28:31], v[140:143], a[8:11]
    v_mfma_f32_16x16x32_bf16 a[12:15], a[28:31], v[144:147], a[12:15]
    s_waitcnt lgkmcnt(1)
    v_mfma_f32_16x16x32_bf16 a[0:3], a[32:35], v[148:151], a[0:3]
    v_mfma_f32_16x16x32_bf16 a[4:7], a[32:35], v[152:155], a[4:7]
    s_waitcnt lgkmcnt(0)
    v_mfma_f32_16x16x32_bf16 a[8:11], a[36:39], v[148:151], a[8:11]
    v_mfma_f32_16x16x32_bf16 a[12:15], a[36:39], v[152:155], a[12:15]
    s_nop 3
    v_accvgpr_read_b32 v156, a0
    v_accvgpr_read_b32 v157, a1
    v_accvgpr_read_b32 v158, a2
    v_accvgpr_read_b32 v159, a3
    v_fma_f32 v156, v156, v196, v198
    v_fma_f32 v157, v157, v196, v198
    v_fma_f32 v158, v158, v196, v198
    v_fma_f32 v159, v159, v196, v198
    v_mul_f32 v204, s37, v156
    v_mul_f32 v205, s37, v157
    v_mul_f32 v206, s37, v158
    v_mul_f32 v207, s37, v159
    v_exp_f32 v204, v204 clamp
    v_exp_f32 v205, v205 clamp
    v_exp_f32 v206, v206 clamp
    v_exp_f32 v207, v207 clamp
    v_max_f32 v156, v156, v198
    v_max_f32 v157, v157, v198
    v_max_f32 v158, v158, v198
    v_max_f32 v159, v159, v198
    v_add_f32 v156, v156, v204
    v_add_f32 v157, v157, v205
    v_add_f32 v158, v158, v206
    v_add_f32 v159, v159, v207
    v_cvt_pk_bf16_f32 v156, v156, v157
    v_cvt_pk_bf16_f32 v157, v158, v159
    v_accvgpr_read_b32 v160, a8
    v_accvgpr_read_b32 v161, a9
    v_accvgpr_read_b32 v162, a10
    v_accvgpr_read_b32 v163, a11
    v_fma_f32 v160, v160, v196, v198
    v_fma_f32 v161, v161, v196, v198
    v_fma_f32 v162, v162, v196, v198
    v_fma_f32 v163, v163, v196, v198
    v_mul_f32 v204, s37, v160
    v_mul_f32 v205, s37, v161
    v_mul_f32 v206, s37, v162
    v_mul_f32 v207, s37, v163
    v_exp_f32 v204, v204 clamp
    v_exp_f32 v205, v205 clamp
    v_exp_f32 v206, v206 clamp
    v_exp_f32 v207, v207 clamp
    v_max_f32 v160, v160, v198
    v_max_f32 v161, v161, v198
    v_max_f32 v162, v162, v198
    v_max_f32 v163, v163, v198
    v_add_f32 v160, v160, v204
    v_add_f32 v161, v161, v205
    v_add_f32 v162, v162, v206
    v_add_f32 v163, v163, v207
    v_cvt_pk_bf16_f32 v158, v160, v161
    v_cvt_pk_bf16_f32 v159, v162, v163
    s_nop 0
    v_permlane16_swap_b32 v156, v158
    v_permlane16_swap_b32 v157, v159
    buffer_store_dwordx4 v[156:159], v6, s[16:19], s48 offen sc1
    v_accvgpr_read_b32 v164, a4
    v_accvgpr_read_b32 v165, a5
    v_accvgpr_read_b32 v166, a6
    v_accvgpr_read_b32 v167, a7
    v_fma_f32 v164, v164, v197, v198
    v_fma_f32 v165, v165, v197, v198
    v_fma_f32 v166, v166, v197, v198
    v_fma_f32 v167, v167, v197, v198
    v_mul_f32 v204, s37, v164
    v_mul_f32 v205, s37, v165
    v_mul_f32 v206, s37, v166
    v_mul_f32 v207, s37, v167
    v_exp_f32 v204, v204 clamp
    v_exp_f32 v205, v205 clamp
    v_exp_f32 v206, v206 clamp
    v_exp_f32 v207, v207 clamp
    v_max_f32 v164, v164, v198
    v_max_f32 v165, v165, v198
    v_max_f32 v166, v166, v198
    v_max_f32 v167, v167, v198
    v_add_f32 v164, v164, v204
    v_add_f32 v165, v165, v205
    v_add_f32 v166, v166, v206
    v_add_f32 v167, v167, v207
    v_cvt_pk_bf16_f32 v164, v164, v165
    v_cvt_pk_bf16_f32 v165, v166, v167
    v_accvgpr_read_b32 v168, a12
    v_accvgpr_read_b32 v169, a13
    v_accvgpr_read_b32 v170, a14
    v_accvgpr_read_b32 v171, a15
    v_fma_f32 v168, v168, v197, v198
    v_fma_f32 v169, v169, v197, v198
    v_fma_f32 v170, v170, v197, v198
    v_fma_f32 v171, v171, v197, v198
    v_mul_f32 v204, s37, v168
    v_mul_f32 v205, s37, v169
    v_mul_f32 v206, s37, v170
    v_mul_f32 v207, s37, v171
    v_exp_f32 v204, v204 clamp
    v_exp_f32 v205, v205 clamp
    v_exp_f32 v206, v206 clamp
    v_exp_f32 v207, v207 clamp
    v_max_f32 v168, v168, v198
    v_max_f32 v169, v169, v198
    v_max_f32 v170, v170, v198
    v_max_f32 v171, v171, v198
    v_add_f32 v168, v168, v204
    v_add_f32 v169, v169, v205
    v_add_f32 v170, v170, v206
    v_add_f32 v171, v171, v207
    v_cvt_pk_bf16_f32 v166, v168, v169
    v_cvt_pk_bf16_f32 v167, v170, v171
    s_nop 0
    v_permlane16_swap_b32 v164, v166
    v_permlane16_swap_b32 v165, v167
    buffer_store_dwordx4 v[164:167], v6, s[16:19], s49 offen sc1
    s_waitcnt vmcnt(0)
    s_branch L_a3_done
L_a3_help:
    s_add_u32 s32, s4, 0x1330000
    s_addc_u32 s33, s5, 0
    s_mov_b32 s34, 0xb000
    s_mov_b32 s35, 0x20000
    v_mov_b32 v4, 0x40000000
    s_lshl_b32 s29, s30, 10
    s_add_u32 s29, s29, 131072
    v_add_u32 v6, s29, v5
    v_lshlrev_b32 v7, 3, v1
    v_lshl_add_u32 v7, v2, 7, v7
    v_add_u32 v7, 147456, v7
    s_cmp_lt_u32 s24, 2
    s_cselect_b64 s[70:71], -1, 0
    s_cselect_b32 s48, 6, 3
    s_cmp_eq_u32 s30, 1
    s_cselect_b64 s[46:47], -1, 0
    s_lshl_b32 s29, s23, 1
    s_add_u32 s29, s29, s30
    s_mul_i32 s29, s29, 1408
    v_and_b32 v3, 1, v1
    v_lshlrev_b32 v3, 2, v3
    v_add_u32 v3, 1216, v3
    v_lshrrev_b32 v8, 1, v1
    v_cmp_eq_u32 vcc, s30, v8
    s_nop 1
    v_cndmask_b32 v3, v4, v3, vcc
    v_lshlrev_b32 v8, 2, v1
    v_cndmask_b32 v8, v3, v8, s[70:71]
    v_add_u32 v8, s29, v8
    s_lshl_b32 s49, 4, s48
    s_lshl_b32 s50, 8, s48
    s_lshl_b32 s51, 12, s48
    s_lshl_b32 s52, 16, s48
    s_lshl_b32 s53, 17, s48
    s_lshl_b32 s54, 18, s48
    v_lshlrev_b32 v9, s48, v2
    v_add_u32 v9, v9, v8
    v_add_u32 v11, s53, v8
    v_cndmask_b32 v11, v4, v11, s[58:59]
    v_add_u32 v10, s54, v8
    v_cndmask_b32 v10, v4, v10, s[68:69]
    v_add_u32 v3, s52, v8
    v_cndmask_b32 v10, v10, v3, s[58:59]
    v_mov_b32 v1, v9
    v_mov_b32 v2, v10
    v_mov_b32 v5, v11
    s_waitcnt vmcnt(0)
    s_barrier
    s_lshr_b32 s3, s2, 5
    s_mul_i32 s3, s3, 110592
    s_add_u32 s40, s4, 0x11c0000
    s_addc_u32 s41, s5, 0
    s_add_u32 s40, s40, s3
    s_addc_u32 s41, s41, 0
    s_mov_b32 s42, 0x1b000
    s_mov_b32 s43, 0x20000
    s_setprio 3
    s_barrier
    ds_read_b128 v[8:11], v6 offset:0
    ds_read_b128 v[24:27], v6 offset:2048
    ds_read_b64_tr_b16 v[40:41], v7 offset:0
    ds_read_b64_tr_b16 v[42:43], v7 offset:512
    ds_read_b128 v[12:15], v6 offset:4096
    ds_read_b128 v[28:31], v6 offset:6144
    ds_read_b64_tr_b16 v[44:45], v7 offset:1024
    ds_read_b64_tr_b16 v[46:47], v7 offset:1536
    ds_read_b128 v[16:19], v6 offset:8192
    ds_read_b128 v[32:35], v6 offset:10240
    ds_read_b64_tr_b16 v[48:49], v7 offset:2048
    ds_read_b64_tr_b16 v[50:51], v7 offset:2560
    ds_read_b128 v[20:23], v6 offset:12288
    ds_read_b128 v[36:39], v6 offset:14336
    ds_read_b64_tr_b16 v[52:53], v7 offset:3072
    ds_read_b64_tr_b16 v[54:55], v7 offset:3584
    s_waitcnt lgkmcnt(13)
    v_cndmask_b32 v8, v40, v8, s[70:71]
    v_cndmask_b32 v9, v41, v9, s[70:71]
    s_waitcnt lgkmcnt(12)
    v_cndmask_b32 v10, v42, v10, s[70:71]
    v_cndmask_b32 v11, v43, v11, s[70:71]
    s_nop 1
    v_mfma_f32_16x16x32_bf16 v[56:59], v[24:27], v[8:11], 0
    v_mfma_f32_16x16x32_bf16 v[60:63], v[40:43], v[8:11], 0
    s_waitcnt lgkmcnt(9)
    v_cndmask_b32 v12, v44, v12, s[70:71]
    v_cndmask_b32 v13, v45, v13, s[70:71]
    s_waitcnt lgkmcnt(8)
    v_cndmask_b32 v14, v46, v14, s[70:71]
    v_cndmask_b32 v15, v47, v15, s[70:71]
    s_nop 1
    v_mfma_f32_16x16x32_bf16 v[56:59], v[28:31], v[12:15], v[56:59]
    v_mfma_f32_16x16x32_bf16 v[60:63], v[44:47], v[12:15], v[60:63]
    s_waitcnt lgkmcnt(5)
    v_cndmask_b32 v16, v48, v16, s[70:71]
    v_cndmask_b32 v17, v49, v17, s[70:71]
    s_waitcnt lgkmcnt(4)
    v_cndmask_b32 v18, v50, v18, s[70:71]
    v_cndmask_b32 v19, v51, v19, s[70:71]
    s_nop 1
    v_mfma_f32_16x16x32_bf16 v[56:59], v[32:35], v[16:19], v[56:59]
    v_mfma_f32_16x16x32_bf16 v[60:63], v[48:51], v[16:19], v[60:63]
    s_waitcnt lgkmcnt(1)
    v_cndmask_b32 v20, v52, v20, s[70:71]
    v_cndmask_b32 v21, v53, v21, s[70:71]
    s_waitcnt lgkmcnt(0)
    v_cndmask_b32 v22, v54, v22, s[70:71]
    v_cndmask_b32 v23, v55, v23, s[70:71]
    s_nop 1
    v_mfma_f32_16x16x32_bf16 v[56:59], v[36:39], v[20:23], v[56:59]
    v_mfma_f32_16x16x32_bf16 v[60:63], v[52:55], v[20:23], v[60:63]
    s_nop 6
    buffer_atomic_add_f32 v56, v1, s[32:35], 0 offen
    buffer_atomic_add_f32 v57, v1, s[32:35], s49 offen
    buffer_atomic_add_f32 v58, v1, s[32:35], s50 offen
    buffer_atomic_add_f32 v59, v1, s[32:35], s51 offen
    v_cndmask_b32 v60, v60, v62, s[46:47]
    v_cndmask_b32 v61, v61, v63, s[46:47]
    buffer_atomic_add_f32 v60, v2, s[32:35], 0 offen
    buffer_atomic_add_f32 v61, v5, s[32:35], 0 offen
    s_setprio 0
    s_waitcnt vmcnt(0)
L_a3_done:
    s_lshl_b32 s3, s2, 7
    s_add_u32 s3, s3, 0x10000
    v_mov_b32 v1, s3
    v_mov_b32 v2, s64
    v_mov_b32 v3, s65
    s_cmp_lg_u32 s56, 0
    s_barrier
    s_cbranch_scc1 L_sig2_3375
    s_mov_b64 exec, 1
    buffer_store_dwordx2 v[2:3], v1, s[60:63], 0 offen sc1
    s_mov_b64 exec, -1
L_sig2_3375:
    s_cmp_ge_u32 s2, 192
    s_cbranch_scc1 L_a4_skip
    v_and_b32 v7, 63, v0
    v_lshlrev_b32 v7, 4, v7
    s_lshr_b32 s3, s2, 5
    s_mul_i32 s3, s3, 110592
    s_add_u32 s40, s4, 0x11c0000
    s_addc_u32 s41, s5, 0
    s_add_u32 s40, s40, s3
    s_addc_u32 s41, s41, 0
    s_mov_b32 s42, 0x1b000
    s_mov_b32 s43, 0x20000
    s_sub_u32 s44, s56, 0
    s_cmp_ge_u32 s44, 6
    s_cbranch_scc1 L_a4w_nd
    s_mul_i32 s44, s56, 18432
    s_mov_b32 m0, s44
    s_nop 0
    buffer_load_dwordx4 v7, s[40:43], s44 offen offset:0 sc1 lds
    buffer_load_dwordx4 v7, s[40:43], s44 offen offset:1024 sc1 lds
    buffer_load_dwordx4 v7, s[40:43], s44 offen offset:2048 sc1 lds
    buffer_load_dwordx4 v7, s[40:43], s44 offen offset:3072 sc1 lds
    s_add_u32 s44, s44, 0x1000
    s_mov_b32 m0, s44
    s_nop 0
    buffer_load_dwordx4 v7, s[40:43], s44 offen offset:0 sc1 lds
    buffer_load_dwordx4 v7, s[40:43], s44 offen offset:1024 sc1 lds
    buffer_load_dwordx4 v7, s[40:43], s44 offen offset:2048 sc1 lds
    buffer_load_dwordx4 v7, s[40:43], s44 offen offset:3072 sc1 lds
    s_add_u32 s44, s44, 0x1000
    s_mov_b32 m0, s44
    s_nop 0
    buffer_load_dwordx4 v7, s[40:43], s44 offen offset:0 sc1 lds
    buffer_load_dwordx4 v7, s[40:43], s44 offen offset:1024 sc1 lds
    buffer_load_dwordx4 v7, s[40:43], s44 offen offset:2048 sc1 lds
    buffer_load_dwordx4 v7, s[40:43], s44 offen offset:3072 sc1 lds
    s_add_u32 s44, s44, 0x1000
    s_mov_b32 m0, s44
    s_nop 0
    buffer_load_dwordx4 v7, s[40:43], s44 offen offset:0 sc1 lds
    buffer_load_dwordx4 v7, s[40:43], s44 offen offset:1024 sc1 lds
    buffer_load_dwordx4 v7, s[40:43], s44 offen offset:2048 sc1 lds
    buffer_load_dwordx4 v7, s[40:43], s44 offen offset:3072 sc1 lds
    s_add_u32 s44, s44, 0x1000
    s_mov_b32 m0, s44
    s_nop 0
    buffer_load_dwordx4 v7, s[40:43], s44 offen offset:0 sc1 lds
    buffer_load_dwordx4 v7, s[40:43], s44 offen offset:1024 sc1 lds
L_a4w_nd:
    s_and_b32 s20, s2, 7
    s_lshr_b32 s21, s2, 3
    s_and_b32 s22, s21, 3
    s_lshl_b32 s20, s20, 2
    s_add_u32 s22, s22, s20
    s_lshr_b32 s23, s21, 2
    v_and_b32 v1, 31, v0
    v_bfe_u32 v2, v0, 5, 1
    v_and_b32 v6, 63, v0
    v_lshlrev_b32 v7, 4, v6
    s_and_b32 s24, s56, 3
    s_lshr_b32 s57, s56, 2
    s_add_u32 s8, s4, 0x240000
    s_addc_u32 s9, s5, 0
    s_mov_b32 s10, 0x240000
    s_mov_b32 s11, 0x20000
    s_add_u32 s32, s4, 0x480000
    s_addc_u32 s33, s5, 0
    s_mov_b32 s34, 0x240000
    s_mov_b32 s35, 0x20000
    s_mul_i32 s50, s23, 24
    s_add_u32 s50, s50, s56
    s_lshl_b32 s50, s50, 14
    s_lshl_b32 s51, s22, 9
    s_add_u32 s50, s50, s51
    s_add_u32 s51, s50, 0x20000
    s_add_u32 s52, s50, 0x40000
    v_lshlrev_b32 v16, 3, v6
    v_mul_u32_u24 v8, 1408, v2
    v_lshl_add_u32 v8, v1, 4, v8
    v_mov_b32 v4, 0x40000000
    v_cmp_gt_u32 vcc, 22, v1
    s_nop 1
    v_cndmask_b32 v8, v4, v8, vcc
    s_mul_i32 s25, s56, 5632
    s_lshl_b32 s26, s22, 1
    s_add_u32 s26, s26, s57
    s_mul_i32 s26, s26, 36
    s_mul_i32 s27, s24, 9
    s_add_u32 s26, s26, s27
    s_lshl_b32 s26, s26, 10
    s_add_u32 s16, s4, 0x1330000
    s_addc_u32 s17, s5, 0
    s_mov_b32 s18, 0x16000
    s_mov_b32 s19, 0x20000
    s_add_u32 s12, s4, 0x900000
    s_addc_u32 s13, s5, 0
    s_add_u32 s12, s12, s26
    s_addc_u32 s13, s13, 0
    s_mov_b32 s14, 0x2400
    s_mov_b32 s15, 0x20000
    s_add_u32 s28, s25, 2816
    s_add_u32 s29, s25, 45056
    s_add_u32 s30, s29, 2816
    s_movk_i32 s31, 0x1000
    s_movk_i32 s27, 0x2000
    s_lshl_b32 s53, s56, 12
    s_add_u32 s53, s53, 114688
    v_lshrrev_b32 v115, 2, v6
    v_and_b32 v3, 3, v115
    v_lshrrev_b32 v112, 2, v115
    v_lshl_add_u32 v112, v3, 2, v112
    v_cmp_gt_u32 vcc, 16, v115
    s_nop 1
    v_cndmask_b32 v112, v115, v112, vcc
    v_cmp_lt_u32 vcc, 8, v112
    v_subrev_u32 v113, 9, v112
    s_nop 0
    v_cndmask_b32 v113, v112, v113, vcc
    v_cndmask_b32 v3, 0, 4, vcc
    v_and_b32 v5, 3, v113
    v_lshrrev_b32 v113, 2, v113
    v_lshl_add_u32 v5, v113, 3, v5
    v_add_u32 v114, v5, v3
    v_bfe_u32 v3, v6, 1, 1
    v_and_b32 v4, 1, v6
    v_lshlrev_b32 v116, 9, v3
    v_lshl_add_u32 v116, v4, 3, v116
    v_add_u32 v116, s53, v116
    v_lshl_add_u32 v9, v114, 4, v116
    v_cmp_gt_u32 s[48:49], 12, v1
    v_lshrrev_b32 v3, 2, v1
    v_add_u32 v3, 16, v3
    v_lshlrev_b32 v4, 1, v1
    v_subrev_u32 v4, 24, v4
    v_cndmask_b32 v115, v4, v3, s[48:49]
    v_and_b32 v3, 3, v115
    v_lshrrev_b32 v112, 2, v115
    v_lshl_add_u32 v112, v3, 2, v112
    v_cmp_gt_u32 vcc, 16, v115
    s_nop 1
    v_cndmask_b32 v112, v115, v112, vcc
    v_cmp_lt_u32 vcc, 8, v112
    v_subrev_u32 v113, 9, v112
    s_nop 0
    v_cndmask_b32 v113, v112, v113, vcc
    v_cndmask_b32 v3, 0, 4, vcc
    v_and_b32 v5, 3, v113
    v_lshrrev_b32 v113, 2, v113
    v_lshl_add_u32 v5, v113, 3, v5
    v_add_u32 v117, v5, v3
    v_cmp_eq_u32 vcc, 18, v112
    s_nop 1
    v_cndmask_b32 v118, v117, v5, vcc
    v_add_u32 v115, 1, v115
    v_and_b32 v3, 3, v115
    v_lshrrev_b32 v112, 2, v115
    v_lshl_add_u32 v112, v3, 2, v112
    v_cmp_gt_u32 vcc, 16, v115
    s_nop 1
    v_cndmask_b32 v112, v115, v112, vcc
    v_cmp_lt_u32 vcc, 8, v112
    v_subrev_u32 v113, 9, v112
    s_nop 0
    v_cndmask_b32 v113, v112, v113, vcc
    v_cndmask_b32 v3, 0, 4, vcc
    v_and_b32 v5, 3, v113
    v_lshrrev_b32 v113, 2, v113
    v_lshl_add_u32 v5, v113, 3, v5
    v_add_u32 v119, v5, v3
    v_lshl_add_u32 v116, v2, 10, v116
    s_lshl_b32 s53, s56, 9
    s_add_u32 s53, s53, 147456
    v_lshlrev_b32 v120, 7, v2
    v_add_u32 v120, s53, v120
    v_lshl_add_u32 v3, v117, 4, v116
    v_lshl_add_u32 v4, v117, 2, v120
    v_cndmask_b32 v10, v4, v3, s[48:49]
    v_lshl_add_u32 v3, v118, 4, v116
    v_lshl_add_u32 v4, v118, 2, v120
    v_cndmask_b32 v12, v4, v3, s[48:49]
    v_lshl_add_u32 v4, v119, 2, v120
    v_add_u32 v3, 4, v10
    v_cndmask_b32 v11, v4, v3, s[48:49]
    v_add_u32 v3, 4, v12
    v_cndmask_b32 v13, v4, v3, s[48:49]
    v_mov_b32 v3, 151552
    v_cmp_lt_u32 vcc, 21, v1
    s_nop 1
    v_cndmask_b32 v10, v10, v3, vcc
    v_cndmask_b32 v12, v12, v3, vcc
    v_cmp_lt_u32 vcc, 20, v1
    s_nop 1
    v_cndmask_b32 v11, v11, v3, vcc
    v_cndmask_b32 v13, v13, v3, vcc
    v_mov_b32 v3, 0x800
    v_mov_b32 v4, 0x100
    v_cndmask_b32 v14, v4, v3, s[48:49]
    v_lshlrev_b32 v3, 2, v0
    v_add_u32 v15, 152064, v3
    v_and_b32 v3, 1, v6
    v_lshrrev_b32 v4, 1, v1
    v_lshl_add_u32 v3, v3, 4, v4
    v_lshl_add_u32 v3, v2, 5, v3
    v_mul_u32_u24 v18, 144, v3
    s_lshl_b32 s53, s56, 4
    v_add_u32 v18, s53, v18
    s_add_u32 s53, s23, s56
    s_cmp_eq_u32 s53, 0
    s_cselect_b32 s54, 0, 1.0
    s_add_u32 s36, s4, 0x132e000
    s_addc_u32 s37, s5, 0
    s_mov_b32 s38, 0x2000
    s_mov_b32 s39, 0x20000
    s_mul_i32 s53, s24, 9216
    s_mul_i32 s55, s57, 4608
    s_add_u32 s53, s53, s55
    v_mul_u32_u24 v17, 144, v1
    v_lshl_add_u32 v17, v2, 4, v17
    v_add_u32 v17, s53, v17
    s_mul_i32 s53, s24, 9216
    v_add_u32 v19, s53, v7
    v_add_u32 v20, 73728, v19
    v_mov_b32 v72, 0
    v_mov_b32 v78, 0
    v_mov_b32 v73, 0
    v_mov_b32 v79, 0
    v_mov_b32 v74, 0
    v_mov_b32 v80, 0
    v_mov_b32 v75, 0
    v_mov_b32 v81, 0
    v_mov_b32 v76, 0
    v_mov_b32 v82, 0
    v_mov_b32 v77, 0
    v_mov_b32 v83, 0
    s_lshl_b32 s53, s24, 13
    s_add_u32 s53, s53, 114688
    v_add_u32 v84, s53, v7
    s_lshl_b32 s53, s24, 10
    s_add_u32 s53, s53, 147456
    v_lshlrev_b32 v85, 2, v1
    v_add_u32 v85, s53, v85
    v_mov_b32 v86, 0x358637bd
    v_subrev_u32 v32, 1, v2
    v_not_b32 v33, v32
    s_cmp_ge_u32 s56, 4
    s_cbranch_scc1 L_wait2_3609_d
    v_min_u32 v88, 255, v0
    v_lshlrev_b32 v88, 7, v88
    v_add_u32 v88, 0x10000, v88
    s_mov_b32 s3, 0
L_wait2_3609_p:
    buffer_load_dwordx2 v[92:93], v88, s[60:63], 0 offen sc1
    s_waitcnt vmcnt(0)
    v_cmp_ne_u64 vcc, s[64:65], v[92:93]
    s_nop 0
    s_mov_b64 exec, vcc
    s_add_u32 s3, s3, 1
    s_cmp_gt_u32 s3, 0x30d40
    s_cbranch_scc1 L_wait2_3609_x
    s_cmp_eq_u64 vcc, 0
    s_cbranch_scc1 L_wait2_3609_x
    s_sleep 1
    s_branch L_wait2_3609_p
L_wait2_3609_x:
    s_mov_b64 exec, -1
L_wait2_3609_d:
    s_barrier
    buffer_load_dwordx4 v[88:91], v7, s[16:19], s25 offen offset:0 sc1
    buffer_load_dwordx4 v[92:95], v7, s[16:19], s25 offen offset:1408 sc1
    buffer_load_dwordx4 v[96:99], v7, s[16:19], s28 offen offset:0 sc1
    buffer_load_dwordx4 v[100:103], v7, s[16:19], s28 offen offset:1408 sc1
    buffer_load_dwordx4 v[104:107], v8, s[16:19], s25 offen offset:1024 sc1
    buffer_load_dwordx4 v[108:111], v8, s[16:19], s28 offen offset:1024 sc1
    s_barrier
    buffer_load_dwordx4 v[200:203], v7, s[12:15], s27 offen offset:0 sc1
    buffer_load_dwordx4 v[168:171], v7, s[12:15], 0 offen offset:0 sc1
    buffer_load_dwordx4 v[172:175], v7, s[12:15], 0 offen offset:1024 sc1
    buffer_load_dwordx4 v[176:179], v7, s[12:15], 0 offen offset:2048 sc1
    buffer_load_dwordx4 v[180:183], v7, s[12:15], 0 offen offset:3072 sc1
    s_waitcnt vmcnt(10)
    v_cvt_pk_bf16_f32 v88, v88, v89
    v_cvt_pk_bf16_f32 v89, v90, v91
    ds_write_b64 v9, v[88:89] offset:0
    s_waitcnt vmcnt(9)
    v_cvt_pk_bf16_f32 v92, v92, v93
    v_cvt_pk_bf16_f32 v93, v94, v95
    ds_write_b64 v9, v[92:93] offset:1024
    s_waitcnt vmcnt(8)
    v_cvt_pk_bf16_f32 v96, v96, v97
    v_cvt_pk_bf16_f32 v97, v98, v99
    ds_write_b64 v9, v[96:97] offset:2048
    s_waitcnt vmcnt(7)
    v_cvt_pk_bf16_f32 v100, v100, v101
    v_cvt_pk_bf16_f32 v101, v102, v103
    ds_write_b64 v9, v[100:101] offset:3072
    s_waitcnt vmcnt(6)
    v_cvt_pk_bf16_f32 v104, v104, v105
    v_cvt_pk_bf16_f32 v105, v106, v107
    ds_write_b32 v10, v104
    ds_write_b32 v12, v104
    ds_write_b32 v11, v105
    ds_write_b32 v13, v105
    v_add_u32 v10, v10, v14
    v_add_u32 v12, v12, v14
    v_add_u32 v11, v11, v14
    v_add_u32 v13, v13, v14
    s_waitcnt vmcnt(5)
    v_cvt_pk_bf16_f32 v108, v108, v109
    v_cvt_pk_bf16_f32 v109, v110, v111
    ds_write_b32 v10, v108
    ds_write_b32 v12, v108
    ds_write_b32 v11, v109
    ds_write_b32 v13, v109
    s_waitcnt lgkmcnt(0)
    s_barrier
    ds_read_b128 v[88:91], v84 offset:0
    ds_read_b32 v120, v85 offset:0
    ds_read_b128 v[92:95], v84 offset:1024
    ds_read_b32 v121, v85 offset:128
    ds_read_b128 v[96:99], v84 offset:2048
    ds_read_b32 v122, v85 offset:256
    ds_read_b128 v[100:103], v84 offset:3072
    ds_read_b32 v123, v85 offset:384
    ds_read_b128 v[104:107], v84 offset:4096
    ds_read_b32 v124, v85 offset:512
    ds_read_b128 v[108:111], v84 offset:5120
    ds_read_b32 v125, v85 offset:640
    ds_read_b128 v[112:115], v84 offset:6144
    ds_read_b32 v126, v85 offset:768
    ds_read_b128 v[116:119], v84 offset:7168
    ds_read_b32 v127, v85 offset:896
    ds_read_b128 v[128:131], v19 offset:8192
    ds_read_b128 v[132:135], v19 offset:45056
    buffer_load_dwordx4 v[184:187], v7, s[12:15], s31 offen offset:0 sc1
    buffer_load_dwordx4 v[188:191], v7, s[12:15], s31 offen offset:1024 sc1
    s_waitcnt lgkmcnt(15)
    v_and_b32 v74, v32, v120
    s_waitcnt vmcnt(5)
    v_mfma_f32_32x32x16_bf16 v[136:151], v[88:91], v[168:171], 0
    v_mfma_f32_32x32x16_bf16 v[136:151], v[74:77], v[200:203], v[136:151]
    ds_read_b128 v[88:91], v19 offset:0
    ds_read_b128 v[168:171], v19 offset:36864
    buffer_load_dwordx4 v[192:195], v7, s[12:15], s31 offen offset:2048 sc1
    buffer_load_dwordx4 v[196:199], v7, s[12:15], s31 offen offset:3072 sc1
    s_waitcnt lgkmcnt(15)
    v_and_b32 v81, v32, v121
    s_waitcnt vmcnt(6)
    v_mfma_f32_32x32x16_bf16 v[152:167], v[92:95], v[172:175], 0
    v_mfma_f32_32x32x16_bf16 v[152:167], v[80:83], v[200:203], v[152:167]
    ds_read_b128 v[92:95], v19 offset:1024
    ds_read_b128 v[172:175], v19 offset:37888
    buffer_load_dwordx2 v[24:25], v16, s[8:11], s50 offen sc1
    buffer_load_dwordx2 v[26:27], v16, s[8:11], s51 offen sc1
    v_add_f32 v145, v145, v86
    v_rcp_f32 v145, v145
    s_nop 0
    v_mul_f32 v136, v136, v145
    v_mul_f32 v137, v137, v145
    v_mul_f32 v138, v138, v145
    v_mul_f32 v139, v139, v145
    v_mul_f32 v140, v140, v145
    v_mul_f32 v141, v141, v145
    v_mul_f32 v142, v142, v145
    v_mul_f32 v143, v143, v145
    v_mul_f32 v87, v144, v145
    v_cvt_pk_bf16_f32 v36, v136, v137
    v_cvt_pk_bf16_f32 v37, v138, v139
    v_cvt_pk_bf16_f32 v38, v140, v141
    v_cvt_pk_bf16_f32 v39, v142, v143
    s_waitcnt lgkmcnt(15)
    v_and_b32 v74, v32, v122
    s_waitcnt vmcnt(7)
    v_mfma_f32_32x32x16_bf16 v[136:151], v[96:99], v[176:179], 0
    v_mfma_f32_32x32x16_bf16 v[136:151], v[72:75], v[200:203], v[136:151]
    ds_read_b128 v[96:99], v19 offset:2048
    ds_read_b128 v[176:179], v19 offset:38912
    buffer_load_dwordx2 v[28:29], v16, s[8:11], s52 offen sc1
    s_waitcnt lgkmcnt(5)
    v_mfma_f32_32x32x16_bf16 a[0:15], v[88:91], v[36:39], 0
    ds_read_b128 v[88:91], v20 offset:0
    v_add_f32 v161, v161, v86
    v_rcp_f32 v161, v161
    s_nop 0
    v_mul_f32 v152, v152, v161
    v_mul_f32 v153, v153, v161
    v_mul_f32 v154, v154, v161
    v_mul_f32 v155, v155, v161
    v_mul_f32 v156, v156, v161
    v_mul_f32 v157, v157, v161
    v_mul_f32 v158, v158, v161
    v_mul_f32 v159, v159, v161
    v_mul_f32 v160, v160, v161
    v_cvt_pk_bf16_f32 v40, v87, v152
    v_cvt_pk_bf16_f32 v41, v153, v154
    v_cvt_pk_bf16_f32 v42, v155, v156
    v_cvt_pk_bf16_f32 v43, v157, v158
    v_cvt_pk_bf16_f32 v44, v159, v160
    v_and_b32 v81, v32, v123
    s_waitcnt vmcnt(7)
    v_mfma_f32_32x32x16_bf16 v[152:167], v[100:103], v[180:183], 0
    v_mfma_f32_32x32x16_bf16 v[152:167], v[78:81], v[200:203], v[152:167]
    ds_read_b128 v[100:103], v19 offset:3072
    ds_read_b128 v[180:183], v19 offset:39936
    s_waitcnt lgkmcnt(6)
    v_mfma_f32_32x32x16_bf16 a[0:15], v[92:95], v[40:43], a[0:15]
    ds_read_b128 v[92:95], v20 offset:1024
    v_add_f32 v145, v145, v86
    v_rcp_f32 v145, v145
    s_nop 0
    v_mul_f32 v136, v136, v145
    v_mul_f32 v137, v137, v145
    v_mul_f32 v138, v138, v145
    v_mul_f32 v139, v139, v145
    v_mul_f32 v140, v140, v145
    v_mul_f32 v141, v141, v145
    v_mul_f32 v142, v142, v145
    v_mul_f32 v143, v143, v145
    v_mul_f32 v87, v144, v145
    v_cvt_pk_bf16_f32 v45, v136, v137
    v_cvt_pk_bf16_f32 v46, v138, v139
    v_cvt_pk_bf16_f32 v47, v140, v141
    v_cvt_pk_bf16_f32 v48, v142, v143
    v_and_b32 v74, v33, v124
    s_waitcnt vmcnt(6)
    v_mfma_f32_32x32x16_bf16 v[136:151], v[104:107], v[184:187], 0
    v_mfma_f32_32x32x16_bf16 v[136:151], v[74:77], v[200:203], v[136:151]
    ds_read_b128 v[104:107], v19 offset:4096
    ds_read_b128 v[184:187], v19 offset:40960
    s_waitcnt lgkmcnt(7)
    v_mfma_f32_32x32x16_bf16 a[0:15], v[96:99], v[44:47], a[0:15]
    ds_read_b128 v[96:99], v20 offset:2048
    v_add_f32 v161, v161, v86
    v_rcp_f32 v161, v161
    s_nop 0
    v_mul_f32 v152, v152, v161
    v_mul_f32 v153, v153, v161
    v_mul_f32 v154, v154, v161
    v_mul_f32 v155, v155, v161
    v_mul_f32 v156, v156, v161
    v_mul_f32 v157, v157, v161
    v_mul_f32 v158, v158, v161
    v_mul_f32 v159, v159, v161
    v_mul_f32 v160, v160, v161
    v_cvt_pk_bf16_f32 v49, v87, v152
    v_cvt_pk_bf16_f32 v50, v153, v154
    v_cvt_pk_bf16_f32 v51, v155, v156
    v_cvt_pk_bf16_f32 v52, v157, v158
    v_cvt_pk_bf16_f32 v53, v159, v160
    v_and_b32 v81, v33, v125
    s_waitcnt vmcnt(5)
    v_mfma_f32_32x32x16_bf16 v[152:167], v[108:111], v[188:191], 0
    v_mfma_f32_32x32x16_bf16 v[152:167], v[80:83], v[200:203], v[152:167]
    ds_read_b128 v[108:111], v19 offset:5120
    ds_read_b128 v[188:191], v19 offset:41984
    s_waitcnt lgkmcnt(7)
    v_mfma_f32_32x32x16_bf16 a[0:15], v[100:103], v[48:51], a[0:15]
    ds_read_b128 v[100:103], v20 offset:3072
    v_add_f32 v145, v145, v86
    v_rcp_f32 v145, v145
    s_nop 0
    v_mul_f32 v136, v136, v145
    v_mul_f32 v137, v137, v145
    v_mul_f32 v138, v138, v145
    v_mul_f32 v139, v139, v145
    v_mul_f32 v140, v140, v145
    v_mul_f32 v141, v141, v145
    v_mul_f32 v142, v142, v145
    v_mul_f32 v143, v143, v145
    v_mul_f32 v87, v144, v145
    v_cvt_pk_bf16_f32 v54, v136, v137
    v_cvt_pk_bf16_f32 v55, v138, v139
    v_cvt_pk_bf16_f32 v56, v140, v141
    v_cvt_pk_bf16_f32 v57, v142, v143
    v_and_b32 v74, v33, v126
    s_waitcnt vmcnt(4)
    v_mfma_f32_32x32x16_bf16 v[136:151], v[112:115], v[192:195], 0
    v_mfma_f32_32x32x16_bf16 v[136:151], v[72:75], v[200:203], v[136:151]
    ds_read_b128 v[112:115], v19 offset:6144
    ds_read_b128 v[192:195], v19 offset:43008
    s_waitcnt lgkmcnt(7)
    v_mfma_f32_32x32x16_bf16 a[0:15], v[104:107], v[52:55], a[0:15]
    ds_read_b128 v[104:107], v20 offset:4096
    v_add_f32 v161, v161, v86
    v_rcp_f32 v161, v161
    s_nop 0
    v_mul_f32 v152, v152, v161
    v_mul_f32 v153, v153, v161
    v_mul_f32 v154, v154, v161
    v_mul_f32 v155, v155, v161
    v_mul_f32 v156, v156, v161
    v_mul_f32 v157, v157, v161
    v_mul_f32 v158, v158, v161
    v_mul_f32 v159, v159, v161
    v_mul_f32 v160, v160, v161
    v_cvt_pk_bf16_f32 v58, v87, v152
    v_cvt_pk_bf16_f32 v59, v153, v154
    v_cvt_pk_bf16_f32 v60, v155, v156
    v_cvt_pk_bf16_f32 v61, v157, v158
    v_cvt_pk_bf16_f32 v62, v159, v160
    v_and_b32 v81, v33, v127
    s_waitcnt vmcnt(3)
    v_mfma_f32_32x32x16_bf16 v[152:167], v[116:119], v[196:199], 0
    v_mfma_f32_32x32x16_bf16 v[152:167], v[78:81], v[200:203], v[152:167]
    ds_read_b128 v[116:119], v19 offset:7168
    ds_read_b128 v[196:199], v19 offset:44032
    s_waitcnt lgkmcnt(7)
    v_mfma_f32_32x32x16_bf16 a[0:15], v[108:111], v[56:59], a[0:15]
    ds_read_b128 v[108:111], v20 offset:5120
    v_add_f32 v145, v145, v86
    v_rcp_f32 v145, v145
    s_nop 0
    v_mul_f32 v136, v136, v145
    v_mul_f32 v137, v137, v145
    v_mul_f32 v138, v138, v145
    v_mul_f32 v139, v139, v145
    v_mul_f32 v140, v140, v145
    v_mul_f32 v141, v141, v145
    v_mul_f32 v142, v142, v145
    v_mul_f32 v143, v143, v145
    v_mul_f32 v87, v144, v145
    v_cvt_pk_bf16_f32 v63, v136, v137
    v_cvt_pk_bf16_f32 v64, v138, v139
    v_cvt_pk_bf16_f32 v65, v140, v141
    v_cvt_pk_bf16_f32 v66, v142, v143
    ds_read_b128 v[200:203], v20 offset:8192
    s_waitcnt lgkmcnt(6)
    v_mfma_f32_32x32x16_bf16 a[0:15], v[112:115], v[60:63], a[0:15]
    ds_read_b128 v[112:115], v20 offset:6144
    v_mfma_f32_32x32x16_bf16 a[16:31], v[168:171], v[36:39], 0
    v_add_f32 v161, v161, v86
    v_rcp_f32 v161, v161
    s_nop 0
    v_mul_f32 v152, v152, v161
    v_mul_f32 v153, v153, v161
    v_mul_f32 v154, v154, v161
    v_mul_f32 v155, v155, v161
    v_mfma_f32_32x32x16_bf16 a[16:31], v[172:175], v[40:43], a[16:31]
    v_mul_f32 v156, v156, v161
    v_mul_f32 v157, v157, v161
    v_mul_f32 v158, v158, v161
    v_mul_f32 v159, v159, v161
    v_mul_f32 v160, v160, v161
    v_cvt_pk_bf16_f32 v67, v87, v152
    v_mfma_f32_32x32x16_bf16 a[16:31], v[176:179], v[44:47], a[16:31]
    v_cvt_pk_bf16_f32 v68, v153, v154
    v_cvt_pk_bf16_f32 v69, v155, v156
    v_cvt_pk_bf16_f32 v70, v157, v158
    v_cvt_pk_bf16_f32 v71, v159, v160
    s_waitcnt lgkmcnt(4)
    v_mfma_f32_32x32x16_bf16 a[0:15], v[116:119], v[64:67], a[0:15]
    ds_read_b128 v[116:119], v20 offset:7168
    v_mfma_f32_32x32x16_bf16 a[0:15], v[128:131], v[68:71], a[0:15]
    v_mfma_f32_32x32x16_bf16 a[16:31], v[180:183], v[48:51], a[16:31]
    s_waitcnt lgkmcnt(0)
    s_barrier
    v_mfma_f32_32x32x16_bf16 a[16:31], v[184:187], v[52:55], a[16:31]
    v_add_u32 v22, 114688, v17
    s_nop 6
    ds_write_b128 v22, a[0:3] offset:0
    v_mfma_f32_32x32x16_bf16 a[16:31], v[188:191], v[56:59], a[16:31]
    ds_write_b128 v22, a[4:7] offset:32
    ds_write_b128 v22, a[8:11] offset:64
    v_mfma_f32_32x32x16_bf16 a[16:31], v[192:195], v[60:63], a[16:31]
    ds_write_b128 v22, a[12:15] offset:96
    v_mfma_f32_32x32x16_bf16 a[16:31], v[196:199], v[64:67], a[16:31]
    v_mfma_f32_32x32x16_bf16 a[16:31], v[132:135], v[68:71], a[16:31]
    s_waitcnt lgkmcnt(0)
    s_barrier
    v_mfma_f32_32x32x16_bf16 a[32:47], v[88:91], v[36:39], 0
    v_add_u32 v23, 114688, v18
    ds_read_b128 v[72:75], v23 offset:0
    ds_read_b128 v[76:79], v23 offset:9216
    ds_read_b128 v[80:83], v23 offset:18432
    v_mfma_f32_32x32x16_bf16 a[32:47], v[92:95], v[40:43], a[32:47]
    ds_read_b128 v[84:87], v23 offset:27648
    s_nop 0
    s_nop 0
    s_nop 0
    v_mfma_f32_32x32x16_bf16 a[32:47], v[96:99], v[44:47], a[32:47]
    ds_write_b128 v17, a[16:19] offset:0
    ds_write_b128 v17, a[20:23] offset:32
    ds_write_b128 v17, a[24:27] offset:64
    ds_write_b128 v17, a[28:31] offset:96
    v_mfma_f32_32x32x16_bf16 a[32:47], v[100:103], v[48:51], a[32:47]
    s_waitcnt vmcnt(2)
    v_lshlrev_b32 v32, 16, v24
    v_and_b32 v33, 0xffff0000, v24
    v_lshlrev_b32 v34, 16, v25
    v_and_b32 v35, 0xffff0000, v25
    v_mfma_f32_32x32x16_bf16 a[32:47], v[104:107], v[52:55], a[32:47]
    s_waitcnt lgkmcnt(6)
    v_add_f32 v72, v72, v76
    v_add_f32 v73, v73, v77
    v_add_f32 v74, v74, v78
    v_add_f32 v75, v75, v79
    v_mfma_f32_32x32x16_bf16 a[32:47], v[108:111], v[56:59], a[32:47]
    s_waitcnt lgkmcnt(4)
    v_add_f32 v80, v80, v84
    v_add_f32 v81, v81, v85
    v_add_f32 v82, v82, v86
    v_add_f32 v83, v83, v87
    v_mfma_f32_32x32x16_bf16 a[32:47], v[112:115], v[60:63], a[32:47]
    v_add_f32 v72, v72, v32
    v_add_f32 v73, v73, v33
    v_add_f32 v74, v74, v34
    v_add_f32 v75, v75, v35
    v_mfma_f32_32x32x16_bf16 a[32:47], v[116:119], v[64:67], a[32:47]
    v_add_f32 v72, v72, v80
    v_add_f32 v73, v73, v81
    v_add_f32 v74, v74, v82
    v_add_f32 v75, v75, v83
    v_mfma_f32_32x32x16_bf16 a[32:47], v[200:203], v[68:71], a[32:47]
    v_cvt_pk_bf16_f32 v24, v72, v73
    v_cvt_pk_bf16_f32 v25, v74, v75
    buffer_store_dwordx2 v[24:25], v16, s[32:35], s50 offen sc1
    v_mul_f32 v73, s54, v73
    v_mul_f32 v21, v72, v72
    v_fmac_f32 v21, v73, v73
    v_fmac_f32 v21, v74, v74
    v_fmac_f32 v21, v75, v75
    v_add_u32 v22, 36864, v17
    s_nop 2
    ds_write_b128 v22, a[32:35] offset:0
    ds_write_b128 v22, a[36:39] offset:32
    ds_write_b128 v22, a[40:43] offset:64
    ds_write_b128 v22, a[44:47] offset:96
    s_waitcnt lgkmcnt(0)
    s_barrier
    ds_read_b128 v[72:75], v18 offset:0
    ds_read_b128 v[76:79], v18 offset:9216
    ds_read_b128 v[80:83], v18 offset:18432
    ds_read_b128 v[84:87], v18 offset:27648
    v_add_u32 v23, 36864, v18
    ds_read_b128 v[136:139], v23 offset:0
    ds_read_b128 v[140:143], v23 offset:9216
    ds_read_b128 v[144:147], v23 offset:18432
    ds_read_b128 v[148:151], v23 offset:27648
    s_waitcnt vmcnt(2)
    v_lshlrev_b32 v32, 16, v26
    v_and_b32 v33, 0xffff0000, v26
    v_lshlrev_b32 v34, 16, v27
    v_and_b32 v35, 0xffff0000, v27
    s_waitcnt lgkmcnt(6)
    v_add_f32 v72, v72, v76
    v_add_f32 v73, v73, v77
    v_add_f32 v74, v74, v78
    v_add_f32 v75, v75, v79
    s_waitcnt lgkmcnt(4)
    v_add_f32 v80, v80, v84
    v_add_f32 v81, v81, v85
    v_add_f32 v82, v82, v86
    v_add_f32 v83, v83, v87
    v_add_f32 v72, v72, v32
    v_add_f32 v73, v73, v33
    v_add_f32 v74, v74, v34
    v_add_f32 v75, v75, v35
    v_add_f32 v72, v72, v80
    v_add_f32 v73, v73, v81
    v_add_f32 v74, v74, v82
    v_add_f32 v75, v75, v83
    v_cvt_pk_bf16_f32 v26, v72, v73
    v_cvt_pk_bf16_f32 v27, v74, v75
    buffer_store_dwordx2 v[26:27], v16, s[32:35], s51 offen sc1
    v_fmac_f32 v21, v72, v72
    v_fmac_f32 v21, v73, v73
    v_fmac_f32 v21, v74, v74
    v_fmac_f32 v21, v75, v75
    s_waitcnt vmcnt(2)
    v_lshlrev_b32 v32, 16, v28
    v_and_b32 v33, 0xffff0000, v28
    v_lshlrev_b32 v34, 16, v29
    v_and_b32 v35, 0xffff0000, v29
    s_waitcnt lgkmcnt(2)
    v_add_f32 v136, v136, v140
    v_add_f32 v137, v137, v141
    v_add_f32 v138, v138, v142
    v_add_f32 v139, v139, v143
    s_waitcnt lgkmcnt(0)
    v_add_f32 v144, v144, v148
    v_add_f32 v145, v145, v149
    v_add_f32 v146, v146, v150
    v_add_f32 v147, v147, v151
    v_add_f32 v136, v136, v32
    v_add_f32 v137, v137, v33
    v_add_f32 v138, v138, v34
    v_add_f32 v139, v139, v35
    v_add_f32 v136, v136, v144
    v_add_f32 v137, v137, v145
    v_add_f32 v138, v138, v146
    v_add_f32 v139, v139, v147
    v_cvt_pk_bf16_f32 v28, v136, v137
    v_cvt_pk_bf16_f32 v29, v138, v139
    buffer_store_dwordx2 v[28:29], v16, s[32:35], s52 offen sc1
    v_fmac_f32 v21, v136, v136
    v_fmac_f32 v21, v137, v137
    v_fmac_f32 v21, v138, v138
    v_fmac_f32 v21, v139, v139
    v_lshlrev_b32 v3, 2, v6
    ds_write_b32 v15, v21
    s_waitcnt lgkmcnt(0)
    s_barrier
    s_cmp_lg_u32 s56, 0
    s_cbranch_scc1 L_a4_na
    ds_read_b32 v73, v15 offset:256
    ds_read_b32 v74, v15 offset:512
    ds_read_b32 v75, v15 offset:768
    ds_read_b32 v76, v15 offset:1024
    ds_read_b32 v77, v15 offset:1280
    ds_read_b32 v78, v15 offset:1536
    ds_read_b32 v79, v15 offset:1792
    s_waitcnt lgkmcnt(6)
    v_add_f32 v21, v21, v73
    s_waitcnt lgkmcnt(5)
    v_add_f32 v21, v21, v74
    s_waitcnt lgkmcnt(4)
    v_add_f32 v21, v21, v75
    s_waitcnt lgkmcnt(3)
    v_add_f32 v21, v21, v76
    s_waitcnt lgkmcnt(2)
    v_add_f32 v21, v21, v77
    s_waitcnt lgkmcnt(1)
    v_add_f32 v21, v21, v78
    s_waitcnt lgkmcnt(0)
    v_add_f32 v21, v21, v79
    s_lshl_b32 s25, s22, 8
    buffer_atomic_add_f32 v21, v3, s[36:39], s25 offen
L_a4_na:
    s_lshl_b32 s3, s2, 7
    s_add_u32 s3, s3, 0x18000
    v_mov_b32 v1, s3
    v_mov_b32 v4, s64
    v_mov_b32 v5, s65
    s_cmp_lg_u32 s56, 0
    s_waitcnt vmcnt(0)
    s_barrier
    s_cbranch_scc1 L_sig3_4048
    s_mov_b64 exec, 1
    buffer_store_dwordx2 v[4:5], v1, s[60:63], 0 offen sc1
    s_mov_b64 exec, -1
L_sig3_4048:
L_a4_skip:
    s_cmp_lt_u32 s2, 192
    s_cbranch_scc1 L_pfb_np
    s_cmp_lg_u32 s56, 7
    s_cbranch_scc1 L_pfb_np
    s_getpc_b64 s[68:69]
L_pfb_pc:
    s_add_u32 s68, s68, L_pfb_np - L_pfb_pc
    s_addc_u32 s69, s69, 0
    s_bfe_u32 s3, s2, 0x30003
    s_lshl_b32 s3, s3, 5
    v_and_b32 v205, 31, v0
    v_add_u32 v205, s3, v205
    v_lshlrev_b32 v205, 7, v205
    v_min_u32 v205, L_end - L_pfb_np - 4, v205
    global_load_dword v206, v205, s[68:69]
    s_waitcnt vmcnt(0)
L_pfb_np:
    s_cmp_ge_u32 s2, 144
    s_cbranch_scc1 L_b2_skip
    s_lshl_b32 s3, s2, 14
    s_add_u32 s8, s4, 0x480000
    s_addc_u32 s9, s5, 0
    s_add_u32 s8, s8, s3
    s_addc_u32 s9, s9, 0
    s_mov_b32 s10, 0x4000
    s_mov_b32 s11, 0x20000
    s_add_u32 s12, s4, 0x6c0000
    s_addc_u32 s13, s5, 0
    s_add_u32 s12, s12, s3
    s_addc_u32 s13, s13, 0
    s_mov_b32 s14, 0x4000
    s_mov_b32 s15, 0x20000
    s_add_u32 s16, s4, 0x132e000
    s_addc_u32 s17, s5, 0
    s_mov_b32 s18, 0x2000
    s_mov_b32 s19, 0x20000
    s_add_u32 s20, s4, 0xd80000
    s_addc_u32 s21, s5, 0
    s_add_u32 s20, s20, s3
    s_addc_u32 s21, s21, 0
    s_mov_b32 s22, 0x4000
    s_mov_b32 s23, 0x20000
    s_lshr_b32 s3, s3, 1
    s_add_u32 s48, s4, 0x1620000
    s_addc_u32 s49, s5, 0
    s_add_u32 s48, s48, s3
    s_addc_u32 s49, s49, 0
    s_mov_b32 s50, 0x2000
    s_mov_b32 s51, 0x20000
    v_and_b32 v1, 15, v0
    v_bfe_u32 v2, v0, 4, 2
    s_and_b32 s25, s56, 3
    s_lshr_b32 s26, s56, 2
    s_lshl_b32 s28, s25, 4
    v_and_b32 v9, 63, v0
    s_lshl_b32 s27, s56, 11
    v_lshlrev_b32 v5, 4, v9
    v_add_u32 v5, s27, v5
    v_lshrrev_b32 v6, 1, v5
    s_lshl_b32 s27, s26, 10
    s_add_u32 s27, s27, s28
    v_lshl_add_u32 v8, v2, 8, v1
    v_add_u32 v8, s27, v8
    v_lshlrev_b32 v8, 3, v8
    v_add_u32 v10, s28, v1
    s_lshl_b32 s29, s26, 13
    v_lshlrev_b32 v7, 2, v10
    v_lshl_add_u32 v7, v2, 10, v7
    v_add_u32 v7, s29, v7
    s_movk_i32 s30, 0x1000
    buffer_load_dword v32, v7, s[20:23], 0 offen offset:0 sc1
    buffer_load_dword v33, v7, s[20:23], 0 offen offset:256 sc1
    buffer_load_dword v34, v7, s[20:23], 0 offen offset:512 sc1
    buffer_load_dword v35, v7, s[20:23], 0 offen offset:768 sc1
    buffer_load_dword v36, v7, s[20:23], s30 offen offset:0 sc1
    buffer_load_dword v37, v7, s[20:23], s30 offen offset:256 sc1
    buffer_load_dword v38, v7, s[20:23], s30 offen offset:512 sc1
    buffer_load_dword v39, v7, s[20:23], s30 offen offset:768 sc1
    v_lshlrev_b32 v40, 4, v9
    s_and_b32 s3, s2, 1
    s_lshl_b32 s3, s3, 3
    s_lshr_b32 s44, s2, 5
    s_add_u32 s3, s3, s44
    s_mul_i32 s3, s3, 129024
    s_add_u32 s40, s4, 0xfc0000
    s_addc_u32 s41, s5, 0
    s_add_u32 s40, s40, s3
    s_addc_u32 s41, s41, 0
    s_mov_b32 s42, 0x1f800
    s_mov_b32 s43, 0x20000
    s_cmp_eq_u32 s2, 0
    s_cselect_b32 s31, 0, 1.0
    s_cselect_b64 s[38:39], -1, 0
    v_cvt_f32_u32 v172, v10
    v_cvt_f32_u32 v173, v1
    v_cvt_f32_u32 v174, v2
    v_mul_f32 v3, 0x3c800000, v172
    v_mul_f32 v4, 0x41000000, v174
    v_mul_f32 v4, v4, v3
    v_cos_f32 v124, v4
    v_sin_f32 v132, v4
    v_add_f32 v4, v4, v3
    v_cos_f32 v125, v4
    v_sin_f32 v133, v4
    v_add_f32 v4, v4, v3
    v_cos_f32 v126, v4
    v_sin_f32 v134, v4
    v_add_f32 v4, v4, v3
    v_cos_f32 v127, v4
    v_sin_f32 v135, v4
    v_add_f32 v4, v4, v3
    v_cos_f32 v128, v4
    v_sin_f32 v136, v4
    v_add_f32 v4, v4, v3
    v_cos_f32 v129, v4
    v_sin_f32 v137, v4
    v_add_f32 v4, v4, v3
    v_cos_f32 v130, v4
    v_sin_f32 v138, v4
    v_add_f32 v4, v4, v3
    v_cos_f32 v131, v4
    v_sin_f32 v139, v4
    v_and_b32 v175, 1, v1
    s_mov_b32 s32, 0x80008000
    v_mul_lo_u32 v175, v175, s32
    v_cvt_pk_bf16_f32 v44, v124, v125
    v_cvt_pk_bf16_f32 v52, v132, v133
    v_cvt_pk_bf16_f32 v45, v126, v127
    v_cvt_pk_bf16_f32 v53, v134, v135
    v_cvt_pk_bf16_f32 v46, v128, v129
    v_cvt_pk_bf16_f32 v54, v136, v137
    v_cvt_pk_bf16_f32 v47, v130, v131
    v_cvt_pk_bf16_f32 v55, v138, v139
    v_xor_b32 v60, s32, v52
    v_xor_b32 v48, v175, v44
    v_xor_b32 v56, v175, v52
    v_xor_b32 v64, v175, v60
    v_xor_b32 v61, s32, v53
    v_xor_b32 v49, v175, v45
    v_xor_b32 v57, v175, v53
    v_xor_b32 v65, v175, v61
    v_xor_b32 v62, s32, v54
    v_xor_b32 v50, v175, v46
    v_xor_b32 v58, v175, v54
    v_xor_b32 v66, v175, v62
    v_xor_b32 v63, s32, v55
    v_xor_b32 v51, v175, v47
    v_xor_b32 v59, v175, v55
    v_xor_b32 v67, v175, v63
    v_mul_f32 v3, 0x3a000000, v172
    v_mul_f32 v4, 4.0, v174
    v_mul_f32 v4, v4, v3
    s_mov_b32 s33, 0x41500000
    v_cos_f32 v92, v4
    v_sin_f32 v100, v4
    v_add_f32 v4, v4, v3
    v_cos_f32 v93, v4
    v_sin_f32 v101, v4
    v_add_f32 v4, v4, v3
    v_cos_f32 v94, v4
    v_sin_f32 v102, v4
    v_add_f32 v4, v4, v3
    v_cos_f32 v95, v4
    v_sin_f32 v103, v4
    v_fma_f32 v4, v3, s33, v4
    v_cos_f32 v96, v4
    v_sin_f32 v104, v4
    v_add_f32 v4, v4, v3
    v_cos_f32 v97, v4
    v_sin_f32 v105, v4
    v_add_f32 v4, v4, v3
    v_cos_f32 v98, v4
    v_sin_f32 v106, v4
    v_add_f32 v4, v4, v3
    v_cos_f32 v99, v4
    v_sin_f32 v107, v4
    s_mul_i32 s27, s56, 640
    s_add_u32 s27, s27, 122880
    v_lshrrev_b32 v3, 5, v9
    v_and_b32 v4, 31, v9
    v_mul_u32_u24 v188, 160, v3
    v_lshl_add_u32 v188, v4, 2, v188
    v_add_u32 v188, s27, v188
    s_mul_i32 s27, s26, 10240
    s_add_u32 s27, s27, 122880
    s_lshl_b32 s29, s25, 5
    s_add_u32 s29, s29, s27
    v_mul_u32_u24 v3, 160, v1
    v_lshl_add_u32 v189, v2, 3, v3
    v_add_u32 v189, s29, v189
    v_lshl_add_u32 v191, v2, 4, v3
    v_add_u32 v190, s27, v191
    s_mul_i32 s27, s26, 2560
    s_add_u32 s27, s27, 122880
    v_add_u32 v191, s27, v191
    s_mov_b32 s36, 0x3ae38e39
    v_mul_f32 v3, 0x3d000000, v173
    v_mul_f32 v4, 4.0, v174
    v_mul_f32 v4, v4, v3
    v_cos_f32 v124, v4
    v_sin_f32 v132, v4
    v_add_f32 v4, v4, v3
    v_cos_f32 v125, v4
    v_sin_f32 v133, v4
    v_add_f32 v4, v4, v3
    v_cos_f32 v126, v4
    v_sin_f32 v134, v4
    v_add_f32 v4, v4, v3
    v_cos_f32 v127, v4
    v_sin_f32 v135, v4
    v_fma_f32 v4, v3, s33, v4
    v_cos_f32 v128, v4
    v_sin_f32 v136, v4
    v_add_f32 v4, v4, v3
    v_cos_f32 v129, v4
    v_sin_f32 v137, v4
    v_add_f32 v4, v4, v3
    v_cos_f32 v130, v4
    v_sin_f32 v138, v4
    v_add_f32 v4, v4, v3
    v_cos_f32 v131, v4
    v_sin_f32 v139, v4
    v_cvt_pk_bf16_f32 v68, v124, v125
    v_cvt_pk_bf16_f32 v76, v132, v133
    v_cvt_pk_bf16_f32 v69, v126, v127
    v_cvt_pk_bf16_f32 v77, v134, v135
    v_cvt_pk_bf16_f32 v70, v128, v129
    v_cvt_pk_bf16_f32 v78, v136, v137
    v_cvt_pk_bf16_f32 v71, v130, v131
    v_cvt_pk_bf16_f32 v79, v138, v139
    s_mov_b32 s34, 0x80000000
    v_xor_b32 v84, s32, v76
    v_xor_b32 v72, s34, v68
    v_xor_b32 v80, s34, v76
    v_xor_b32 v88, s34, v84
    v_xor_b32 v85, s32, v77
    v_xor_b32 v73, s34, v69
    v_xor_b32 v81, s34, v77
    v_xor_b32 v89, s34, v85
    v_xor_b32 v86, s32, v78
    v_xor_b32 v74, s34, v70
    v_xor_b32 v82, s34, v78
    v_xor_b32 v90, s34, v86
    v_xor_b32 v87, s32, v79
    v_xor_b32 v75, s34, v71
    v_xor_b32 v83, s34, v79
    v_xor_b32 v91, s34, v87
    s_cmp_ge_u32 s56, 3
    s_cbranch_scc1 L_wait3_4301_d
    v_min_u32 v156, 191, v0
    v_lshlrev_b32 v156, 7, v156
    v_add_u32 v156, 0x18000, v156
    s_mov_b32 s3, 0
L_wait3_4301_p:
    buffer_load_dwordx2 v[160:161], v156, s[60:63], 0 offen sc1
    s_waitcnt vmcnt(0)
    v_cmp_ne_u64 vcc, s[64:65], v[160:161]
    s_nop 0
    s_mov_b64 exec, vcc
    s_add_u32 s3, s3, 1
    s_cmp_gt_u32 s3, 0x30d40
    s_cbranch_scc1 L_wait3_4301_x
    s_cmp_eq_u64 vcc, 0
    s_cbranch_scc1 L_wait3_4301_x
    s_sleep 1
    s_branch L_wait3_4301_p
L_wait3_4301_x:
    s_mov_b64 exec, -1
L_wait3_4301_d:
    s_barrier
    buffer_load_dwordx4 v[12:15], v5, s[8:11], 0 offen sc1
    buffer_load_dwordx4 v[16:19], v5, s[8:11], 0 offen offset:1024 sc1
    buffer_load_dwordx2 v[20:21], v6, s[16:19], 0 offen sc1
    buffer_load_dwordx2 v[22:23], v6, s[16:19], 0 offen offset:512 sc1
    v_cvt_f32_u32 v176, s28
    v_fma_f32 v176, v174, 4.0, v176
    s_mov_b32 s35, 0x3a000000
    v_mul_f32 v3, s35, v173
    v_mul_f32 v4, v176, v3
    v_cos_f32 v108, v4
    v_sin_f32 v116, v4
    v_add_f32 v4, v4, v3
    v_cos_f32 v109, v4
    v_sin_f32 v117, v4
    v_add_f32 v4, v4, v3
    v_cos_f32 v110, v4
    v_sin_f32 v118, v4
    v_add_f32 v4, v4, v3
    v_cos_f32 v111, v4
    v_sin_f32 v119, v4
    v_add_f32 v3, 0x3c000000, v3
    v_mul_f32 v4, v176, v3
    v_cos_f32 v112, v4
    v_sin_f32 v120, v4
    v_add_f32 v4, v4, v3
    v_cos_f32 v113, v4
    v_sin_f32 v121, v4
    v_add_f32 v4, v4, v3
    v_cos_f32 v114, v4
    v_sin_f32 v122, v4
    v_add_f32 v4, v4, v3
    v_cos_f32 v115, v4
    v_sin_f32 v123, v4
    v_mul_f32 v108, s35, v108
    v_mul_f32 v116, s35, v116
    v_mul_f32 v109, s35, v109
    v_mul_f32 v117, s35, v117
    v_mul_f32 v110, s35, v110
    v_mul_f32 v118, s35, v118
    v_mul_f32 v111, s35, v111
    v_mul_f32 v119, s35, v119
    v_mul_f32 v112, s35, v112
    v_mul_f32 v120, s35, v120
    v_mul_f32 v113, s35, v113
    v_mul_f32 v121, s35, v121
    v_mul_f32 v114, s35, v114
    v_mul_f32 v122, s35, v122
    v_mul_f32 v115, s35, v115
    v_mul_f32 v123, s35, v123
    v_mov_b32 v3, 0x3727c5ac
    s_waitcnt vmcnt(3)
    v_lshlrev_b32 v156, 16, v12
    v_and_b32 v157, 0xffff0000, v12
    v_lshlrev_b32 v158, 16, v13
    v_and_b32 v159, 0xffff0000, v13
    v_lshlrev_b32 v160, 16, v14
    v_and_b32 v161, 0xffff0000, v14
    v_lshlrev_b32 v162, 16, v15
    v_and_b32 v163, 0xffff0000, v15
    s_waitcnt vmcnt(2)
    v_lshlrev_b32 v164, 16, v16
    v_and_b32 v165, 0xffff0000, v16
    v_lshlrev_b32 v166, 16, v17
    v_and_b32 v167, 0xffff0000, v17
    v_lshlrev_b32 v168, 16, v18
    v_and_b32 v169, 0xffff0000, v18
    v_lshlrev_b32 v170, 16, v19
    v_and_b32 v171, 0xffff0000, v19
    v_mul_f32 v157, s31, v157
    v_mul_f32 v161, s31, v161
    v_mul_f32 v165, s31, v165
    v_mul_f32 v169, s31, v169
    s_waitcnt vmcnt(1)
    v_fma_f32 v20, v20, s36, v3
    v_fma_f32 v21, v21, s36, v3
    s_waitcnt vmcnt(0)
    v_fma_f32 v22, v22, s36, v3
    v_fma_f32 v23, v23, s36, v3
    v_rsq_f32 v20, v20
    v_rsq_f32 v21, v21
    v_rsq_f32 v22, v22
    v_rsq_f32 v23, v23
    v_mul_f32 v124, v156, v20
    v_mul_f32 v125, v160, v21
    v_mul_f32 v126, v164, v22
    v_mul_f32 v127, v168, v23
    v_cvt_pk_bf16_f32 v140, v124, v125
    ds_write_b32 v188, v140 offset:0
    v_cvt_pk_bf16_f32 v141, v126, v127
    ds_write_b32 v188, v141 offset:320
    v_mul_f32 v128, v157, v20
    v_mul_f32 v129, v161, v21
    v_mul_f32 v130, v165, v22
    v_mul_f32 v131, v169, v23
    v_cvt_pk_bf16_f32 v142, v128, v129
    ds_write_b32 v188, v142 offset:5120
    v_cvt_pk_bf16_f32 v143, v130, v131
    ds_write_b32 v188, v143 offset:5440
    v_mul_f32 v132, v158, v20
    v_mul_f32 v133, v162, v21
    v_mul_f32 v134, v166, v22
    v_mul_f32 v135, v170, v23
    v_cvt_pk_bf16_f32 v144, v132, v133
    ds_write_b32 v188, v144 offset:10240
    v_cvt_pk_bf16_f32 v145, v134, v135
    ds_write_b32 v188, v145 offset:10560
    v_mul_f32 v136, v159, v20
    v_mul_f32 v137, v163, v21
    v_mul_f32 v138, v167, v22
    v_mul_f32 v139, v171, v23
    v_cvt_pk_bf16_f32 v146, v136, v137
    ds_write_b32 v188, v146 offset:15360
    v_cvt_pk_bf16_f32 v147, v138, v139
    ds_write_b32 v188, v147 offset:15680
    buffer_load_dwordx2 v[24:25], v8, s[8:11], 0 offen offset:0 sc1
    buffer_load_dwordx2 v[26:27], v8, s[8:11], 0 offen offset:512 sc1
    buffer_load_dwordx2 v[28:29], v8, s[8:11], 0 offen offset:1024 sc1
    buffer_load_dwordx2 v[30:31], v8, s[8:11], 0 offen offset:1536 sc1
    s_waitcnt lgkmcnt(0)
    s_barrier
    ds_read_b128 v[156:159], v190 offset:0
    ds_read_b128 v[160:163], v190 offset:5120
    ds_read_b128 v[164:167], v190 offset:64
    ds_read_b128 v[168:171], v190 offset:5184
    ds_read_b128 v[172:175], v190 offset:2560
    ds_read_b128 v[176:179], v190 offset:7680
    ds_read_b128 v[180:183], v190 offset:2624
    ds_read_b128 v[184:187], v190 offset:7744
    s_waitcnt lgkmcnt(7)
    v_mfma_f32_16x16x32_bf16 v[124:127], v[156:159], v[44:47], 0
    s_waitcnt lgkmcnt(6)
    v_mfma_f32_16x16x32_bf16 v[128:131], v[160:163], v[44:47], 0
    v_mfma_f32_16x16x32_bf16 v[124:127], v[160:163], v[52:55], v[124:127]
    v_mfma_f32_16x16x32_bf16 v[128:131], v[156:159], v[60:63], v[128:131]
    s_waitcnt lgkmcnt(5)
    v_mfma_f32_16x16x32_bf16 v[124:127], v[164:167], v[48:51], v[124:127]
    s_waitcnt lgkmcnt(4)
    v_mfma_f32_16x16x32_bf16 v[128:131], v[168:171], v[48:51], v[128:131]
    v_mfma_f32_16x16x32_bf16 v[124:127], v[168:171], v[56:59], v[124:127]
    v_mfma_f32_16x16x32_bf16 v[128:131], v[164:167], v[64:67], v[128:131]
    s_waitcnt lgkmcnt(3)
    v_mfma_f32_16x16x32_bf16 v[132:135], v[172:175], v[44:47], 0
    v_lshlrev_b32 v156, 16, v32
    v_and_b32 v164, 0xffff0000, v32
    v_lshlrev_b32 v157, 16, v33
    s_waitcnt lgkmcnt(2)
    v_mfma_f32_16x16x32_bf16 v[136:139], v[176:179], v[44:47], 0
    v_and_b32 v165, 0xffff0000, v33
    v_lshlrev_b32 v158, 16, v34
    v_and_b32 v166, 0xffff0000, v34
    v_mfma_f32_16x16x32_bf16 v[132:135], v[176:179], v[52:55], v[132:135]
    v_mul_f32 v140, v128, v100
    v_mul_f32 v141, v129, v101
    v_mul_f32 v142, v130, v102
    v_mfma_f32_16x16x32_bf16 v[136:139], v[172:175], v[60:63], v[136:139]
    v_mul_f32 v143, v131, v103
    v_mul_f32 v148, v124, v100
    v_mul_f32 v149, v125, v101
    s_waitcnt lgkmcnt(1)
    v_mfma_f32_16x16x32_bf16 v[132:135], v[180:183], v[48:51], v[132:135]
    v_mul_f32 v150, v126, v102
    v_mul_f32 v151, v127, v103
    v_fma_f32 v140, v124, v92, v140
    s_waitcnt lgkmcnt(0)
    v_mfma_f32_16x16x32_bf16 v[136:139], v[184:187], v[48:51], v[136:139]
    v_fma_f32 v141, v125, v93, v141
    v_fma_f32 v142, v126, v94, v142
    v_fma_f32 v143, v127, v95, v143
    v_mfma_f32_16x16x32_bf16 v[132:135], v[184:187], v[56:59], v[132:135]
    v_fma_f32 v148, v128, v92, -v148
    v_fma_f32 v149, v129, v93, -v149
    v_fma_f32 v150, v130, v94, -v150
    v_mfma_f32_16x16x32_bf16 v[136:139], v[180:183], v[64:67], v[136:139]
    v_fma_f32 v151, v131, v95, -v151
    v_cvt_pk_bf16_f32 v12, v140, v141
    v_cvt_pk_bf16_f32 v16, v148, v149
    v_cvt_pk_bf16_f32 v13, v142, v143
    v_cvt_pk_bf16_f32 v17, v150, v151
    v_lshlrev_b32 v159, 16, v35
    v_and_b32 v167, 0xffff0000, v35
    v_lshlrev_b32 v160, 16, v36
    v_and_b32 v168, 0xffff0000, v36
    v_lshlrev_b32 v161, 16, v37
    v_and_b32 v169, 0xffff0000, v37
    v_lshlrev_b32 v162, 16, v38
    v_and_b32 v170, 0xffff0000, v38
    v_lshlrev_b32 v163, 16, v39
    v_and_b32 v171, 0xffff0000, v39
    v_mul_f32 v144, v136, v104
    v_mul_f32 v145, v137, v105
    v_mul_f32 v146, v138, v106
    v_mul_f32 v147, v139, v107
    v_mul_f32 v152, v132, v104
    v_mul_f32 v153, v133, v105
    v_mul_f32 v154, v134, v106
    v_mul_f32 v155, v135, v107
    v_fma_f32 v144, v132, v96, v144
    v_fma_f32 v145, v133, v97, v145
    v_fma_f32 v146, v134, v98, v146
    v_fma_f32 v147, v135, v99, v147
    v_fma_f32 v152, v136, v96, -v152
    v_fma_f32 v153, v137, v97, -v153
    v_fma_f32 v154, v138, v98, -v154
    v_fma_f32 v155, v139, v99, -v155
    v_cvt_pk_bf16_f32 v14, v144, v145
    v_cvt_pk_bf16_f32 v18, v152, v153
    v_cvt_pk_bf16_f32 v15, v146, v147
    v_cvt_pk_bf16_f32 v19, v154, v155
    s_nop 0
    v_mfma_f32_16x16x32_bf16 v[124:127], v[68:71], v[12:15], 0
    s_waitcnt vmcnt(3)
    v_lshlrev_b32 v92, 16, v24
    v_and_b32 v96, 0xffff0000, v24
    v_mfma_f32_16x16x32_bf16 v[128:131], v[68:71], v[16:19], 0
    v_lshlrev_b32 v100, 16, v25
    v_and_b32 v104, 0xffff0000, v25
    v_mfma_f32_16x16x32_bf16 v[124:127], v[76:79], v[16:19], v[124:127]
    s_waitcnt vmcnt(2)
    v_lshlrev_b32 v93, 16, v26
    v_and_b32 v97, 0xffff0000, v26
    v_mfma_f32_16x16x32_bf16 v[128:131], v[84:87], v[12:15], v[128:131]
    v_lshlrev_b32 v101, 16, v27
    v_and_b32 v105, 0xffff0000, v27
    v_mfma_f32_16x16x32_bf16 v[132:135], v[72:75], v[12:15], 0
    v_mfma_f32_16x16x32_bf16 v[136:139], v[72:75], v[16:19], 0
    v_mfma_f32_16x16x32_bf16 v[132:135], v[80:83], v[16:19], v[132:135]
    s_nop 2
    v_mul_f32 v140, v128, v164
    v_mul_f32 v141, v129, v165
    v_mul_f32 v142, v130, v166
    v_mfma_f32_16x16x32_bf16 v[136:139], v[88:91], v[12:15], v[136:139]
    v_mul_f32 v143, v131, v167
    v_mul_f32 v148, v124, v164
    v_mul_f32 v149, v125, v165
    v_mul_f32 v150, v126, v166
    v_mul_f32 v151, v127, v167
    v_fma_f32 v140, v124, v156, -v140
    v_fma_f32 v141, v125, v157, -v141
    v_fma_f32 v142, v126, v158, -v142
    v_fma_f32 v143, v127, v159, -v143
    v_fma_f32 v148, v128, v156, v148
    v_fma_f32 v149, v129, v157, v149
    v_fma_f32 v150, v130, v158, v150
    v_fma_f32 v151, v131, v159, v151
    v_cvt_pk_bf16_f32 v180, v140, v141
    v_cvt_pk_bf16_f32 v184, v148, v149
    v_cvt_pk_bf16_f32 v181, v142, v143
    v_cvt_pk_bf16_f32 v185, v150, v151
    v_mul_f32 v144, v136, v168
    v_mul_f32 v145, v137, v169
    v_mul_f32 v146, v138, v170
    v_mul_f32 v147, v139, v171
    v_mul_f32 v152, v132, v168
    v_mul_f32 v153, v133, v169
    v_mul_f32 v154, v134, v170
    v_mul_f32 v155, v135, v171
    v_fma_f32 v144, v132, v160, -v144
    v_fma_f32 v145, v133, v161, -v145
    v_fma_f32 v146, v134, v162, -v146
    v_fma_f32 v147, v135, v163, -v147
    v_fma_f32 v152, v136, v160, v152
    v_fma_f32 v153, v137, v161, v153
    v_fma_f32 v154, v138, v162, v154
    v_fma_f32 v155, v139, v163, v155
    v_cvt_pk_bf16_f32 v182, v144, v145
    v_cvt_pk_bf16_f32 v186, v152, v153
    v_cvt_pk_bf16_f32 v183, v146, v147
    v_cvt_pk_bf16_f32 v187, v154, v155
    s_nop 0
    v_mfma_f32_16x16x32_bf16 v[124:127], v[180:183], v[68:71], 0
    s_waitcnt vmcnt(1)
    v_lshlrev_b32 v94, 16, v28
    v_and_b32 v98, 0xffff0000, v28
    v_mfma_f32_16x16x32_bf16 v[128:131], v[180:183], v[76:79], 0
    v_lshlrev_b32 v102, 16, v29
    v_and_b32 v106, 0xffff0000, v29
    v_mfma_f32_16x16x32_bf16 v[124:127], v[184:187], v[84:87], v[124:127]
    s_waitcnt vmcnt(0)
    v_lshlrev_b32 v95, 16, v30
    v_and_b32 v99, 0xffff0000, v30
    v_mfma_f32_16x16x32_bf16 v[128:131], v[184:187], v[68:71], v[128:131]
    v_lshlrev_b32 v103, 16, v31
    v_and_b32 v107, 0xffff0000, v31
    v_mfma_f32_16x16x32_bf16 v[132:135], v[180:183], v[72:75], 0
    v_mfma_f32_16x16x32_bf16 v[136:139], v[180:183], v[80:83], 0
    v_mfma_f32_16x16x32_bf16 v[132:135], v[184:187], v[88:91], v[132:135]
    s_nop 2
    v_mul_f32 v140, v128, v116
    v_mul_f32 v141, v129, v117
    v_mul_f32 v142, v130, v118
    v_mfma_f32_16x16x32_bf16 v[136:139], v[184:187], v[72:75], v[136:139]
    v_mul_f32 v143, v131, v119
    v_mul_f32 v148, v124, v116
    v_mul_f32 v149, v125, v117
    v_mul_f32 v150, v126, v118
    v_mul_f32 v151, v127, v119
    v_fma_f32 v140, v124, v108, -v140
    v_fma_f32 v141, v125, v109, -v141
    v_fma_f32 v142, v126, v110, -v142
    v_fma_f32 v143, v127, v111, -v143
    v_fma_f32 v148, v128, v108, v148
    v_fma_f32 v149, v129, v109, v149
    v_fma_f32 v150, v130, v110, v150
    v_fma_f32 v151, v131, v111, v151
    v_cvt_pk_bf16_f32 v172, v140, v141
    v_cvt_pk_bf16_f32 v173, v142, v143
    ds_write_b64 v189, v[172:173] offset:20480
    v_cvt_pk_bf16_f32 v174, v148, v149
    v_cvt_pk_bf16_f32 v175, v150, v151
    ds_write_b64 v189, v[174:175] offset:25600
    v_mul_f32 v144, v136, v120
    v_mul_f32 v145, v137, v121
    v_mul_f32 v146, v138, v122
    v_mul_f32 v147, v139, v123
    v_mul_f32 v152, v132, v120
    v_mul_f32 v153, v133, v121
    v_mul_f32 v154, v134, v122
    v_mul_f32 v155, v135, v123
    v_fma_f32 v144, v132, v112, -v144
    v_fma_f32 v145, v133, v113, -v145
    v_fma_f32 v146, v134, v114, -v146
    v_fma_f32 v147, v135, v115, -v147
    v_fma_f32 v152, v136, v112, v152
    v_fma_f32 v153, v137, v113, v153
    v_fma_f32 v154, v138, v114, v154
    v_fma_f32 v155, v139, v115, v155
    v_cvt_pk_bf16_f32 v176, v144, v145
    v_cvt_pk_bf16_f32 v177, v146, v147
    ds_write_b64 v189, v[176:177] offset:23040
    v_cvt_pk_bf16_f32 v178, v152, v153
    v_cvt_pk_bf16_f32 v179, v154, v155
    ds_write_b64 v189, v[178:179] offset:28160
    s_waitcnt lgkmcnt(0)
    s_barrier
    ds_read_b128 v[156:159], v191 offset:20480
    ds_read_b128 v[160:163], v191 offset:25600
    ds_read_b128 v[164:167], v191 offset:20544
    ds_read_b128 v[168:171], v191 offset:25664
    ds_read_b128 v[172:175], v191 offset:30720
    ds_read_b128 v[176:179], v191 offset:35840
    ds_read_b128 v[180:183], v191 offset:30784
    ds_read_b128 v[184:187], v191 offset:35904
    s_waitcnt lgkmcnt(7)
    v_mfma_f32_16x16x32_bf16 v[124:127], v[156:159], v[44:47], v[92:95]
    v_mfma_f32_16x16x32_bf16 v[128:131], v[156:159], v[52:55], v[96:99]
    s_waitcnt lgkmcnt(6)
    v_mfma_f32_16x16x32_bf16 v[124:127], v[160:163], v[60:63], v[124:127]
    v_mfma_f32_16x16x32_bf16 v[128:131], v[160:163], v[44:47], v[128:131]
    s_waitcnt lgkmcnt(5)
    v_mfma_f32_16x16x32_bf16 v[124:127], v[164:167], v[48:51], v[124:127]
    v_mfma_f32_16x16x32_bf16 v[128:131], v[164:167], v[56:59], v[128:131]
    s_waitcnt lgkmcnt(4)
    v_mfma_f32_16x16x32_bf16 v[124:127], v[168:171], v[64:67], v[124:127]
    v_mfma_f32_16x16x32_bf16 v[128:131], v[168:171], v[48:51], v[128:131]
    s_waitcnt lgkmcnt(3)
    v_mfma_f32_16x16x32_bf16 v[132:135], v[172:175], v[44:47], v[100:103]
    v_mfma_f32_16x16x32_bf16 v[136:139], v[172:175], v[52:55], v[104:107]
    s_waitcnt lgkmcnt(2)
    v_mfma_f32_16x16x32_bf16 v[132:135], v[176:179], v[60:63], v[132:135]
    v_mfma_f32_16x16x32_bf16 v[136:139], v[176:179], v[44:47], v[136:139]
    s_nop 1
    v_cndmask_b32 v128, v128, v96, s[38:39]
    v_cndmask_b32 v129, v129, v97, s[38:39]
    v_cndmask_b32 v130, v130, v98, s[38:39]
    s_waitcnt lgkmcnt(1)
    v_mfma_f32_16x16x32_bf16 v[132:135], v[180:183], v[48:51], v[132:135]
    v_cndmask_b32 v131, v131, v99, s[38:39]
    v_cvt_pk_bf16_f32 v12, v124, v128
    v_cvt_pk_bf16_f32 v14, v125, v129
    v_mfma_f32_16x16x32_bf16 v[136:139], v[180:183], v[56:59], v[136:139]
    v_cvt_pk_bf16_f32 v16, v126, v130
    v_cvt_pk_bf16_f32 v18, v127, v131
    s_waitcnt lgkmcnt(0)
    v_mfma_f32_16x16x32_bf16 v[132:135], v[184:187], v[64:67], v[132:135]
    v_mfma_f32_16x16x32_bf16 v[136:139], v[184:187], v[48:51], v[136:139]
    s_nop 7
    v_cvt_pk_bf16_f32 v13, v132, v136
    buffer_store_dwordx2 v[12:13], v8, s[12:15], 0 offen offset:0 sc1
    v_cvt_pk_bf16_f32 v15, v133, v137
    buffer_store_dwordx2 v[14:15], v8, s[12:15], 0 offen offset:512 sc1
    v_cvt_pk_bf16_f32 v17, v134, v138
    buffer_store_dwordx2 v[16:17], v8, s[12:15], 0 offen offset:1024 sc1
    v_cvt_pk_bf16_f32 v19, v135, v139
    buffer_store_dwordx2 v[18:19], v8, s[12:15], 0 offen offset:1536 sc1
    s_lshl_b32 s3, s2, 7
    s_add_u32 s3, s3, 0x20000
    v_mov_b32 v1, s3
    v_mov_b32 v2, s64
    v_mov_b32 v3, s65
    s_cmp_lg_u32 s56, 0
    s_waitcnt vmcnt(0)
    s_barrier
    s_cbranch_scc1 L_sig4_4685
    s_mov_b64 exec, 1
    buffer_store_dwordx2 v[2:3], v1, s[60:63], 0 offen sc1
    s_mov_b64 exec, -1
L_sig4_4685:
    s_branch L_b2_end
L_b2_skip:
    v_and_b32 v1, 63, v0
    v_lshlrev_b32 v1, 4, v1
    s_and_b32 s3, s2, 1
    s_lshl_b32 s3, s3, 3
    s_lshr_b32 s44, s2, 5
    s_add_u32 s3, s3, s44
    s_mul_i32 s3, s3, 129024
    s_add_u32 s40, s4, 0xfc0000
    s_addc_u32 s41, s5, 0
    s_add_u32 s40, s40, s3
    s_addc_u32 s41, s41, 0
    s_mov_b32 s42, 0x1f800
    s_mov_b32 s43, 0x20000
L_b2_end:
    s_and_b32 s20, s2, 7
    s_lshr_b32 s21, s2, 3
    s_lshr_b32 s22, s20, 1
    s_lshl_b32 s22, s22, 2
    s_and_b32 s23, s21, 3
    s_add_u32 s22, s22, s23
    s_and_b32 s23, s20, 1
    s_lshl_b32 s23, s23, 3
    s_lshr_b32 s21, s21, 2
    s_add_u32 s23, s23, s21
    v_and_b32 v5, 63, v0
    v_lshlrev_b32 v5, 4, v5
    s_sub_u32 s44, s56, 0
    s_cmp_ge_u32 s44, 4
    s_cbranch_scc1 L_b3b_nd
    s_mul_i32 s44, s56, 32768
    s_mov_b32 m0, s44
    s_nop 0
    buffer_load_dwordx4 v5, s[40:43], s44 offen offset:0 sc1 lds
    buffer_load_dwordx4 v5, s[40:43], s44 offen offset:1024 sc1 lds
    buffer_load_dwordx4 v5, s[40:43], s44 offen offset:2048 sc1 lds
    buffer_load_dwordx4 v5, s[40:43], s44 offen offset:3072 sc1 lds
    s_add_u32 s44, s44, 0x1000
    s_mov_b32 m0, s44
    s_nop 0
    buffer_load_dwordx4 v5, s[40:43], s44 offen offset:0 sc1 lds
    buffer_load_dwordx4 v5, s[40:43], s44 offen offset:1024 sc1 lds
    buffer_load_dwordx4 v5, s[40:43], s44 offen offset:2048 sc1 lds
    buffer_load_dwordx4 v5, s[40:43], s44 offen offset:3072 sc1 lds
    s_add_u32 s44, s44, 0x1000
    s_mov_b32 m0, s44
    s_nop 0
    buffer_load_dwordx4 v5, s[40:43], s44 offen offset:0 sc1 lds
    buffer_load_dwordx4 v5, s[40:43], s44 offen offset:1024 sc1 lds
    buffer_load_dwordx4 v5, s[40:43], s44 offen offset:2048 sc1 lds
    buffer_load_dwordx4 v5, s[40:43], s44 offen offset:3072 sc1 lds
    s_add_u32 s44, s44, 0x1000
    s_mov_b32 m0, s44
    s_nop 0
    buffer_load_dwordx4 v5, s[40:43], s44 offen offset:0 sc1 lds
    buffer_load_dwordx4 v5, s[40:43], s44 offen offset:1024 sc1 lds
    buffer_load_dwordx4 v5, s[40:43], s44 offen offset:2048 sc1 lds
    buffer_load_dwordx4 v5, s[40:43], s44 offen offset:3072 sc1 lds
    s_add_u32 s44, s44, 0x1000
    s_mov_b32 m0, s44
    s_nop 0
    buffer_load_dwordx4 v5, s[40:43], s44 offen offset:0 sc1 lds
    buffer_load_dwordx4 v5, s[40:43], s44 offen offset:1024 sc1 lds
    buffer_load_dwordx4 v5, s[40:43], s44 offen offset:2048 sc1 lds
    buffer_load_dwordx4 v5, s[40:43], s44 offen offset:3072 sc1 lds
    s_add_u32 s44, s44, 0x1000
    s_mov_b32 m0, s44
    s_nop 0
    buffer_load_dwordx4 v5, s[40:43], s44 offen offset:0 sc1 lds
    buffer_load_dwordx4 v5, s[40:43], s44 offen offset:1024 sc1 lds
    buffer_load_dwordx4 v5, s[40:43], s44 offen offset:2048 sc1 lds
    buffer_load_dwordx4 v5, s[40:43], s44 offen offset:3072 sc1 lds
    s_add_u32 s44, s44, 0x1000
    s_mov_b32 m0, s44
    s_nop 0
    buffer_load_dwordx4 v5, s[40:43], s44 offen offset:0 sc1 lds
    buffer_load_dwordx4 v5, s[40:43], s44 offen offset:1024 sc1 lds
    buffer_load_dwordx4 v5, s[40:43], s44 offen offset:2048 sc1 lds
    buffer_load_dwordx4 v5, s[40:43], s44 offen offset:3072 sc1 lds
    s_add_u32 s44, s44, 0x1000
    s_mov_b32 m0, s44
    s_nop 0
    buffer_load_dwordx4 v5, s[40:43], s44 offen offset:0 sc1 lds
    buffer_load_dwordx4 v5, s[40:43], s44 offen offset:1024 sc1 lds
    buffer_load_dwordx4 v5, s[40:43], s44 offen offset:2048 sc1 lds
    buffer_load_dwordx4 v5, s[40:43], s44 offen offset:3072 sc1 lds
    s_add_u32 s44, s44, 0x1000
L_b3b_nd:
    v_and_b32 v1, 15, v0
    v_bfe_u32 v2, v0, 4, 2
    s_and_b32 s24, s56, 3
    s_and_b32 s30, s24, 1
    v_cmp_eq_u32 s[58:59], 1, v2
    v_cmp_eq_u32 s[68:69], 3, v2
    s_cmp_ge_u32 s56, 4
    s_cbranch_scc1 L_b3_help
    s_lshl_b32 s25, s22, 10
    s_lshl_b32 s26, s24, 8
    s_add_u32 s25, s25, s26
    v_lshlrev_b32 v6, 15, v2
    v_lshl_add_u32 v6, v1, 4, v6
    v_add_u32 v6, s25, v6
    v_add_u32 v7, 0x4000, v6
    s_mov_b32 s28, 0
    s_add_u32 s8, s4, 0x6c0000
    s_addc_u32 s9, s5, 0
    s_mov_b32 s10, 0x240000
    s_mov_b32 s11, 0x20000
    s_add_u32 s16, s4, 0xb40000
    s_addc_u32 s17, s5, 0
    s_mov_b32 s18, 0x240000
    s_mov_b32 s19, 0x20000
    v_add_u32 v8, 0x10000, v5
    v_cmp_eq_u32 vcc, 0, v2
    v_mov_b32 v3, 0xffff
    s_nop 0
    v_cndmask_b32 v9, -1, v3, vcc
    s_mov_b32 s37, 0x3fb8aa3b
    s_mov_b32 s36, 0x3ae38e39
    v_mov_b32 v198, 0x358637bd
    v_cndmask_b32 v199, v198, 0, s[58:59]
    v_mov_b32 v3, 0xff800000
    v_cndmask_b32 v200, v198, v3, s[58:59]
    v_mov_b32 v3, 1.0
    v_cndmask_b32 v201, v3, 0, s[58:59]
    v_and_b32 v3, 3, v1
    v_cmp_eq_u32 s[32:33], 1, v3
    v_cmp_eq_u32 s[34:35], 2, v3
    v_cmp_eq_u32 s[46:47], 3, v3
    s_lshl_b32 s29, s22, 2
    s_add_u32 s29, s29, s24
    s_mul_i32 s29, s29, 36
    s_lshr_b32 s31, s23, 2
    s_mul_i32 s31, s31, 9
    s_add_u32 s29, s29, s31
    s_lshl_b32 s29, s29, 10
    s_and_b32 s31, s23, 3
    s_lshl_b32 s48, s31, 11
    s_add_u32 s48, s48, s29
    s_add_u32 s49, s48, 256
    s_lshr_b32 s50, s31, 1
    s_lshl_b32 s50, s50, 9
    s_and_b32 s51, s31, 1
    s_lshl_b32 s51, s51, 3
    s_add_u32 s50, s50, s51
    s_add_u32 s50, s50, s29
    s_add_u32 s50, s50, 8192
    s_add_u32 s51, s50, 256
    s_lshl_b32 s52, s24, 10
    s_add_u32 s52, s52, 147456
    s_lshl_b32 s53, s24, 12
    s_add_u32 s53, s53, 131072
    s_waitcnt vmcnt(0)
    s_cmp_ge_u32 s56, 3
    s_cbranch_scc1 L_wait4_4835_d
    v_min_u32 v12, 143, v0
    v_lshlrev_b32 v12, 7, v12
    v_add_u32 v12, 0x20000, v12
    s_mov_b32 s3, 0
L_wait4_4835_p:
    buffer_load_dwordx2 v[16:17], v12, s[60:63], 0 offen sc1
    s_waitcnt vmcnt(0)
    v_cmp_ne_u64 vcc, s[64:65], v[16:17]
    s_nop 0
    s_mov_b64 exec, vcc
    s_add_u32 s3, s3, 1
    s_cmp_gt_u32 s3, 0x30d40
    s_cbranch_scc1 L_wait4_4835_x
    s_cmp_eq_u64 vcc, 0
    s_cbranch_scc1 L_wait4_4835_x
    s_sleep 1
    s_branch L_wait4_4835_p
L_wait4_4835_x:
    s_mov_b64 exec, -1
L_wait4_4835_d:
    s_barrier
    buffer_load_dwordx4 v[12:15], v6, s[8:11], s28 offen sc1
    buffer_load_dwordx4 v[16:19], v7, s[8:11], s28 offen sc1
    s_add_u32 s28, s28, 0x20000
    buffer_load_dwordx4 v[20:23], v6, s[8:11], s28 offen sc1
    buffer_load_dwordx4 v[24:27], v7, s[8:11], s28 offen sc1
    s_add_u32 s28, s28, 0x20000
    buffer_load_dwordx4 v[28:31], v6, s[8:11], s28 offen sc1
    buffer_load_dwordx4 v[32:35], v7, s[8:11], s28 offen sc1
    s_add_u32 s28, s28, 0x20000
    buffer_load_dwordx4 v[36:39], v6, s[8:11], s28 offen sc1
    buffer_load_dwordx4 v[40:43], v7, s[8:11], s28 offen sc1
    s_add_u32 s28, s28, 0x20000
    ds_read_b128 a[0:3], v5 offset:0
    ds_read_b128 a[4:7], v5 offset:1024
    ds_read_b128 a[8:11], v5 offset:2048
    ds_read_b128 a[12:15], v5 offset:3072
    ds_read_b128 a[16:19], v5 offset:4096
    s_waitcnt vmcnt(6)
    v_swap_b32 v14, v16
    v_swap_b32 v15, v17
    v_and_b32 v12, v9, v12
    v_and_b32 v16, v9, v16
    s_waitcnt lgkmcnt(4)
    v_mfma_f32_16x16x32_bf16 v[156:159], v[12:15], a[0:3], 0
    ds_read_b128 a[20:23], v5 offset:5120
    v_mfma_f32_16x16x32_bf16 v[160:163], v[16:19], a[0:3], 0
    buffer_load_dwordx4 v[44:47], v6, s[8:11], s28 offen sc1
    s_waitcnt lgkmcnt(4)
    v_mfma_f32_16x16x32_bf16 v[164:167], v[12:15], a[4:7], 0
    ds_read_b128 a[24:27], v5 offset:6144
    v_mfma_f32_16x16x32_bf16 v[168:171], v[16:19], a[4:7], 0
    ds_read_b128 a[28:31], v5 offset:7168
    s_waitcnt lgkmcnt(5)
    v_mfma_f32_16x16x32_bf16 v[172:175], v[12:15], a[8:11], 0
    ds_read_b128 a[32:35], v5 offset:8192
    v_mfma_f32_16x16x32_bf16 v[176:179], v[16:19], a[8:11], 0
    buffer_load_dwordx4 v[48:51], v7, s[8:11], s28 offen sc1
    s_add_u32 s28, s28, 0x20000
    s_waitcnt lgkmcnt(5)
    v_mfma_f32_16x16x32_bf16 v[180:183], v[12:15], a[12:15], 0
    ds_read_b128 a[36:39], v5 offset:9216
    v_mfma_f32_16x16x32_bf16 v[184:187], v[16:19], a[12:15], 0
    s_waitcnt vmcnt(6)
    v_swap_b32 v22, v24
    s_waitcnt lgkmcnt(5)
    v_mfma_f32_16x16x32_bf16 v[188:191], a[16:19], v[12:15], 0
    v_swap_b32 v23, v25
    v_mfma_f32_16x16x32_bf16 v[192:195], a[16:19], v[16:19], 0
    v_mfma_f32_16x16x32_bf16 a[40:43], v[12:15], v[12:15], 0
    v_mfma_f32_16x16x32_bf16 a[44:47], v[16:19], v[16:19], 0
    s_waitcnt lgkmcnt(4)
    v_mfma_f32_16x16x32_bf16 v[156:159], v[20:23], a[20:23], v[156:159]
    ds_read_b128 a[0:3], v5 offset:10240
    v_mfma_f32_16x16x32_bf16 v[160:163], v[24:27], a[20:23], v[160:163]
    buffer_load_dwordx4 v[52:55], v6, s[8:11], s28 offen sc1
    s_waitcnt lgkmcnt(4)
    v_mfma_f32_16x16x32_bf16 v[164:167], v[20:23], a[24:27], v[164:167]
    ds_read_b128 a[4:7], v5 offset:11264
    v_mfma_f32_16x16x32_bf16 v[168:171], v[24:27], a[24:27], v[168:171]
    ds_read_b128 a[8:11], v5 offset:12288
    s_waitcnt lgkmcnt(5)
    v_mfma_f32_16x16x32_bf16 v[172:175], v[20:23], a[28:31], v[172:175]
    ds_read_b128 a[12:15], v5 offset:13312
    v_mfma_f32_16x16x32_bf16 v[176:179], v[24:27], a[28:31], v[176:179]
    buffer_load_dwordx4 v[56:59], v7, s[8:11], s28 offen sc1
    s_add_u32 s28, s28, 0x20000
    s_waitcnt lgkmcnt(5)
    v_mfma_f32_16x16x32_bf16 v[180:183], v[20:23], a[32:35], v[180:183]
    ds_read_b128 a[16:19], v5 offset:14336
    v_mfma_f32_16x16x32_bf16 v[184:187], v[24:27], a[32:35], v[184:187]
    s_waitcnt vmcnt(6)
    v_swap_b32 v30, v32
    s_waitcnt lgkmcnt(5)
    v_mfma_f32_16x16x32_bf16 v[188:191], a[36:39], v[20:23], v[188:191]
    v_swap_b32 v31, v33
    v_mfma_f32_16x16x32_bf16 v[192:195], a[36:39], v[24:27], v[192:195]
    v_mfma_f32_16x16x32_bf16 a[40:43], v[20:23], v[20:23], a[40:43]
    v_mfma_f32_16x16x32_bf16 a[44:47], v[24:27], v[24:27], a[44:47]
    s_waitcnt lgkmcnt(4)
    v_mfma_f32_16x16x32_bf16 v[156:159], v[28:31], a[0:3], v[156:159]
    ds_read_b128 a[20:23], v5 offset:15360
    v_mfma_f32_16x16x32_bf16 v[160:163], v[32:35], a[0:3], v[160:163]
    buffer_load_dwordx4 v[60:63], v6, s[8:11], s28 offen sc1
    s_waitcnt lgkmcnt(4)
    v_mfma_f32_16x16x32_bf16 v[164:167], v[28:31], a[4:7], v[164:167]
    ds_read_b128 a[24:27], v5 offset:16384
    v_mfma_f32_16x16x32_bf16 v[168:171], v[32:35], a[4:7], v[168:171]
    ds_read_b128 a[28:31], v5 offset:17408
    s_waitcnt lgkmcnt(5)
    v_mfma_f32_16x16x32_bf16 v[172:175], v[28:31], a[8:11], v[172:175]
    ds_read_b128 a[32:35], v5 offset:18432
    v_mfma_f32_16x16x32_bf16 v[176:179], v[32:35], a[8:11], v[176:179]
    buffer_load_dwordx4 v[64:67], v7, s[8:11], s28 offen sc1
    s_add_u32 s28, s28, 0x20000
    s_waitcnt lgkmcnt(5)
    v_mfma_f32_16x16x32_bf16 v[180:183], v[28:31], a[12:15], v[180:183]
    ds_read_b128 a[36:39], v5 offset:19456
    v_mfma_f32_16x16x32_bf16 v[184:187], v[32:35], a[12:15], v[184:187]
    s_waitcnt vmcnt(6)
    v_swap_b32 v38, v40
    s_waitcnt lgkmcnt(5)
    v_mfma_f32_16x16x32_bf16 v[188:191], a[16:19], v[28:31], v[188:191]
    v_swap_b32 v39, v41
    v_mfma_f32_16x16x32_bf16 v[192:195], a[16:19], v[32:35], v[192:195]
    v_mfma_f32_16x16x32_bf16 a[40:43], v[28:31], v[28:31], a[40:43]
    v_mfma_f32_16x16x32_bf16 a[44:47], v[32:35], v[32:35], a[44:47]
    s_waitcnt lgkmcnt(4)
    v_mfma_f32_16x16x32_bf16 v[156:159], v[36:39], a[20:23], v[156:159]
    ds_read_b128 a[0:3], v5 offset:20480
    v_mfma_f32_16x16x32_bf16 v[160:163], v[40:43], a[20:23], v[160:163]
    buffer_load_dwordx4 v[68:71], v6, s[8:11], s28 offen sc1
    s_waitcnt lgkmcnt(4)
    v_mfma_f32_16x16x32_bf16 v[164:167], v[36:39], a[24:27], v[164:167]
    ds_read_b128 a[4:7], v5 offset:21504
    v_mfma_f32_16x16x32_bf16 v[168:171], v[40:43], a[24:27], v[168:171]
    ds_read_b128 a[8:11], v5 offset:22528
    s_waitcnt lgkmcnt(5)
    v_mfma_f32_16x16x32_bf16 v[172:175], v[36:39], a[28:31], v[172:175]
    ds_read_b128 a[12:15], v5 offset:23552
    v_mfma_f32_16x16x32_bf16 v[176:179], v[40:43], a[28:31], v[176:179]
    buffer_load_dwordx4 v[72:75], v7, s[8:11], s28 offen sc1
    s_add_u32 s28, s28, 0x20000
    s_waitcnt lgkmcnt(5)
    v_mfma_f32_16x16x32_bf16 v[180:183], v[36:39], a[32:35], v[180:183]
    ds_read_b128 a[16:19], v5 offset:24576
    v_mfma_f32_16x16x32_bf16 v[184:187], v[40:43], a[32:35], v[184:187]
    s_waitcnt vmcnt(6)
    v_swap_b32 v46, v48
    s_waitcnt lgkmcnt(5)
    v_mfma_f32_16x16x32_bf16 v[188:191], a[36:39], v[36:39], v[188:191]
    v_swap_b32 v47, v49
    v_mfma_f32_16x16x32_bf16 v[192:195], a[36:39], v[40:43], v[192:195]
    v_mfma_f32_16x16x32_bf16 a[40:43], v[36:39], v[36:39], a[40:43]
    v_mfma_f32_16x16x32_bf16 a[44:47], v[40:43], v[40:43], a[44:47]
    s_waitcnt lgkmcnt(4)
    v_mfma_f32_16x16x32_bf16 v[156:159], v[44:47], a[0:3], v[156:159]
    ds_read_b128 a[20:23], v5 offset:25600
    v_mfma_f32_16x16x32_bf16 v[160:163], v[48:51], a[0:3], v[160:163]
    buffer_load_dwordx4 v[76:79], v6, s[8:11], s28 offen sc1
    s_waitcnt lgkmcnt(4)
    v_mfma_f32_16x16x32_bf16 v[164:167], v[44:47], a[4:7], v[164:167]
    ds_read_b128 a[24:27], v5 offset:26624
    v_mfma_f32_16x16x32_bf16 v[168:171], v[48:51], a[4:7], v[168:171]
    ds_read_b128 a[28:31], v5 offset:27648
    s_waitcnt lgkmcnt(5)
    v_mfma_f32_16x16x32_bf16 v[172:175], v[44:47], a[8:11], v[172:175]
    ds_read_b128 a[32:35], v5 offset:28672
    v_mfma_f32_16x16x32_bf16 v[176:179], v[48:51], a[8:11], v[176:179]
    buffer_load_dwordx4 v[80:83], v7, s[8:11], s28 offen sc1
    s_add_u32 s28, s28, 0x20000
    s_waitcnt lgkmcnt(5)
    v_mfma_f32_16x16x32_bf16 v[180:183], v[44:47], a[12:15], v[180:183]
    ds_read_b128 a[36:39], v5 offset:29696
    v_mfma_f32_16x16x32_bf16 v[184:187], v[48:51], a[12:15], v[184:187]
    s_waitcnt vmcnt(6)
    v_swap_b32 v54, v56
    s_waitcnt lgkmcnt(5)
    v_mfma_f32_16x16x32_bf16 v[188:191], a[16:19], v[44:47], v[188:191]
    v_swap_b32 v55, v57
    v_mfma_f32_16x16x32_bf16 v[192:195], a[16:19], v[48:51], v[192:195]
    v_mfma_f32_16x16x32_bf16 a[40:43], v[44:47], v[44:47], a[40:43]
    v_mfma_f32_16x16x32_bf16 a[44:47], v[48:51], v[48:51], a[44:47]
    s_waitcnt lgkmcnt(4)
    v_mfma_f32_16x16x32_bf16 v[156:159], v[52:55], a[20:23], v[156:159]
    ds_read_b128 a[0:3], v5 offset:30720
    v_mfma_f32_16x16x32_bf16 v[160:163], v[56:59], a[20:23], v[160:163]
    buffer_load_dwordx4 v[84:87], v6, s[8:11], s28 offen sc1
    s_waitcnt lgkmcnt(4)
    v_mfma_f32_16x16x32_bf16 v[164:167], v[52:55], a[24:27], v[164:167]
    ds_read_b128 a[4:7], v5 offset:31744
    v_mfma_f32_16x16x32_bf16 v[168:171], v[56:59], a[24:27], v[168:171]
    ds_read_b128 a[8:11], v5 offset:32768
    s_waitcnt lgkmcnt(5)
    v_mfma_f32_16x16x32_bf16 v[172:175], v[52:55], a[28:31], v[172:175]
    ds_read_b128 a[12:15], v5 offset:33792
    v_mfma_f32_16x16x32_bf16 v[176:179], v[56:59], a[28:31], v[176:179]
    buffer_load_dwordx4 v[88:91], v7, s[8:11], s28 offen sc1
    s_add_u32 s28, s28, 0x20000
    s_waitcnt lgkmcnt(5)
    v_mfma_f32_16x16x32_bf16 v[180:183], v[52:55], a[32:35], v[180:183]
    ds_read_b128 a[16:19], v5 offset:34816
    v_mfma_f32_16x16x32_bf16 v[184:187], v[56:59], a[32:35], v[184:187]
    s_waitcnt vmcnt(6)
    v_swap_b32 v62, v64
    s_waitcnt lgkmcnt(5)
    v_mfma_f32_16x16x32_bf16 v[188:191], a[36:39], v[52:55], v[188:191]
    v_swap_b32 v63, v65
    v_mfma_f32_16x16x32_bf16 v[192:195], a[36:39], v[56:59], v[192:195]
    v_mfma_f32_16x16x32_bf16 a[40:43], v[52:55], v[52:55], a[40:43]
    v_mfma_f32_16x16x32_bf16 a[44:47], v[56:59], v[56:59], a[44:47]
    s_waitcnt lgkmcnt(4)
    v_mfma_f32_16x16x32_bf16 v[156:159], v[60:63], a[0:3], v[156:159]
    ds_read_b128 a[20:23], v5 offset:35840
    v_mfma_f32_16x16x32_bf16 v[160:163], v[64:67], a[0:3], v[160:163]
    buffer_load_dwordx4 v[92:95], v6, s[8:11], s28 offen sc1
    s_waitcnt lgkmcnt(4)
    v_mfma_f32_16x16x32_bf16 v[164:167], v[60:63], a[4:7], v[164:167]
    ds_read_b128 a[24:27], v5 offset:36864
    v_mfma_f32_16x16x32_bf16 v[168:171], v[64:67], a[4:7], v[168:171]
    ds_read_b128 a[28:31], v5 offset:37888
    s_waitcnt lgkmcnt(5)
    v_mfma_f32_16x16x32_bf16 v[172:175], v[60:63], a[8:11], v[172:175]
    ds_read_b128 a[32:35], v5 offset:38912
    v_mfma_f32_16x16x32_bf16 v[176:179], v[64:67], a[8:11], v[176:179]
    buffer_load_dwordx4 v[96:99], v7, s[8:11], s28 offen sc1
    s_add_u32 s28, s28, 0x20000
    s_waitcnt lgkmcnt(5)
    v_mfma_f32_16x16x32_bf16 v[180:183], v[60:63], a[12:15], v[180:183]
    ds_read_b128 a[36:39], v5 offset:39936
    v_mfma_f32_16x16x32_bf16 v[184:187], v[64:67], a[12:15], v[184:187]
    s_waitcnt vmcnt(6)
    v_swap_b32 v70, v72
    s_waitcnt lgkmcnt(5)
    v_mfma_f32_16x16x32_bf16 v[188:191], a[16:19], v[60:63], v[188:191]
    v_swap_b32 v71, v73
    v_mfma_f32_16x16x32_bf16 v[192:195], a[16:19], v[64:67], v[192:195]
    v_mfma_f32_16x16x32_bf16 a[40:43], v[60:63], v[60:63], a[40:43]
    v_mfma_f32_16x16x32_bf16 a[44:47], v[64:67], v[64:67], a[44:47]
    s_waitcnt lgkmcnt(4)
    v_mfma_f32_16x16x32_bf16 v[156:159], v[68:71], a[20:23], v[156:159]
    ds_read_b128 a[0:3], v5 offset:40960
    v_mfma_f32_16x16x32_bf16 v[160:163], v[72:75], a[20:23], v[160:163]
    buffer_load_dwordx4 v[100:103], v6, s[8:11], s28 offen sc1
    s_waitcnt lgkmcnt(4)
    v_mfma_f32_16x16x32_bf16 v[164:167], v[68:71], a[24:27], v[164:167]
    ds_read_b128 a[4:7], v5 offset:41984
    v_mfma_f32_16x16x32_bf16 v[168:171], v[72:75], a[24:27], v[168:171]
    ds_read_b128 a[8:11], v5 offset:43008
    s_waitcnt lgkmcnt(5)
    v_mfma_f32_16x16x32_bf16 v[172:175], v[68:71], a[28:31], v[172:175]
    ds_read_b128 a[12:15], v5 offset:44032
    v_mfma_f32_16x16x32_bf16 v[176:179], v[72:75], a[28:31], v[176:179]
    buffer_load_dwordx4 v[104:107], v7, s[8:11], s28 offen sc1
    s_add_u32 s28, s28, 0x20000
    s_waitcnt lgkmcnt(5)
    v_mfma_f32_16x16x32_bf16 v[180:183], v[68:71], a[32:35], v[180:183]
    ds_read_b128 a[16:19], v5 offset:45056
    v_mfma_f32_16x16x32_bf16 v[184:187], v[72:75], a[32:35], v[184:187]
    s_waitcnt vmcnt(6)
    v_swap_b32 v78, v80
    s_waitcnt lgkmcnt(5)
    v_mfma_f32_16x16x32_bf16 v[188:191], a[36:39], v[68:71], v[188:191]
    v_swap_b32 v79, v81
    v_mfma_f32_16x16x32_bf16 v[192:195], a[36:39], v[72:75], v[192:195]
    v_mfma_f32_16x16x32_bf16 a[40:43], v[68:71], v[68:71], a[40:43]
    v_mfma_f32_16x16x32_bf16 a[44:47], v[72:75], v[72:75], a[44:47]
    s_waitcnt lgkmcnt(4)
    v_mfma_f32_16x16x32_bf16 v[156:159], v[76:79], a[0:3], v[156:159]
    ds_read_b128 a[20:23], v5 offset:46080
    v_mfma_f32_16x16x32_bf16 v[160:163], v[80:83], a[0:3], v[160:163]
    buffer_load_dwordx4 v[108:111], v6, s[8:11], s28 offen sc1
    s_waitcnt lgkmcnt(4)
    v_mfma_f32_16x16x32_bf16 v[164:167], v[76:79], a[4:7], v[164:167]
    ds_read_b128 a[24:27], v5 offset:47104
    v_mfma_f32_16x16x32_bf16 v[168:171], v[80:83], a[4:7], v[168:171]
    ds_read_b128 a[28:31], v5 offset:48128
    s_waitcnt lgkmcnt(5)
    v_mfma_f32_16x16x32_bf16 v[172:175], v[76:79], a[8:11], v[172:175]
    ds_read_b128 a[32:35], v5 offset:49152
    v_mfma_f32_16x16x32_bf16 v[176:179], v[80:83], a[8:11], v[176:179]
    buffer_load_dwordx4 v[112:115], v7, s[8:11], s28 offen sc1
    s_add_u32 s28, s28, 0x20000
    s_waitcnt lgkmcnt(5)
    v_mfma_f32_16x16x32_bf16 v[180:183], v[76:79], a[12:15], v[180:183]
    ds_read_b128 a[36:39], v5 offset:50176
    v_mfma_f32_16x16x32_bf16 v[184:187], v[80:83], a[12:15], v[184:187]
    s_waitcnt vmcnt(6)
    v_swap_b32 v86, v88
    s_waitcnt lgkmcnt(5)
    v_mfma_f32_16x16x32_bf16 v[188:191], a[16:19], v[76:79], v[188:191]
    v_swap_b32 v87, v89
    v_mfma_f32_16x16x32_bf16 v[192:195], a[16:19], v[80:83], v[192:195]
    v_mfma_f32_16x16x32_bf16 a[40:43], v[76:79], v[76:79], a[40:43]
    v_mfma_f32_16x16x32_bf16 a[44:47], v[80:83], v[80:83], a[44:47]
    s_waitcnt lgkmcnt(4)
    v_mfma_f32_16x16x32_bf16 v[156:159], v[84:87], a[20:23], v[156:159]
    ds_read_b128 a[0:3], v5 offset:51200
    v_mfma_f32_16x16x32_bf16 v[160:163], v[88:91], a[20:23], v[160:163]
    buffer_load_dwordx4 v[116:119], v6, s[8:11], s28 offen sc1
    s_waitcnt lgkmcnt(4)
    v_mfma_f32_16x16x32_bf16 v[164:167], v[84:87], a[24:27], v[164:167]
    ds_read_b128 a[4:7], v5 offset:52224
    v_mfma_f32_16x16x32_bf16 v[168:171], v[88:91], a[24:27], v[168:171]
    ds_read_b128 a[8:11], v5 offset:53248
    s_waitcnt lgkmcnt(5)
    v_mfma_f32_16x16x32_bf16 v[172:175], v[84:87], a[28:31], v[172:175]
    ds_read_b128 a[12:15], v5 offset:54272
    v_mfma_f32_16x16x32_bf16 v[176:179], v[88:91], a[28:31], v[176:179]
    buffer_load_dwordx4 v[120:123], v7, s[8:11], s28 offen sc1
    s_add_u32 s28, s28, 0x20000
    s_waitcnt lgkmcnt(5)
    v_mfma_f32_16x16x32_bf16 v[180:183], v[84:87], a[32:35], v[180:183]
    ds_read_b128 a[16:19], v5 offset:55296
    v_mfma_f32_16x16x32_bf16 v[184:187], v[88:91], a[32:35], v[184:187]
    s_waitcnt vmcnt(6)
    v_swap_b32 v94, v96
    s_waitcnt lgkmcnt(5)
    v_mfma_f32_16x16x32_bf16 v[188:191], a[36:39], v[84:87], v[188:191]
    v_swap_b32 v95, v97
    v_mfma_f32_16x16x32_bf16 v[192:195], a[36:39], v[88:91], v[192:195]
    v_mfma_f32_16x16x32_bf16 a[40:43], v[84:87], v[84:87], a[40:43]
    v_mfma_f32_16x16x32_bf16 a[44:47], v[88:91], v[88:91], a[44:47]
    s_waitcnt lgkmcnt(4)
    v_mfma_f32_16x16x32_bf16 v[156:159], v[92:95], a[0:3], v[156:159]
    ds_read_b128 a[20:23], v5 offset:56320
    v_mfma_f32_16x16x32_bf16 v[160:163], v[96:99], a[0:3], v[160:163]
    buffer_load_dwordx4 v[124:127], v6, s[8:11], s28 offen sc1
    s_waitcnt lgkmcnt(4)
    v_mfma_f32_16x16x32_bf16 v[164:167], v[92:95], a[4:7], v[164:167]
    ds_read_b128 a[24:27], v5 offset:57344
    v_mfma_f32_16x16x32_bf16 v[168:171], v[96:99], a[4:7], v[168:171]
    ds_read_b128 a[28:31], v5 offset:58368
    s_waitcnt lgkmcnt(5)
    v_mfma_f32_16x16x32_bf16 v[172:175], v[92:95], a[8:11], v[172:175]
    ds_read_b128 a[32:35], v5 offset:59392
    v_mfma_f32_16x16x32_bf16 v[176:179], v[96:99], a[8:11], v[176:179]
    buffer_load_dwordx4 v[128:131], v7, s[8:11], s28 offen sc1
    s_add_u32 s28, s28, 0x20000
    s_waitcnt lgkmcnt(5)
    v_mfma_f32_16x16x32_bf16 v[180:183], v[92:95], a[12:15], v[180:183]
    ds_read_b128 a[36:39], v5 offset:60416
    v_mfma_f32_16x16x32_bf16 v[184:187], v[96:99], a[12:15], v[184:187]
    s_waitcnt vmcnt(6)
    v_swap_b32 v102, v104
    s_waitcnt lgkmcnt(5)
    v_mfma_f32_16x16x32_bf16 v[188:191], a[16:19], v[92:95], v[188:191]
    v_swap_b32 v103, v105
    v_mfma_f32_16x16x32_bf16 v[192:195], a[16:19], v[96:99], v[192:195]
    v_mfma_f32_16x16x32_bf16 a[40:43], v[92:95], v[92:95], a[40:43]
    v_mfma_f32_16x16x32_bf16 a[44:47], v[96:99], v[96:99], a[44:47]
    s_waitcnt lgkmcnt(4)
    v_mfma_f32_16x16x32_bf16 v[156:159], v[100:103], a[20:23], v[156:159]
    ds_read_b128 a[0:3], v5 offset:61440
    v_mfma_f32_16x16x32_bf16 v[160:163], v[104:107], a[20:23], v[160:163]
    buffer_load_dwordx4 v[132:135], v6, s[8:11], s28 offen sc1
    s_waitcnt lgkmcnt(4)
    v_mfma_f32_16x16x32_bf16 v[164:167], v[100:103], a[24:27], v[164:167]
    ds_read_b128 a[4:7], v5 offset:62464
    v_mfma_f32_16x16x32_bf16 v[168:171], v[104:107], a[24:27], v[168:171]
    ds_read_b128 a[8:11], v5 offset:63488
    s_waitcnt lgkmcnt(5)
    v_mfma_f32_16x16x32_bf16 v[172:175], v[100:103], a[28:31], v[172:175]
    ds_read_b128 a[12:15], v5 offset:64512
    v_mfma_f32_16x16x32_bf16 v[176:179], v[104:107], a[28:31], v[176:179]
    buffer_load_dwordx4 v[136:139], v7, s[8:11], s28 offen sc1
    s_add_u32 s28, s28, 0x20000
    s_waitcnt lgkmcnt(5)
    v_mfma_f32_16x16x32_bf16 v[180:183], v[100:103], a[32:35], v[180:183]
    ds_read_b128 a[16:19], v8 offset:0
    v_mfma_f32_16x16x32_bf16 v[184:187], v[104:107], a[32:35], v[184:187]
    s_waitcnt vmcnt(6)
    v_swap_b32 v110, v112
    s_waitcnt lgkmcnt(5)
    v_mfma_f32_16x16x32_bf16 v[188:191], a[36:39], v[100:103], v[188:191]
    v_swap_b32 v111, v113
    v_mfma_f32_16x16x32_bf16 v[192:195], a[36:39], v[104:107], v[192:195]
    v_mfma_f32_16x16x32_bf16 a[40:43], v[100:103], v[100:103], a[40:43]
    v_mfma_f32_16x16x32_bf16 a[44:47], v[104:107], v[104:107], a[44:47]
    s_waitcnt lgkmcnt(4)
    v_mfma_f32_16x16x32_bf16 v[156:159], v[108:111], a[0:3], v[156:159]
    ds_read_b128 a[20:23], v8 offset:1024
    v_mfma_f32_16x16x32_bf16 v[160:163], v[112:115], a[0:3], v[160:163]
    buffer_load_dwordx4 v[140:143], v6, s[8:11], s28 offen sc1
    s_waitcnt lgkmcnt(4)
    v_mfma_f32_16x16x32_bf16 v[164:167], v[108:111], a[4:7], v[164:167]
    ds_read_b128 a[24:27], v8 offset:2048
    v_mfma_f32_16x16x32_bf16 v[168:171], v[112:115], a[4:7], v[168:171]
    ds_read_b128 a[28:31], v8 offset:3072
    s_waitcnt lgkmcnt(5)
    v_mfma_f32_16x16x32_bf16 v[172:175], v[108:111], a[8:11], v[172:175]
    ds_read_b128 a[32:35], v8 offset:4096
    v_mfma_f32_16x16x32_bf16 v[176:179], v[112:115], a[8:11], v[176:179]
    buffer_load_dwordx4 v[144:147], v7, s[8:11], s28 offen sc1
    s_add_u32 s28, s28, 0x20000
    s_waitcnt lgkmcnt(5)
    v_mfma_f32_16x16x32_bf16 v[180:183], v[108:111], a[12:15], v[180:183]
    ds_read_b128 a[36:39], v8 offset:5120
    v_mfma_f32_16x16x32_bf16 v[184:187], v[112:115], a[12:15], v[184:187]
    s_waitcnt vmcnt(6)
    v_swap_b32 v118, v120
    s_waitcnt lgkmcnt(5)
    v_mfma_f32_16x16x32_bf16 v[188:191], a[16:19], v[108:111], v[188:191]
    v_swap_b32 v119, v121
    v_mfma_f32_16x16x32_bf16 v[192:195], a[16:19], v[112:115], v[192:195]
    v_mfma_f32_16x16x32_bf16 a[40:43], v[108:111], v[108:111], a[40:43]
    v_mfma_f32_16x16x32_bf16 a[44:47], v[112:115], v[112:115], a[44:47]
    s_waitcnt lgkmcnt(4)
    v_mfma_f32_16x16x32_bf16 v[156:159], v[116:119], a[20:23], v[156:159]
    ds_read_b128 a[0:3], v8 offset:6144
    v_mfma_f32_16x16x32_bf16 v[160:163], v[120:123], a[20:23], v[160:163]
    buffer_load_dwordx4 v[148:151], v6, s[8:11], s28 offen sc1
    s_waitcnt lgkmcnt(4)
    v_mfma_f32_16x16x32_bf16 v[164:167], v[116:119], a[24:27], v[164:167]
    ds_read_b128 a[4:7], v8 offset:7168
    v_mfma_f32_16x16x32_bf16 v[168:171], v[120:123], a[24:27], v[168:171]
    ds_read_b128 a[8:11], v8 offset:8192
    s_waitcnt lgkmcnt(5)
    v_mfma_f32_16x16x32_bf16 v[172:175], v[116:119], a[28:31], v[172:175]
    ds_read_b128 a[12:15], v8 offset:9216
    v_mfma_f32_16x16x32_bf16 v[176:179], v[120:123], a[28:31], v[176:179]
    buffer_load_dwordx4 v[152:155], v7, s[8:11], s28 offen sc1
    s_add_u32 s28, s28, 0x20000
    s_waitcnt lgkmcnt(5)
    v_mfma_f32_16x16x32_bf16 v[180:183], v[116:119], a[32:35], v[180:183]
    ds_read_b128 a[16:19], v8 offset:10240
    v_mfma_f32_16x16x32_bf16 v[184:187], v[120:123], a[32:35], v[184:187]
    s_waitcnt vmcnt(6)
    v_swap_b32 v126, v128
    s_waitcnt lgkmcnt(5)
    v_mfma_f32_16x16x32_bf16 v[188:191], a[36:39], v[116:119], v[188:191]
    v_swap_b32 v127, v129
    v_mfma_f32_16x16x32_bf16 v[192:195], a[36:39], v[120:123], v[192:195]
    v_mfma_f32_16x16x32_bf16 a[40:43], v[116:119], v[116:119], a[40:43]
    v_mfma_f32_16x16x32_bf16 a[44:47], v[120:123], v[120:123], a[44:47]
    s_waitcnt lgkmcnt(4)
    v_mfma_f32_16x16x32_bf16 v[156:159], v[124:127], a[0:3], v[156:159]
    ds_read_b128 a[20:23], v8 offset:11264
    v_mfma_f32_16x16x32_bf16 v[160:163], v[128:131], a[0:3], v[160:163]
    ds_read_b128 a[24:27], v8 offset:12288
    s_waitcnt lgkmcnt(5)
    v_mfma_f32_16x16x32_bf16 v[164:167], v[124:127], a[4:7], v[164:167]
    ds_read_b128 a[28:31], v8 offset:13312
    v_mfma_f32_16x16x32_bf16 v[168:171], v[128:131], a[4:7], v[168:171]
    ds_read_b128 a[32:35], v8 offset:14336
    s_waitcnt lgkmcnt(6)
    v_mfma_f32_16x16x32_bf16 v[172:175], v[124:127], a[8:11], v[172:175]
    ds_read_b128 a[36:39], v8 offset:15360
    v_mfma_f32_16x16x32_bf16 v[176:179], v[128:131], a[8:11], v[176:179]
    s_waitcnt vmcnt(4)
    v_swap_b32 v134, v136
    s_waitcnt lgkmcnt(6)
    v_mfma_f32_16x16x32_bf16 v[180:183], v[124:127], a[12:15], v[180:183]
    v_swap_b32 v135, v137
    v_mfma_f32_16x16x32_bf16 v[184:187], v[128:131], a[12:15], v[184:187]
    s_waitcnt lgkmcnt(5)
    v_mfma_f32_16x16x32_bf16 v[188:191], a[16:19], v[124:127], v[188:191]
    v_mfma_f32_16x16x32_bf16 v[192:195], a[16:19], v[128:131], v[192:195]
    v_mfma_f32_16x16x32_bf16 a[40:43], v[124:127], v[124:127], a[40:43]
    v_mfma_f32_16x16x32_bf16 a[44:47], v[128:131], v[128:131], a[44:47]
    s_barrier
    s_waitcnt lgkmcnt(4)
    v_mfma_f32_16x16x32_bf16 v[156:159], v[132:135], a[20:23], v[156:159]
    ds_read_b128 a[0:3], v8 offset:16384
    v_mfma_f32_16x16x32_bf16 v[160:163], v[136:139], a[20:23], v[160:163]
    ds_read_b128 a[4:7], v8 offset:17408
    s_waitcnt lgkmcnt(5)
    v_mfma_f32_16x16x32_bf16 v[164:167], v[132:135], a[24:27], v[164:167]
    ds_read_b128 a[8:11], v8 offset:18432
    v_mfma_f32_16x16x32_bf16 v[168:171], v[136:139], a[24:27], v[168:171]
    ds_read_b128 a[12:15], v8 offset:19456
    s_waitcnt lgkmcnt(6)
    v_mfma_f32_16x16x32_bf16 v[172:175], v[132:135], a[28:31], v[172:175]
    ds_read_b128 a[16:19], v8 offset:20480
    v_mfma_f32_16x16x32_bf16 v[176:179], v[136:139], a[28:31], v[176:179]
    s_waitcnt vmcnt(2)
    v_swap_b32 v142, v144
    s_waitcnt lgkmcnt(6)
    v_mfma_f32_16x16x32_bf16 v[180:183], v[132:135], a[32:35], v[180:183]
    v_swap_b32 v143, v145
    v_mfma_f32_16x16x32_bf16 v[184:187], v[136:139], a[32:35], v[184:187]
    s_waitcnt lgkmcnt(5)
    v_mfma_f32_16x16x32_bf16 v[188:191], a[36:39], v[132:135], v[188:191]
    v_mfma_f32_16x16x32_bf16 v[192:195], a[36:39], v[136:139], v[192:195]
    v_mfma_f32_16x16x32_bf16 a[40:43], v[132:135], v[132:135], a[40:43]
    v_mfma_f32_16x16x32_bf16 a[44:47], v[136:139], v[136:139], a[44:47]
    s_waitcnt lgkmcnt(4)
    v_mfma_f32_16x16x32_bf16 v[156:159], v[140:143], a[0:3], v[156:159]
    ds_read_b128 a[20:23], v8 offset:21504
    v_mfma_f32_16x16x32_bf16 v[160:163], v[144:147], a[0:3], v[160:163]
    ds_read_b128 a[24:27], v8 offset:22528
    s_waitcnt lgkmcnt(5)
    v_mfma_f32_16x16x32_bf16 v[164:167], v[140:143], a[4:7], v[164:167]
    ds_read_b128 a[28:31], v8 offset:23552
    v_mfma_f32_16x16x32_bf16 v[168:171], v[144:147], a[4:7], v[168:171]
    ds_read_b128 a[32:35], v8 offset:24576
    s_waitcnt lgkmcnt(6)
    v_mfma_f32_16x16x32_bf16 v[172:175], v[140:143], a[8:11], v[172:175]
    ds_read_b128 a[36:39], v8 offset:25600
    v_mfma_f32_16x16x32_bf16 v[176:179], v[144:147], a[8:11], v[176:179]
    s_waitcnt vmcnt(0)
    v_swap_b32 v150, v152
    s_waitcnt lgkmcnt(6)
    v_mfma_f32_16x16x32_bf16 v[180:183], v[140:143], a[12:15], v[180:183]
    v_swap_b32 v151, v153
    v_mfma_f32_16x16x32_bf16 v[184:187], v[144:147], a[12:15], v[184:187]
    s_waitcnt lgkmcnt(5)
    v_mfma_f32_16x16x32_bf16 v[188:191], a[16:19], v[140:143], v[188:191]
    v_mfma_f32_16x16x32_bf16 v[192:195], a[16:19], v[144:147], v[192:195]
    v_mfma_f32_16x16x32_bf16 a[40:43], v[140:143], v[140:143], a[40:43]
    v_mfma_f32_16x16x32_bf16 a[44:47], v[144:147], v[144:147], a[44:47]
    s_waitcnt lgkmcnt(4)
    v_mfma_f32_16x16x32_bf16 v[156:159], v[148:151], a[20:23], v[156:159]
    v_mfma_f32_16x16x32_bf16 v[160:163], v[152:155], a[20:23], v[160:163]
    s_waitcnt lgkmcnt(3)
    v_mfma_f32_16x16x32_bf16 v[164:167], v[148:151], a[24:27], v[164:167]
    v_mfma_f32_16x16x32_bf16 v[168:171], v[152:155], a[24:27], v[168:171]
    s_waitcnt lgkmcnt(2)
    v_mfma_f32_16x16x32_bf16 v[172:175], v[148:151], a[28:31], v[172:175]
    v_mfma_f32_16x16x32_bf16 v[176:179], v[152:155], a[28:31], v[176:179]
    s_waitcnt lgkmcnt(1)
    v_mfma_f32_16x16x32_bf16 v[180:183], v[148:151], a[32:35], v[180:183]
    v_mfma_f32_16x16x32_bf16 v[184:187], v[152:155], a[32:35], v[184:187]
    s_waitcnt lgkmcnt(0)
    v_mfma_f32_16x16x32_bf16 v[188:191], a[36:39], v[148:151], v[188:191]
    v_mfma_f32_16x16x32_bf16 v[192:195], a[36:39], v[152:155], v[192:195]
    v_mfma_f32_16x16x32_bf16 a[40:43], v[148:151], v[148:151], a[40:43]
    v_mfma_f32_16x16x32_bf16 a[44:47], v[152:155], v[152:155], a[44:47]
    ds_read_b128 a[16:19], v8 offset:26624
    ds_read_b128 a[20:23], v8 offset:27648
    ds_read_b128 a[24:27], v8 offset:28672
    ds_read_b128 a[28:31], v8 offset:29696
    ds_read_b128 a[32:35], v8 offset:30720
    ds_read_b128 a[36:39], v8 offset:31744
    s_nop 0
    v_accvgpr_read_b32 v204, a40
    v_accvgpr_read_b32 v205, a41
    v_accvgpr_read_b32 v206, a42
    v_accvgpr_read_b32 v207, a43
    v_cndmask_b32 v196, v204, v205, s[32:33]
    v_cndmask_b32 v196, v196, v206, s[34:35]
    v_cndmask_b32 v196, v196, v207, s[46:47]
    v_accvgpr_read_b32 v204, a44
    v_accvgpr_read_b32 v205, a45
    v_accvgpr_read_b32 v206, a46
    v_accvgpr_read_b32 v207, a47
    v_cndmask_b32 v197, v204, v205, s[32:33]
    v_cndmask_b32 v197, v197, v206, s[34:35]
    v_cndmask_b32 v197, v197, v207, s[46:47]
    v_mov_b32 v3, 0x3727c5ac
    v_lshrrev_b32 v10, 2, v1
    v_lshl_add_u32 v10, v10, 4, v1
    v_lshlrev_b32 v10, 2, v10
    v_mul_u32_u24 v4, 80, v2
    v_fma_f32 v196, v196, s36, v3
    v_fma_f32 v197, v197, s36, v3
    v_rsq_f32 v196, v196
    v_rsq_f32 v197, v197
    s_waitcnt lgkmcnt(5)
    v_mfma_f32_16x16x32_bf16 a[0:3], a[16:19], v[12:15], 0
    v_mfma_f32_16x16x32_bf16 a[4:7], a[16:19], v[16:19], 0
    ds_read_b128 a[16:19], v8 offset:32768
    s_waitcnt lgkmcnt(5)
    v_mfma_f32_16x16x32_bf16 a[8:11], a[20:23], v[12:15], 0
    v_mfma_f32_16x16x32_bf16 a[12:15], a[20:23], v[16:19], 0
    ds_read_b128 a[20:23], v8 offset:33792
    ds_bpermute_b32 v12, v4, v196 offset:0
    ds_bpermute_b32 v13, v4, v196 offset:4
    ds_bpermute_b32 v14, v4, v196 offset:8
    ds_bpermute_b32 v15, v4, v196 offset:12
    ds_bpermute_b32 v16, v4, v197 offset:0
    ds_bpermute_b32 v17, v4, v197 offset:4
    ds_bpermute_b32 v18, v4, v197 offset:8
    ds_bpermute_b32 v19, v4, v197 offset:12
    ds_bpermute_b32 v196, v10, v196
    ds_bpermute_b32 v197, v10, v197
    v_lshlrev_b32 v6, 5, v1
    v_lshl_add_u32 v6, v2, 3, v6
    v_add_u32 v6, s52, v6
    v_add_u32 v7, s53, v5
    s_waitcnt lgkmcnt(15)
    v_mfma_f32_16x16x32_bf16 a[0:3], a[24:27], v[20:23], a[0:3]
    v_mov_b32 v3, 0x3f803f80
    s_waitcnt lgkmcnt(1)
    v_fma_f32 v188, v188, v196, v199
    v_fma_f32 v189, v189, v196, v199
    v_fma_f32 v190, v190, v196, v199
    v_fma_f32 v191, v191, v196, v199
    v_mul_f32 v204, s37, v188
    v_mfma_f32_16x16x32_bf16 a[4:7], a[24:27], v[24:27], a[4:7]
    ds_read_b128 a[24:27], v8 offset:34816
    v_mul_f32 v205, s37, v189
    v_mul_f32 v206, s37, v190
    v_mul_f32 v207, s37, v191
    v_exp_f32 v204, v204 clamp
    v_exp_f32 v205, v205 clamp
    v_exp_f32 v206, v206 clamp
    v_mfma_f32_16x16x32_bf16 a[8:11], a[28:31], v[20:23], a[8:11]
    v_exp_f32 v207, v207 clamp
    v_max_f32 v188, v188, v200
    v_max_f32 v189, v189, v200
    v_max_f32 v190, v190, v200
    v_max_f32 v191, v191, v200
    v_fmac_f32 v188, v204, v201
    v_mfma_f32_16x16x32_bf16 a[12:15], a[28:31], v[24:27], a[12:15]
    ds_read_b128 a[28:31], v8 offset:35840
    v_fmac_f32 v189, v205, v201
    v_fmac_f32 v190, v206, v201
    v_fmac_f32 v191, v207, v201
    v_cvt_pk_bf16_f32 v188, v188, v189
    v_cvt_pk_bf16_f32 v189, v190, v191
    v_cndmask_b32 v188, v188, v3, s[68:69]
    v_mfma_f32_16x16x32_bf16 a[0:3], a[32:35], v[28:31], a[0:3]
    v_cndmask_b32 v189, v189, v3, s[68:69]
    ds_write_b64 v6, v[188:189] offset:0
    s_waitcnt lgkmcnt(3)
    v_fma_f32 v192, v192, v197, v199
    v_fma_f32 v193, v193, v197, v199
    v_fma_f32 v194, v194, v197, v199
    v_fma_f32 v195, v195, v197, v199
    v_mfma_f32_16x16x32_bf16 a[4:7], a[32:35], v[32:35], a[4:7]
    ds_read_b128 a[32:35], v8 offset:36864
    v_mul_f32 v204, s37, v192
    v_mul_f32 v205, s37, v193
    v_mul_f32 v206, s37, v194
    v_mul_f32 v207, s37, v195
    v_exp_f32 v204, v204 clamp
    v_exp_f32 v205, v205 clamp
    v_mfma_f32_16x16x32_bf16 a[8:11], a[36:39], v[28:31], a[8:11]
    v_exp_f32 v206, v206 clamp
    v_exp_f32 v207, v207 clamp
    v_max_f32 v192, v192, v200
    v_max_f32 v193, v193, v200
    v_max_f32 v194, v194, v200
    v_max_f32 v195, v195, v200
    v_mfma_f32_16x16x32_bf16 a[12:15], a[36:39], v[32:35], a[12:15]
    ds_read_b128 a[36:39], v8 offset:37888
    v_fmac_f32 v192, v204, v201
    v_fmac_f32 v193, v205, v201
    v_fmac_f32 v194, v206, v201
    v_fmac_f32 v195, v207, v201
    v_cvt_pk_bf16_f32 v190, v192, v193
    v_cvt_pk_bf16_f32 v191, v194, v195
    v_mfma_f32_16x16x32_bf16 a[0:3], a[16:19], v[36:39], a[0:3]
    v_cndmask_b32 v190, v190, v3, s[68:69]
    v_cndmask_b32 v191, v191, v3, s[68:69]
    ds_write_b64 v6, v[190:191] offset:512
    v_mul_f32 v172, v172, v12
    v_mul_f32 v173, v173, v13
    v_mul_f32 v174, v174, v14
    v_mfma_f32_16x16x32_bf16 a[4:7], a[16:19], v[40:43], a[4:7]
    ds_read_b128 a[16:19], v8 offset:38912
    v_mul_f32 v175, v175, v15
    v_cvt_pk_bf16_f32 v172, v172, v173
    v_cvt_pk_bf16_f32 v173, v174, v175
    v_mul_f32 v176, v176, v16
    v_mul_f32 v177, v177, v17
    v_mul_f32 v178, v178, v18
    v_mfma_f32_16x16x32_bf16 a[8:11], a[20:23], v[36:39], a[8:11]
    v_mul_f32 v179, v179, v19
    v_cvt_pk_bf16_f32 v174, v176, v177
    v_cvt_pk_bf16_f32 v175, v178, v179
    ds_write_b128 v7, v[172:175] offset:2048
    v_mul_f32 v180, v180, v12
    v_mul_f32 v181, v181, v13
    v_mfma_f32_16x16x32_bf16 a[12:15], a[20:23], v[40:43], a[12:15]
    ds_read_b128 a[20:23], v8 offset:39936
    v_mul_f32 v182, v182, v14
    v_mul_f32 v183, v183, v15
    v_cvt_pk_bf16_f32 v180, v180, v181
    v_cvt_pk_bf16_f32 v181, v182, v183
    v_mul_f32 v184, v184, v16
    v_mul_f32 v185, v185, v17
    s_waitcnt lgkmcnt(8)
    v_mfma_f32_16x16x32_bf16 a[0:3], a[24:27], v[44:47], a[0:3]
    v_mul_f32 v186, v186, v18
    v_mul_f32 v187, v187, v19
    v_cvt_pk_bf16_f32 v182, v184, v185
    v_cvt_pk_bf16_f32 v183, v186, v187
    ds_write_b128 v7, v[180:183] offset:3072
    v_fma_f32 v156, v156, v12, v198
    v_mfma_f32_16x16x32_bf16 a[4:7], a[24:27], v[48:51], a[4:7]
    ds_read_b128 a[24:27], v8 offset:40960
    v_fma_f32 v157, v157, v13, v198
    v_fma_f32 v158, v158, v14, v198
    v_fma_f32 v159, v159, v15, v198
    v_mul_f32 v204, s37, v156
    v_mul_f32 v205, s37, v157
    v_mul_f32 v206, s37, v158
    s_waitcnt lgkmcnt(9)
    v_mfma_f32_16x16x32_bf16 a[8:11], a[28:31], v[44:47], a[8:11]
    v_mul_f32 v207, s37, v159
    v_exp_f32 v204, v204 clamp
    v_exp_f32 v205, v205 clamp
    v_exp_f32 v206, v206 clamp
    v_exp_f32 v207, v207 clamp
    v_max_f32 v156, v156, v198
    v_mfma_f32_16x16x32_bf16 a[12:15], a[28:31], v[48:51], a[12:15]
    ds_read_b128 a[28:31], v8 offset:41984
    v_max_f32 v157, v157, v198
    v_max_f32 v158, v158, v198
    v_max_f32 v159, v159, v198
    v_add_f32 v156, v156, v204
    v_add_f32 v157, v157, v205
    v_add_f32 v158, v158, v206
    s_waitcnt lgkmcnt(8)
    v_mfma_f32_16x16x32_bf16 a[0:3], a[32:35], v[52:55], a[0:3]
    v_add_f32 v159, v159, v207
    v_cvt_pk_bf16_f32 v156, v156, v157
    v_cvt_pk_bf16_f32 v157, v158, v159
    v_fma_f32 v160, v160, v16, v198
    v_fma_f32 v161, v161, v17, v198
    v_fma_f32 v162, v162, v18, v198
    v_mfma_f32_16x16x32_bf16 a[4:7], a[32:35], v[56:59], a[4:7]
    ds_read_b128 a[32:35], v8 offset:43008
    v_fma_f32 v163, v163, v19, v198
    v_mul_f32 v204, s37, v160
    v_mul_f32 v205, s37, v161
    v_mul_f32 v206, s37, v162
    v_mul_f32 v207, s37, v163
    v_exp_f32 v204, v204 clamp
    s_waitcnt lgkmcnt(8)
    v_mfma_f32_16x16x32_bf16 a[8:11], a[36:39], v[52:55], a[8:11]
    v_exp_f32 v205, v205 clamp
    v_exp_f32 v206, v206 clamp
    v_exp_f32 v207, v207 clamp
    v_max_f32 v160, v160, v198
    v_max_f32 v161, v161, v198
    v_max_f32 v162, v162, v198
    v_mfma_f32_16x16x32_bf16 a[12:15], a[36:39], v[56:59], a[12:15]
    ds_read_b128 a[36:39], v8 offset:44032
    v_max_f32 v163, v163, v198
    v_add_f32 v160, v160, v204
    v_add_f32 v161, v161, v205
    v_add_f32 v162, v162, v206
    v_add_f32 v163, v163, v207
    v_cvt_pk_bf16_f32 v158, v160, v161
    s_waitcnt lgkmcnt(7)
    v_mfma_f32_16x16x32_bf16 a[0:3], a[16:19], v[60:63], a[0:3]
    v_cvt_pk_bf16_f32 v159, v162, v163
    ds_write_b128 v7, v[156:159] offset:0
    v_fma_f32 v164, v164, v12, v198
    v_fma_f32 v165, v165, v13, v198
    v_fma_f32 v166, v166, v14, v198
    v_fma_f32 v167, v167, v15, v198
    v_mfma_f32_16x16x32_bf16 a[4:7], a[16:19], v[64:67], a[4:7]
    ds_read_b128 a[16:19], v8 offset:45056
    v_mul_f32 v204, s37, v164
    v_mul_f32 v205, s37, v165
    v_mul_f32 v206, s37, v166
    v_mul_f32 v207, s37, v167
    v_exp_f32 v204, v204 clamp
    v_exp_f32 v205, v205 clamp
    s_waitcnt lgkmcnt(7)
    v_mfma_f32_16x16x32_bf16 a[8:11], a[20:23], v[60:63], a[8:11]
    v_exp_f32 v206, v206 clamp
    v_exp_f32 v207, v207 clamp
    v_max_f32 v164, v164, v198
    v_max_f32 v165, v165, v198
    v_max_f32 v166, v166, v198
    v_max_f32 v167, v167, v198
    v_mfma_f32_16x16x32_bf16 a[12:15], a[20:23], v[64:67], a[12:15]
    ds_read_b128 a[20:23], v8 offset:46080
    v_add_f32 v164, v164, v204
    v_add_f32 v165, v165, v205
    v_add_f32 v166, v166, v206
    v_add_f32 v167, v167, v207
    v_cvt_pk_bf16_f32 v164, v164, v165
    v_cvt_pk_bf16_f32 v165, v166, v167
    s_waitcnt lgkmcnt(6)
    v_mfma_f32_16x16x32_bf16 a[0:3], a[24:27], v[68:71], a[0:3]
    v_fma_f32 v168, v168, v16, v198
    v_fma_f32 v169, v169, v17, v198
    v_fma_f32 v170, v170, v18, v198
    v_fma_f32 v171, v171, v19, v198
    v_mul_f32 v204, s37, v168
    v_mul_f32 v205, s37, v169
    v_mfma_f32_16x16x32_bf16 a[4:7], a[24:27], v[72:75], a[4:7]
    ds_read_b128 a[24:27], v8 offset:47104
    v_mul_f32 v206, s37, v170
    v_mul_f32 v207, s37, v171
    v_exp_f32 v204, v204 clamp
    v_exp_f32 v205, v205 clamp
    v_exp_f32 v206, v206 clamp
    v_exp_f32 v207, v207 clamp
    s_waitcnt lgkmcnt(6)
    v_mfma_f32_16x16x32_bf16 a[8:11], a[28:31], v[68:71], a[8:11]
    v_max_f32 v168, v168, v198
    v_max_f32 v169, v169, v198
    v_max_f32 v170, v170, v198
    v_max_f32 v171, v171, v198
    v_add_f32 v168, v168, v204
    v_add_f32 v169, v169, v205
    v_mfma_f32_16x16x32_bf16 a[12:15], a[28:31], v[72:75], a[12:15]
    ds_read_b128 a[28:31], v8 offset:48128
    v_add_f32 v170, v170, v206
    v_add_f32 v171, v171, v207
    v_cvt_pk_bf16_f32 v166, v168, v169
    v_cvt_pk_bf16_f32 v167, v170, v171
    ds_write_b128 v7, v[164:167] offset:1024
    s_waitcnt lgkmcnt(0)
    s_barrier
    v_and_b32 v3, 1, v2
    v_mfma_f32_16x16x32_bf16 a[0:3], a[32:35], v[76:79], a[0:3]
    v_lshrrev_b32 v10, 1, v2
    v_mfma_f32_16x16x32_bf16 a[4:7], a[32:35], v[80:83], a[4:7]
    ds_read_b128 a[32:35], v8 offset:49152
    v_lshlrev_b32 v7, 4, v1
    v_mfma_f32_16x16x32_bf16 a[8:11], a[36:39], v[76:79], a[8:11]
    v_lshl_add_u32 v3, v3, 10, v7
    v_mfma_f32_16x16x32_bf16 a[12:15], a[36:39], v[80:83], a[12:15]
    ds_read_b128 a[36:39], v8 offset:50176
    v_lshl_add_u32 v6, v10, 9, v3
    v_mfma_f32_16x16x32_bf16 a[0:3], a[16:19], v[84:87], a[0:3]
    v_mov_b32 v4, 0x40000000
    v_mfma_f32_16x16x32_bf16 a[4:7], a[16:19], v[88:91], a[4:7]
    ds_read_b128 a[16:19], v8 offset:51200
    v_cmp_eq_u32 vcc, 2, v2
    v_mfma_f32_16x16x32_bf16 a[8:11], a[20:23], v[84:87], a[8:11]
    s_nop 0
    v_cndmask_b32 v7, v4, v7, vcc
    v_mfma_f32_16x16x32_bf16 a[12:15], a[20:23], v[88:91], a[12:15]
    ds_read_b128 a[20:23], v8 offset:52224
    buffer_store_dwordx2 v[188:189], v7, s[16:19], s50 offen sc1
    buffer_store_dwordx2 v[190:191], v7, s[16:19], s51 offen sc1
    v_mfma_f32_16x16x32_bf16 a[0:3], a[24:27], v[92:95], a[0:3]
    v_mfma_f32_16x16x32_bf16 a[4:7], a[24:27], v[96:99], a[4:7]
    ds_read_b128 a[24:27], v8 offset:53248
    v_mfma_f32_16x16x32_bf16 a[8:11], a[28:31], v[92:95], a[8:11]
    v_mfma_f32_16x16x32_bf16 a[12:15], a[28:31], v[96:99], a[12:15]
    ds_read_b128 a[28:31], v8 offset:54272
    s_waitcnt lgkmcnt(5)
    v_mfma_f32_16x16x32_bf16 a[0:3], a[32:35], v[100:103], a[0:3]
    v_mfma_f32_16x16x32_bf16 a[4:7], a[32:35], v[104:107], a[4:7]
    ds_read_b128 a[32:35], v8 offset:55296
    s_waitcnt lgkmcnt(5)
    v_mfma_f32_16x16x32_bf16 a[8:11], a[36:39], v[100:103], a[8:11]
    v_mfma_f32_16x16x32_bf16 a[12:15], a[36:39], v[104:107], a[12:15]
    ds_read_b128 a[36:39], v8 offset:56320
    s_waitcnt lgkmcnt(5)
    v_mfma_f32_16x16x32_bf16 a[0:3], a[16:19], v[108:111], a[0:3]
    v_mfma_f32_16x16x32_bf16 a[4:7], a[16:19], v[112:115], a[4:7]
    ds_read_b128 a[16:19], v8 offset:57344
    s_waitcnt lgkmcnt(5)
    v_mfma_f32_16x16x32_bf16 a[8:11], a[20:23], v[108:111], a[8:11]
    v_mfma_f32_16x16x32_bf16 a[12:15], a[20:23], v[112:115], a[12:15]
    ds_read_b128 a[20:23], v8 offset:58368
    s_waitcnt lgkmcnt(5)
    v_mfma_f32_16x16x32_bf16 a[0:3], a[24:27], v[116:119], a[0:3]
    v_mfma_f32_16x16x32_bf16 a[4:7], a[24:27], v[120:123], a[4:7]
    ds_read_b128 a[24:27], v8 offset:59392
    s_waitcnt lgkmcnt(5)
    v_mfma_f32_16x16x32_bf16 a[8:11], a[28:31], v[116:119], a[8:11]
    v_mfma_f32_16x16x32_bf16 a[12:15], a[28:31], v[120:123], a[12:15]
    ds_read_b128 a[28:31], v8 offset:60416
    s_waitcnt lgkmcnt(5)
    v_mfma_f32_16x16x32_bf16 a[0:3], a[32:35], v[124:127], a[0:3]
    v_mfma_f32_16x16x32_bf16 a[4:7], a[32:35], v[128:131], a[4:7]
    ds_read_b128 a[32:35], v8 offset:61440
    s_waitcnt lgkmcnt(5)
    v_mfma_f32_16x16x32_bf16 a[8:11], a[36:39], v[124:127], a[8:11]
    v_mfma_f32_16x16x32_bf16 a[12:15], a[36:39], v[128:131], a[12:15]
    ds_read_b128 a[36:39], v8 offset:62464
    s_waitcnt lgkmcnt(5)
    v_mfma_f32_16x16x32_bf16 a[0:3], a[16:19], v[132:135], a[0:3]
    v_mfma_f32_16x16x32_bf16 a[4:7], a[16:19], v[136:139], a[4:7]
    s_waitcnt lgkmcnt(4)
    v_mfma_f32_16x16x32_bf16 a[8:11], a[20:23], v[132:135], a[8:11]
    v_mfma_f32_16x16x32_bf16 a[12:15], a[20:23], v[136:139], a[12:15]
    s_waitcnt lgkmcnt(3)
    v_mfma_f32_16x16x32_bf16 a[0:3], a[24:27], v[140:143], a[0:3]
    v_mfma_f32_16x16x32_bf16 a[4:7], a[24:27], v[144:147], a[4:7]
    s_waitcnt lgkmcnt(2)
    v_mfma_f32_16x16x32_bf16 a[8:11], a[28:31], v[140:143], a[8:11]
    v_mfma_f32_16x16x32_bf16 a[12:15], a[28:31], v[144:147], a[12:15]
    s_waitcnt lgkmcnt(1)
    v_mfma_f32_16x16x32_bf16 a[0:3], a[32:35], v[148:151], a[0:3]
    v_mfma_f32_16x16x32_bf16 a[4:7], a[32:35], v[152:155], a[4:7]
    s_waitcnt lgkmcnt(0)
    v_mfma_f32_16x16x32_bf16 a[8:11], a[36:39], v[148:151], a[8:11]
    v_mfma_f32_16x16x32_bf16 a[12:15], a[36:39], v[152:155], a[12:15]
    s_nop 3
    v_accvgpr_read_b32 v156, a0
    v_accvgpr_read_b32 v157, a1
    v_accvgpr_read_b32 v158, a2
    v_accvgpr_read_b32 v159, a3
    v_fma_f32 v156, v156, v196, v198
    v_fma_f32 v157, v157, v196, v198
    v_fma_f32 v158, v158, v196, v198
    v_fma_f32 v159, v159, v196, v198
    v_mul_f32 v204, s37, v156
    v_mul_f32 v205, s37, v157
    v_mul_f32 v206, s37, v158
    v_mul_f32 v207, s37, v159
    v_exp_f32 v204, v204 clamp
    v_exp_f32 v205, v205 clamp
    v_exp_f32 v206, v206 clamp
    v_exp_f32 v207, v207 clamp
    v_max_f32 v156, v156, v198
    v_max_f32 v157, v157, v198
    v_max_f32 v158, v158, v198
    v_max_f32 v159, v159, v198
    v_add_f32 v156, v156, v204
    v_add_f32 v157, v157, v205
    v_add_f32 v158, v158, v206
    v_add_f32 v159, v159, v207
    v_cvt_pk_bf16_f32 v156, v156, v157
    v_cvt_pk_bf16_f32 v157, v158, v159
    v_accvgpr_read_b32 v160, a8
    v_accvgpr_read_b32 v161, a9
    v_accvgpr_read_b32 v162, a10
    v_accvgpr_read_b32 v163, a11
    v_fma_f32 v160, v160, v196, v198
    v_fma_f32 v161, v161, v196, v198
    v_fma_f32 v162, v162, v196, v198
    v_fma_f32 v163, v163, v196, v198
    v_mul_f32 v204, s37, v160
    v_mul_f32 v205, s37, v161
    v_mul_f32 v206, s37, v162
    v_mul_f32 v207, s37, v163
    v_exp_f32 v204, v204 clamp
    v_exp_f32 v205, v205 clamp
    v_exp_f32 v206, v206 clamp
    v_exp_f32 v207, v207 clamp
    v_max_f32 v160, v160, v198
    v_max_f32 v161, v161, v198
    v_max_f32 v162, v162, v198
    v_max_f32 v163, v163, v198
    v_add_f32 v160, v160, v204
    v_add_f32 v161, v161, v205
    v_add_f32 v162, v162, v206
    v_add_f32 v163, v163, v207
    v_cvt_pk_bf16_f32 v158, v160, v161
    v_cvt_pk_bf16_f32 v159, v162, v163
    s_nop 0
    v_permlane16_swap_b32 v156, v158
    v_permlane16_swap_b32 v157, v159
    buffer_store_dwordx4 v[156:159], v6, s[16:19], s48 offen sc1
    v_accvgpr_read_b32 v164, a4
    v_accvgpr_read_b32 v165, a5
    v_accvgpr_read_b32 v166, a6
    v_accvgpr_read_b32 v167, a7
    v_fma_f32 v164, v164, v197, v198
    v_fma_f32 v165, v165, v197, v198
    v_fma_f32 v166, v166, v197, v198
    v_fma_f32 v167, v167, v197, v198
    v_mul_f32 v204, s37, v164
    v_mul_f32 v205, s37, v165
    v_mul_f32 v206, s37, v166
    v_mul_f32 v207, s37, v167
    v_exp_f32 v204, v204 clamp
    v_exp_f32 v205, v205 clamp
    v_exp_f32 v206, v206 clamp
    v_exp_f32 v207, v207 clamp
    v_max_f32 v164, v164, v198
    v_max_f32 v165, v165, v198
    v_max_f32 v166, v166, v198
    v_max_f32 v167, v167, v198
    v_add_f32 v164, v164, v204
    v_add_f32 v165, v165, v205
    v_add_f32 v166, v166, v206
    v_add_f32 v167, v167, v207
    v_cvt_pk_bf16_f32 v164, v164, v165
    v_cvt_pk_bf16_f32 v165, v166, v167
    v_accvgpr_read_b32 v168, a12
    v_accvgpr_read_b32 v169, a13
    v_accvgpr_read_b32 v170, a14
    v_accvgpr_read_b32 v171, a15
    v_fma_f32 v168, v168, v197, v198
    v_fma_f32 v169, v169, v197, v198
    v_fma_f32 v170, v170, v197, v198
    v_fma_f32 v171, v171, v197, v198
    v_mul_f32 v204, s37, v168
    v_mul_f32 v205, s37, v169
    v_mul_f32 v206, s37, v170
    v_mul_f32 v207, s37, v171
    v_exp_f32 v204, v204 clamp
    v_exp_f32 v205, v205 clamp
    v_exp_f32 v206, v206 clamp
    v_exp_f32 v207, v207 clamp
    v_max_f32 v168, v168, v198
    v_max_f32 v169, v169, v198
    v_max_f32 v170, v170, v198
    v_max_f32 v171, v171, v198
    v_add_f32 v168, v168, v204
    v_add_f32 v169, v169, v205
    v_add_f32 v170, v170, v206
    v_add_f32 v171, v171, v207
    v_cvt_pk_bf16_f32 v166, v168, v169
    v_cvt_pk_bf16_f32 v167, v170, v171
    s_nop 0
    v_permlane16_swap_b32 v164, v166
    v_permlane16_swap_b32 v165, v167
    buffer_store_dwordx4 v[164:167], v6, s[16:19], s49 offen sc1
    s_waitcnt vmcnt(0)
    s_branch L_b3_done
L_b3_help:
    s_add_u32 s32, s4, 0x1348000
    s_addc_u32 s33, s5, 0
    s_mov_b32 s34, 0xb000
    s_mov_b32 s35, 0x20000
    v_mov_b32 v4, 0x40000000
    s_lshl_b32 s29, s30, 10
    s_add_u32 s29, s29, 131072
    v_add_u32 v6, s29, v5
    v_lshlrev_b32 v7, 3, v1
    v_lshl_add_u32 v7, v2, 7, v7
    v_add_u32 v7, 147456, v7
    s_cmp_lt_u32 s24, 2
    s_cselect_b64 s[70:71], -1, 0
    s_cselect_b32 s48, 6, 3
    s_cmp_eq_u32 s30, 1
    s_cselect_b64 s[46:47], -1, 0
    s_lshl_b32 s29, s23, 1
    s_add_u32 s29, s29, s30
    s_mul_i32 s29, s29, 1408
    v_and_b32 v3, 1, v1
    v_lshlrev_b32 v3, 2, v3
    v_add_u32 v3, 1216, v3
    v_lshrrev_b32 v8, 1, v1
    v_cmp_eq_u32 vcc, s30, v8
    s_nop 1
    v_cndmask_b32 v3, v4, v3, vcc
    v_lshlrev_b32 v8, 2, v1
    v_cndmask_b32 v8, v3, v8, s[70:71]
    v_add_u32 v8, s29, v8
    s_lshl_b32 s49, 4, s48
    s_lshl_b32 s50, 8, s48
    s_lshl_b32 s51, 12, s48
    s_lshl_b32 s52, 16, s48
    s_lshl_b32 s53, 17, s48
    s_lshl_b32 s54, 18, s48
    v_lshlrev_b32 v9, s48, v2
    v_add_u32 v9, v9, v8
    v_add_u32 v11, s53, v8
    v_cndmask_b32 v11, v4, v11, s[58:59]
    v_add_u32 v10, s54, v8
    v_cndmask_b32 v10, v4, v10, s[68:69]
    v_add_u32 v3, s52, v8
    v_cndmask_b32 v10, v10, v3, s[58:59]
    v_mov_b32 v1, v9
    v_mov_b32 v2, v10
    v_mov_b32 v5, v11
    s_cmp_ge_u32 s2, 192
    s_cbranch_scc1 L_q_pre
    v_and_b32 v14, 31, v0
    v_bfe_u32 v15, v0, 5, 1
    s_mov_b32 s8, 0x3ae38e39
    s_mov_b32 s9, 0x3d715bef
    s_mov_b32 s10, 0xc4100000
    s_mul_i32 s11, s24, 72
    v_lshlrev_b32 v16, 2, v15
    v_add_u32 v16, s11, v16
    v_cvt_f32_u32 v21, v16
    v_and_b32 v16, 1, v14
    v_lshlrev_b32 v16, 15, v16
    v_or_b32 v22, 0x3d2b3d2b, v16
    s_cmp_eq_u32 s24, 0
    s_cselect_b32 s12, -1, 0
    s_mov_b32 s13, 0
    s_lshr_b32 s14, s2, 5
    s_mul_i32 s14, s14, 96
    v_add_u32 v16, s14, v14
    s_add_u32 s14, s14, 32
    v_cvt_f32_u32 v17, v16
    v_mul_f32 v18, v17, v21
    v_mul_f32 v16, s8, v18
    v_floor_f32 v16, v16
    v_fma_f32 v18, v16, s10, v18
    v_mul_f32 v20, s8, v18
    v_mul_f32 v17, s8, v17
    v_mul_f32 v19, 0x41000000, v17
    v_cos_f32 v19, v19
    v_cos_f32 v32, v20
    v_sin_f32 v33, v20
    v_add_f32 v20, v17, v20
    v_cos_f32 v34, v20
    v_sin_f32 v35, v20
    v_add_f32 v20, v17, v20
    v_cos_f32 v36, v20
    v_sin_f32 v37, v20
    v_add_f32 v20, v17, v20
    v_cos_f32 v38, v20
    v_sin_f32 v39, v20
    v_mul_f32 v32, s9, v32
    v_mul_f32 v33, s9, -v33
    v_mul_f32 v34, s9, v34
    v_mul_f32 v35, s9, -v35
    v_mul_f32 v36, s9, v36
    v_mul_f32 v37, s9, -v37
    v_mul_f32 v38, s9, v38
    v_mul_f32 v39, s9, -v39
    v_fma_f32 v20, v17, 4.0, v20
    v_add_f32 v20, v17, v20
    v_cos_f32 v24, v20
    v_sin_f32 v25, v20
    v_add_f32 v20, v17, v20
    v_cos_f32 v26, v20
    v_sin_f32 v27, v20
    v_add_f32 v20, v17, v20
    v_cos_f32 v28, v20
    v_sin_f32 v29, v20
    v_add_f32 v20, v17, v20
    v_cos_f32 v30, v20
    v_sin_f32 v31, v20
    v_mul_f32 v24, s9, v24
    v_mul_f32 v25, s9, -v25
    v_mul_f32 v26, s9, v26
    v_mul_f32 v27, s9, -v27
    v_mul_f32 v28, s9, v28
    v_mul_f32 v29, s9, -v29
    v_mul_f32 v30, s9, v30
    v_mul_f32 v31, s9, -v31
    v_add_f32 v20, v19, v19
    v_cvt_pk_bf16_f32 v100, v32, v33
    v_cvt_pk_bf16_f32 v101, v34, v35
    v_cvt_pk_bf16_f32 v102, v36, v37
    v_cvt_pk_bf16_f32 v103, v38, v39
    v_cndmask_b32 v100, v100, v22, s[12:13]
    v_pk_fma_f32 v[32:33], v[20:21], v[24:25], v[32:33] op_sel_hi:[0,1,1] neg_lo:[0,0,1] neg_hi:[0,0,1]
    v_pk_fma_f32 v[34:35], v[20:21], v[26:27], v[34:35] op_sel_hi:[0,1,1] neg_lo:[0,0,1] neg_hi:[0,0,1]
    v_pk_fma_f32 v[36:37], v[20:21], v[28:29], v[36:37] op_sel_hi:[0,1,1] neg_lo:[0,0,1] neg_hi:[0,0,1]
    v_pk_fma_f32 v[38:39], v[20:21], v[30:31], v[38:39] op_sel_hi:[0,1,1] neg_lo:[0,0,1] neg_hi:[0,0,1]
    v_cvt_pk_bf16_f32 v104, v24, v25
    v_cvt_pk_bf16_f32 v105, v26, v27
    v_cvt_pk_bf16_f32 v106, v28, v29
    v_cvt_pk_bf16_f32 v107, v30, v31
    v_pk_fma_f32 v[24:25], v[20:21], v[32:33], v[24:25] op_sel_hi:[0,1,1] neg_lo:[0,0,1] neg_hi:[0,0,1]
    v_pk_fma_f32 v[26:27], v[20:21], v[34:35], v[26:27] op_sel_hi:[0,1,1] neg_lo:[0,0,1] neg_hi:[0,0,1]
    v_pk_fma_f32 v[28:29], v[20:21], v[36:37], v[28:29] op_sel_hi:[0,1,1] neg_lo:[0,0,1] neg_hi:[0,0,1]
    v_pk_fma_f32 v[30:31], v[20:21], v[38:39], v[30:31] op_sel_hi:[0,1,1] neg_lo:[0,0,1] neg_hi:[0,0,1]
    v_cvt_pk_bf16_f32 v108, v32, v33
    v_cvt_pk_bf16_f32 v109, v34, v35
    v_cvt_pk_bf16_f32 v110, v36, v37
    v_cvt_pk_bf16_f32 v111, v38, v39
    v_pk_fma_f32 v[32:33], v[20:21], v[24:25], v[32:33] op_sel_hi:[0,1,1] neg_lo:[0,0,1] neg_hi:[0,0,1]
    v_pk_fma_f32 v[34:35], v[20:21], v[26:27], v[34:35] op_sel_hi:[0,1,1] neg_lo:[0,0,1] neg_hi:[0,0,1]
    v_pk_fma_f32 v[36:37], v[20:21], v[28:29], v[36:37] op_sel_hi:[0,1,1] neg_lo:[0,0,1] neg_hi:[0,0,1]
    v_pk_fma_f32 v[38:39], v[20:21], v[30:31], v[38:39] op_sel_hi:[0,1,1] neg_lo:[0,0,1] neg_hi:[0,0,1]
    v_cvt_pk_bf16_f32 v112, v24, v25
    v_cvt_pk_bf16_f32 v113, v26, v27
    v_cvt_pk_bf16_f32 v114, v28, v29
    v_cvt_pk_bf16_f32 v115, v30, v31
    v_pk_fma_f32 v[24:25], v[20:21], v[32:33], v[24:25] op_sel_hi:[0,1,1] neg_lo:[0,0,1] neg_hi:[0,0,1]
    v_pk_fma_f32 v[26:27], v[20:21], v[34:35], v[26:27] op_sel_hi:[0,1,1] neg_lo:[0,0,1] neg_hi:[0,0,1]
    v_pk_fma_f32 v[28:29], v[20:21], v[36:37], v[28:29] op_sel_hi:[0,1,1] neg_lo:[0,0,1] neg_hi:[0,0,1]
    v_pk_fma_f32 v[30:31], v[20:21], v[38:39], v[30:31] op_sel_hi:[0,1,1] neg_lo:[0,0,1] neg_hi:[0,0,1]
    v_cvt_pk_bf16_f32 v116, v32, v33
    v_cvt_pk_bf16_f32 v117, v34, v35
    v_cvt_pk_bf16_f32 v118, v36, v37
    v_cvt_pk_bf16_f32 v119, v38, v39
    v_pk_fma_f32 v[32:33], v[20:21], v[24:25], v[32:33] op_sel_hi:[0,1,1] neg_lo:[0,0,1] neg_hi:[0,0,1]
    v_pk_fma_f32 v[34:35], v[20:21], v[26:27], v[34:35] op_sel_hi:[0,1,1] neg_lo:[0,0,1] neg_hi:[0,0,1]
    v_pk_fma_f32 v[36:37], v[20:21], v[28:29], v[36:37] op_sel_hi:[0,1,1] neg_lo:[0,0,1] neg_hi:[0,0,1]
    v_pk_fma_f32 v[38:39], v[20:21], v[30:31], v[38:39] op_sel_hi:[0,1,1] neg_lo:[0,0,1] neg_hi:[0,0,1]
    v_cvt_pk_bf16_f32 v120, v24, v25
    v_cvt_pk_bf16_f32 v121, v26, v27
    v_cvt_pk_bf16_f32 v122, v28, v29
    v_cvt_pk_bf16_f32 v123, v30, v31
    v_pk_fma_f32 v[24:25], v[20:21], v[32:33], v[24:25] op_sel_hi:[0,1,1] neg_lo:[0,0,1] neg_hi:[0,0,1]
    v_pk_fma_f32 v[26:27], v[20:21], v[34:35], v[26:27] op_sel_hi:[0,1,1] neg_lo:[0,0,1] neg_hi:[0,0,1]
    v_pk_fma_f32 v[28:29], v[20:21], v[36:37], v[28:29] op_sel_hi:[0,1,1] neg_lo:[0,0,1] neg_hi:[0,0,1]
    v_pk_fma_f32 v[30:31], v[20:21], v[38:39], v[30:31] op_sel_hi:[0,1,1] neg_lo:[0,0,1] neg_hi:[0,0,1]
    v_cvt_pk_bf16_f32 v124, v32, v33
    v_cvt_pk_bf16_f32 v125, v34, v35
    v_cvt_pk_bf16_f32 v126, v36, v37
    v_cvt_pk_bf16_f32 v127, v38, v39
    v_pk_fma_f32 v[32:33], v[20:21], v[24:25], v[32:33] op_sel_hi:[0,1,1] neg_lo:[0,0,1] neg_hi:[0,0,1]
    v_pk_fma_f32 v[34:35], v[20:21], v[26:27], v[34:35] op_sel_hi:[0,1,1] neg_lo:[0,0,1] neg_hi:[0,0,1]
    v_pk_fma_f32 v[36:37], v[20:21], v[28:29], v[36:37] op_sel_hi:[0,1,1] neg_lo:[0,0,1] neg_hi:[0,0,1]
    v_pk_fma_f32 v[38:39], v[20:21], v[30:31], v[38:39] op_sel_hi:[0,1,1] neg_lo:[0,0,1] neg_hi:[0,0,1]
    v_cvt_pk_bf16_f32 v128, v24, v25
    v_cvt_pk_bf16_f32 v129, v26, v27
    v_cvt_pk_bf16_f32 v130, v28, v29
    v_cvt_pk_bf16_f32 v131, v30, v31
    v_cvt_pk_bf16_f32 v132, v32, v33
    v_cvt_pk_bf16_f32 v133, v34, v35
    v_cvt_pk_bf16_f32 v134, v36, v37
    v_cvt_pk_bf16_f32 v135, v38, v39
    v_add_u32 v16, s14, v14
    s_add_u32 s14, s14, 32
    v_cvt_f32_u32 v17, v16
    v_mul_f32 v18, v17, v21
    v_mul_f32 v16, s8, v18
    v_floor_f32 v16, v16
    v_fma_f32 v18, v16, s10, v18
    v_mul_f32 v20, s8, v18
    v_mul_f32 v17, s8, v17
    v_mul_f32 v19, 0x41000000, v17
    v_cos_f32 v19, v19
    v_cos_f32 v32, v20
    v_sin_f32 v33, v20
    v_add_f32 v20, v17, v20
    v_cos_f32 v34, v20
    v_sin_f32 v35, v20
    v_add_f32 v20, v17, v20
    v_cos_f32 v36, v20
    v_sin_f32 v37, v20
    v_add_f32 v20, v17, v20
    v_cos_f32 v38, v20
    v_sin_f32 v39, v20
    v_mul_f32 v32, s9, v32
    v_mul_f32 v33, s9, -v33
    v_mul_f32 v34, s9, v34
    v_mul_f32 v35, s9, -v35
    v_mul_f32 v36, s9, v36
    v_mul_f32 v37, s9, -v37
    v_mul_f32 v38, s9, v38
    v_mul_f32 v39, s9, -v39
    v_fma_f32 v20, v17, 4.0, v20
    v_add_f32 v20, v17, v20
    v_cos_f32 v24, v20
    v_sin_f32 v25, v20
    v_add_f32 v20, v17, v20
    v_cos_f32 v26, v20
    v_sin_f32 v27, v20
    v_add_f32 v20, v17, v20
    v_cos_f32 v28, v20
    v_sin_f32 v29, v20
    v_add_f32 v20, v17, v20
    v_cos_f32 v30, v20
    v_sin_f32 v31, v20
    v_mul_f32 v24, s9, v24
    v_mul_f32 v25, s9, -v25
    v_mul_f32 v26, s9, v26
    v_mul_f32 v27, s9, -v27
    v_mul_f32 v28, s9, v28
    v_mul_f32 v29, s9, -v29
    v_mul_f32 v30, s9, v30
    v_mul_f32 v31, s9, -v31
    v_add_f32 v20, v19, v19
    v_cvt_pk_bf16_f32 v136, v32, v33
    v_cvt_pk_bf16_f32 v137, v34, v35
    v_cvt_pk_bf16_f32 v138, v36, v37
    v_cvt_pk_bf16_f32 v139, v38, v39
    v_cndmask_b32 v136, v136, v22, s[12:13]
    v_pk_fma_f32 v[32:33], v[20:21], v[24:25], v[32:33] op_sel_hi:[0,1,1] neg_lo:[0,0,1] neg_hi:[0,0,1]
    v_pk_fma_f32 v[34:35], v[20:21], v[26:27], v[34:35] op_sel_hi:[0,1,1] neg_lo:[0,0,1] neg_hi:[0,0,1]
    v_pk_fma_f32 v[36:37], v[20:21], v[28:29], v[36:37] op_sel_hi:[0,1,1] neg_lo:[0,0,1] neg_hi:[0,0,1]
    v_pk_fma_f32 v[38:39], v[20:21], v[30:31], v[38:39] op_sel_hi:[0,1,1] neg_lo:[0,0,1] neg_hi:[0,0,1]
    v_cvt_pk_bf16_f32 v140, v24, v25
    v_cvt_pk_bf16_f32 v141, v26, v27
    v_cvt_pk_bf16_f32 v142, v28, v29
    v_cvt_pk_bf16_f32 v143, v30, v31
    v_pk_fma_f32 v[24:25], v[20:21], v[32:33], v[24:25] op_sel_hi:[0,1,1] neg_lo:[0,0,1] neg_hi:[0,0,1]
    v_pk_fma_f32 v[26:27], v[20:21], v[34:35], v[26:27] op_sel_hi:[0,1,1] neg_lo:[0,0,1] neg_hi:[0,0,1]
    v_pk_fma_f32 v[28:29], v[20:21], v[36:37], v[28:29] op_sel_hi:[0,1,1] neg_lo:[0,0,1] neg_hi:[0,0,1]
    v_pk_fma_f32 v[30:31], v[20:21], v[38:39], v[30:31] op_sel_hi:[0,1,1] neg_lo:[0,0,1] neg_hi:[0,0,1]
    v_cvt_pk_bf16_f32 v144, v32, v33
    v_cvt_pk_bf16_f32 v145, v34, v35
    v_cvt_pk_bf16_f32 v146, v36, v37
    v_cvt_pk_bf16_f32 v147, v38, v39
    v_pk_fma_f32 v[32:33], v[20:21], v[24:25], v[32:33] op_sel_hi:[0,1,1] neg_lo:[0,0,1] neg_hi:[0,0,1]
    v_pk_fma_f32 v[34:35], v[20:21], v[26:27], v[34:35] op_sel_hi:[0,1,1] neg_lo:[0,0,1] neg_hi:[0,0,1]
    v_pk_fma_f32 v[36:37], v[20:21], v[28:29], v[36:37] op_sel_hi:[0,1,1] neg_lo:[0,0,1] neg_hi:[0,0,1]
    v_pk_fma_f32 v[38:39], v[20:21], v[30:31], v[38:39] op_sel_hi:[0,1,1] neg_lo:[0,0,1] neg_hi:[0,0,1]
    v_cvt_pk_bf16_f32 v148, v24, v25
    v_cvt_pk_bf16_f32 v149, v26, v27
    v_cvt_pk_bf16_f32 v150, v28, v29
    v_cvt_pk_bf16_f32 v151, v30, v31
    v_pk_fma_f32 v[24:25], v[20:21], v[32:33], v[24:25] op_sel_hi:[0,1,1] neg_lo:[0,0,1] neg_hi:[0,0,1]
    v_pk_fma_f32 v[26:27], v[20:21], v[34:35], v[26:27] op_sel_hi:[0,1,1] neg_lo:[0,0,1] neg_hi:[0,0,1]
    v_pk_fma_f32 v[28:29], v[20:21], v[36:37], v[28:29] op_sel_hi:[0,1,1] neg_lo:[0,0,1] neg_hi:[0,0,1]
    v_pk_fma_f32 v[30:31], v[20:21], v[38:39], v[30:31] op_sel_hi:[0,1,1] neg_lo:[0,0,1] neg_hi:[0,0,1]
    v_cvt_pk_bf16_f32 v152, v32, v33
    v_cvt_pk_bf16_f32 v153, v34, v35
    v_cvt_pk_bf16_f32 v154, v36, v37
    v_cvt_pk_bf16_f32 v155, v38, v39
    v_pk_fma_f32 v[32:33], v[20:21], v[24:25], v[32:33] op_sel_hi:[0,1,1] neg_lo:[0,0,1] neg_hi:[0,0,1]
    v_pk_fma_f32 v[34:35], v[20:21], v[26:27], v[34:35] op_sel_hi:[0,1,1] neg_lo:[0,0,1] neg_hi:[0,0,1]
    v_pk_fma_f32 v[36:37], v[20:21], v[28:29], v[36:37] op_sel_hi:[0,1,1] neg_lo:[0,0,1] neg_hi:[0,0,1]
    v_pk_fma_f32 v[38:39], v[20:21], v[30:31], v[38:39] op_sel_hi:[0,1,1] neg_lo:[0,0,1] neg_hi:[0,0,1]
    v_cvt_pk_bf16_f32 v156, v24, v25
    v_cvt_pk_bf16_f32 v157, v26, v27
    v_cvt_pk_bf16_f32 v158, v28, v29
    v_cvt_pk_bf16_f32 v159, v30, v31
    v_pk_fma_f32 v[24:25], v[20:21], v[32:33], v[24:25] op_sel_hi:[0,1,1] neg_lo:[0,0,1] neg_hi:[0,0,1]
    v_pk_fma_f32 v[26:27], v[20:21], v[34:35], v[26:27] op_sel_hi:[0,1,1] neg_lo:[0,0,1] neg_hi:[0,0,1]
    v_pk_fma_f32 v[28:29], v[20:21], v[36:37], v[28:29] op_sel_hi:[0,1,1] neg_lo:[0,0,1] neg_hi:[0,0,1]
    v_pk_fma_f32 v[30:31], v[20:21], v[38:39], v[30:31] op_sel_hi:[0,1,1] neg_lo:[0,0,1] neg_hi:[0,0,1]
    v_cvt_pk_bf16_f32 v160, v32, v33
    v_cvt_pk_bf16_f32 v161, v34, v35
    v_cvt_pk_bf16_f32 v162, v36, v37
    v_cvt_pk_bf16_f32 v163, v38, v39
    v_pk_fma_f32 v[32:33], v[20:21], v[24:25], v[32:33] op_sel_hi:[0,1,1] neg_lo:[0,0,1] neg_hi:[0,0,1]
    v_pk_fma_f32 v[34:35], v[20:21], v[26:27], v[34:35] op_sel_hi:[0,1,1] neg_lo:[0,0,1] neg_hi:[0,0,1]
    v_pk_fma_f32 v[36:37], v[20:21], v[28:29], v[36:37] op_sel_hi:[0,1,1] neg_lo:[0,0,1] neg_hi:[0,0,1]
    v_pk_fma_f32 v[38:39], v[20:21], v[30:31], v[38:39] op_sel_hi:[0,1,1] neg_lo:[0,0,1] neg_hi:[0,0,1]
    v_cvt_pk_bf16_f32 v164, v24, v25
    v_cvt_pk_bf16_f32 v165, v26, v27
    v_cvt_pk_bf16_f32 v166, v28, v29
    v_cvt_pk_bf16_f32 v167, v30, v31
    v_cvt_pk_bf16_f32 v168, v32, v33
    v_cvt_pk_bf16_f32 v169, v34, v35
    v_cvt_pk_bf16_f32 v170, v36, v37
    v_cvt_pk_bf16_f32 v171, v38, v39
    v_add_u32 v16, s14, v14
    v_cvt_f32_u32 v17, v16
    v_mul_f32 v18, v17, v21
    v_mul_f32 v16, s8, v18
    v_floor_f32 v16, v16
    v_fma_f32 v18, v16, s10, v18
    v_mul_f32 v20, s8, v18
    v_mul_f32 v17, s8, v17
    v_mul_f32 v19, 0x41000000, v17
    v_cos_f32 v19, v19
    v_cos_f32 v32, v20
    v_sin_f32 v33, v20
    v_add_f32 v20, v17, v20
    v_cos_f32 v34, v20
    v_sin_f32 v35, v20
    v_add_f32 v20, v17, v20
    v_cos_f32 v36, v20
    v_sin_f32 v37, v20
    v_add_f32 v20, v17, v20
    v_cos_f32 v38, v20
    v_sin_f32 v39, v20
    v_mul_f32 v32, s9, v32
    v_mul_f32 v33, s9, -v33
    v_mul_f32 v34, s9, v34
    v_mul_f32 v35, s9, -v35
    v_mul_f32 v36, s9, v36
    v_mul_f32 v37, s9, -v37
    v_mul_f32 v38, s9, v38
    v_mul_f32 v39, s9, -v39
    v_fma_f32 v20, v17, 4.0, v20
    v_add_f32 v20, v17, v20
    v_cos_f32 v24, v20
    v_sin_f32 v25, v20
    v_add_f32 v20, v17, v20
    v_cos_f32 v26, v20
    v_sin_f32 v27, v20
    v_add_f32 v20, v17, v20
    v_cos_f32 v28, v20
    v_sin_f32 v29, v20
    v_add_f32 v20, v17, v20
    v_cos_f32 v30, v20
    v_sin_f32 v31, v20
    v_mul_f32 v24, s9, v24
    v_mul_f32 v25, s9, -v25
    v_mul_f32 v26, s9, v26
    v_mul_f32 v27, s9, -v27
    v_mul_f32 v28, s9, v28
    v_mul_f32 v29, s9, -v29
    v_mul_f32 v30, s9, v30
    v_mul_f32 v31, s9, -v31
    v_add_f32 v20, v19, v19
    v_cvt_pk_bf16_f32 v172, v32, v33
    v_cvt_pk_bf16_f32 v173, v34, v35
    v_cvt_pk_bf16_f32 v174, v36, v37
    v_cvt_pk_bf16_f32 v175, v38, v39
    v_cndmask_b32 v172, v172, v22, s[12:13]
    v_pk_fma_f32 v[32:33], v[20:21], v[24:25], v[32:33] op_sel_hi:[0,1,1] neg_lo:[0,0,1] neg_hi:[0,0,1]
    v_pk_fma_f32 v[34:35], v[20:21], v[26:27], v[34:35] op_sel_hi:[0,1,1] neg_lo:[0,0,1] neg_hi:[0,0,1]
    v_pk_fma_f32 v[36:37], v[20:21], v[28:29], v[36:37] op_sel_hi:[0,1,1] neg_lo:[0,0,1] neg_hi:[0,0,1]
    v_pk_fma_f32 v[38:39], v[20:21], v[30:31], v[38:39] op_sel_hi:[0,1,1] neg_lo:[0,0,1] neg_hi:[0,0,1]
    v_cvt_pk_bf16_f32 v176, v24, v25
    v_cvt_pk_bf16_f32 v177, v26, v27
    v_cvt_pk_bf16_f32 v178, v28, v29
    v_cvt_pk_bf16_f32 v179, v30, v31
    v_pk_fma_f32 v[24:25], v[20:21], v[32:33], v[24:25] op_sel_hi:[0,1,1] neg_lo:[0,0,1] neg_hi:[0,0,1]
    v_pk_fma_f32 v[26:27], v[20:21], v[34:35], v[26:27] op_sel_hi:[0,1,1] neg_lo:[0,0,1] neg_hi:[0,0,1]
    v_pk_fma_f32 v[28:29], v[20:21], v[36:37], v[28:29] op_sel_hi:[0,1,1] neg_lo:[0,0,1] neg_hi:[0,0,1]
    v_pk_fma_f32 v[30:31], v[20:21], v[38:39], v[30:31] op_sel_hi:[0,1,1] neg_lo:[0,0,1] neg_hi:[0,0,1]
    v_cvt_pk_bf16_f32 v180, v32, v33
    v_cvt_pk_bf16_f32 v181, v34, v35
    v_cvt_pk_bf16_f32 v182, v36, v37
    v_cvt_pk_bf16_f32 v183, v38, v39
    v_pk_fma_f32 v[32:33], v[20:21], v[24:25], v[32:33] op_sel_hi:[0,1,1] neg_lo:[0,0,1] neg_hi:[0,0,1]
    v_pk_fma_f32 v[34:35], v[20:21], v[26:27], v[34:35] op_sel_hi:[0,1,1] neg_lo:[0,0,1] neg_hi:[0,0,1]
    v_pk_fma_f32 v[36:37], v[20:21], v[28:29], v[36:37] op_sel_hi:[0,1,1] neg_lo:[0,0,1] neg_hi:[0,0,1]
    v_pk_fma_f32 v[38:39], v[20:21], v[30:31], v[38:39] op_sel_hi:[0,1,1] neg_lo:[0,0,1] neg_hi:[0,0,1]
    v_cvt_pk_bf16_f32 v184, v24, v25
    v_cvt_pk_bf16_f32 v185, v26, v27
    v_cvt_pk_bf16_f32 v186, v28, v29
    v_cvt_pk_bf16_f32 v187, v30, v31
    v_pk_fma_f32 v[24:25], v[20:21], v[32:33], v[24:25] op_sel_hi:[0,1,1] neg_lo:[0,0,1] neg_hi:[0,0,1]
    v_pk_fma_f32 v[26:27], v[20:21], v[34:35], v[26:27] op_sel_hi:[0,1,1] neg_lo:[0,0,1] neg_hi:[0,0,1]
    v_pk_fma_f32 v[28:29], v[20:21], v[36:37], v[28:29] op_sel_hi:[0,1,1] neg_lo:[0,0,1] neg_hi:[0,0,1]
    v_pk_fma_f32 v[30:31], v[20:21], v[38:39], v[30:31] op_sel_hi:[0,1,1] neg_lo:[0,0,1] neg_hi:[0,0,1]
    v_cvt_pk_bf16_f32 v188, v32, v33
    v_cvt_pk_bf16_f32 v189, v34, v35
    v_cvt_pk_bf16_f32 v190, v36, v37
    v_cvt_pk_bf16_f32 v191, v38, v39
    v_pk_fma_f32 v[32:33], v[20:21], v[24:25], v[32:33] op_sel_hi:[0,1,1] neg_lo:[0,0,1] neg_hi:[0,0,1]
    v_pk_fma_f32 v[34:35], v[20:21], v[26:27], v[34:35] op_sel_hi:[0,1,1] neg_lo:[0,0,1] neg_hi:[0,0,1]
    v_pk_fma_f32 v[36:37], v[20:21], v[28:29], v[36:37] op_sel_hi:[0,1,1] neg_lo:[0,0,1] neg_hi:[0,0,1]
    v_pk_fma_f32 v[38:39], v[20:21], v[30:31], v[38:39] op_sel_hi:[0,1,1] neg_lo:[0,0,1] neg_hi:[0,0,1]
    v_cvt_pk_bf16_f32 v192, v24, v25
    v_cvt_pk_bf16_f32 v193, v26, v27
    v_cvt_pk_bf16_f32 v194, v28, v29
    v_cvt_pk_bf16_f32 v195, v30, v31
    v_pk_fma_f32 v[24:25], v[20:21], v[32:33], v[24:25] op_sel_hi:[0,1,1] neg_lo:[0,0,1] neg_hi:[0,0,1]
    v_pk_fma_f32 v[26:27], v[20:21], v[34:35], v[26:27] op_sel_hi:[0,1,1] neg_lo:[0,0,1] neg_hi:[0,0,1]
    v_pk_fma_f32 v[28:29], v[20:21], v[36:37], v[28:29] op_sel_hi:[0,1,1] neg_lo:[0,0,1] neg_hi:[0,0,1]
    v_pk_fma_f32 v[30:31], v[20:21], v[38:39], v[30:31] op_sel_hi:[0,1,1] neg_lo:[0,0,1] neg_hi:[0,0,1]
    v_cvt_pk_bf16_f32 v196, v32, v33
    v_cvt_pk_bf16_f32 v197, v34, v35
    v_cvt_pk_bf16_f32 v198, v36, v37
    v_cvt_pk_bf16_f32 v199, v38, v39
    v_pk_fma_f32 v[32:33], v[20:21], v[24:25], v[32:33] op_sel_hi:[0,1,1] neg_lo:[0,0,1] neg_hi:[0,0,1]
    v_pk_fma_f32 v[34:35], v[20:21], v[26:27], v[34:35] op_sel_hi:[0,1,1] neg_lo:[0,0,1] neg_hi:[0,0,1]
    v_pk_fma_f32 v[36:37], v[20:21], v[28:29], v[36:37] op_sel_hi:[0,1,1] neg_lo:[0,0,1] neg_hi:[0,0,1]
    v_pk_fma_f32 v[38:39], v[20:21], v[30:31], v[38:39] op_sel_hi:[0,1,1] neg_lo:[0,0,1] neg_hi:[0,0,1]
    v_cvt_pk_bf16_f32 v200, v24, v25
    v_cvt_pk_bf16_f32 v201, v26, v27
    v_cvt_pk_bf16_f32 v202, v28, v29
    v_cvt_pk_bf16_f32 v203, v30, v31
    v_cvt_pk_bf16_f32 v204, v32, v33
    v_cvt_pk_bf16_f32 v205, v34, v35
    v_cvt_pk_bf16_f32 v206, v36, v37
    v_cvt_pk_bf16_f32 v207, v38, v39
L_q_pre:
    s_waitcnt vmcnt(0)
    s_barrier
    s_lshr_b32 s3, s2, 5
    s_mul_i32 s3, s3, 110592
    s_add_u32 s40, s4, 0x1268000
    s_addc_u32 s41, s5, 0
    s_add_u32 s40, s40, s3
    s_addc_u32 s41, s41, 0
    s_mov_b32 s42, 0x1b000
    s_mov_b32 s43, 0x20000
    s_barrier
    s_cmp_ge_u32 s2, 192
    s_cbranch_scc1 L_q_mid
    s_and_b32 s12, s2, 7
    s_lshl_b32 s12, s12, 2
    s_bfe_u32 s13, s2, 0x20003
    s_add_u32 s12, s12, s13
    s_add_u32 s8, s4, 0x6c0000
    s_addc_u32 s9, s5, 0
    s_mov_b32 s10, 0x240000
    s_mov_b32 s11, 0x20000
    v_and_b32 v16, 15, v14
    v_lshrrev_b32 v17, 4, v14
    v_lshl_add_u32 v16, v16, 1, v17
    v_lshlrev_b32 v4, 3, v16
    v_lshl_add_u32 v4, v15, 15, v4
    s_mul_i32 s13, s24, 589824
    s_lshl_b32 s12, s12, 9
    s_add_u32 s13, s13, s12
    s_mov_b32 s14, s13
    buffer_load_dwordx2 a[0:1], v4, s[8:11], s14 offen offset:0 sc1
    s_add_u32 s14, s14, 0x4000
    buffer_load_dwordx2 a[2:3], v4, s[8:11], s14 offen offset:0 sc1
    s_add_u32 s14, s14, 0xc000
    buffer_load_dwordx2 a[4:5], v4, s[8:11], s14 offen offset:0 sc1
    s_add_u32 s14, s14, 0x4000
    buffer_load_dwordx2 a[6:7], v4, s[8:11], s14 offen offset:0 sc1
    s_add_u32 s14, s14, 0xc000
    buffer_load_dwordx2 a[8:9], v4, s[8:11], s14 offen offset:0 sc1
    s_add_u32 s14, s14, 0x4000
    buffer_load_dwordx2 a[10:11], v4, s[8:11], s14 offen offset:0 sc1
    s_add_u32 s14, s14, 0xc000
    buffer_load_dwordx2 a[12:13], v4, s[8:11], s14 offen offset:0 sc1
    s_add_u32 s14, s14, 0x4000
    buffer_load_dwordx2 a[14:15], v4, s[8:11], s14 offen offset:0 sc1
    s_add_u32 s14, s14, 0xc000
    buffer_load_dwordx2 a[16:17], v4, s[8:11], s14 offen offset:0 sc1
    s_add_u32 s14, s14, 0x4000
    buffer_load_dwordx2 a[18:19], v4, s[8:11], s14 offen offset:0 sc1
    s_add_u32 s14, s14, 0xc000
    buffer_load_dwordx2 a[20:21], v4, s[8:11], s14 offen offset:0 sc1
    s_add_u32 s14, s14, 0x4000
    buffer_load_dwordx2 a[22:23], v4, s[8:11], s14 offen offset:0 sc1
    s_add_u32 s14, s14, 0xc000
    buffer_load_dwordx2 a[24:25], v4, s[8:11], s14 offen offset:0 sc1
    s_add_u32 s14, s14, 0x4000
    buffer_load_dwordx2 a[26:27], v4, s[8:11], s14 offen offset:0 sc1
    s_add_u32 s14, s14, 0xc000
    buffer_load_dwordx2 a[28:29], v4, s[8:11], s14 offen offset:0 sc1
    s_add_u32 s14, s14, 0x4000
    buffer_load_dwordx2 a[30:31], v4, s[8:11], s14 offen offset:0 sc1
    s_add_u32 s14, s14, 0xc000
    buffer_load_dwordx2 a[32:33], v4, s[8:11], s14 offen offset:0 sc1
    s_add_u32 s14, s14, 0x4000
    buffer_load_dwordx2 a[34:35], v4, s[8:11], s14 offen offset:0 sc1
    s_add_u32 s14, s14, 0xc000
    s_mov_b32 s14, s13
    buffer_load_dwordx2 v[64:65], v4, s[8:11], s14 offen offset:256 sc1
    s_add_u32 s14, s14, 0x4000
    buffer_load_dwordx2 v[66:67], v4, s[8:11], s14 offen offset:256 sc1
    s_add_u32 s14, s14, 0xc000
    buffer_load_dwordx2 v[68:69], v4, s[8:11], s14 offen offset:256 sc1
    s_add_u32 s14, s14, 0x4000
    buffer_load_dwordx2 v[70:71], v4, s[8:11], s14 offen offset:256 sc1
    s_add_u32 s14, s14, 0xc000
    buffer_load_dwordx2 v[72:73], v4, s[8:11], s14 offen offset:256 sc1
    s_add_u32 s14, s14, 0x4000
    buffer_load_dwordx2 v[74:75], v4, s[8:11], s14 offen offset:256 sc1
    s_add_u32 s14, s14, 0xc000
    buffer_load_dwordx2 v[76:77], v4, s[8:11], s14 offen offset:256 sc1
    s_add_u32 s14, s14, 0x4000
    buffer_load_dwordx2 v[78:79], v4, s[8:11], s14 offen offset:256 sc1
    s_add_u32 s14, s14, 0xc000
    buffer_load_dwordx2 v[80:81], v4, s[8:11], s14 offen offset:256 sc1
    s_add_u32 s14, s14, 0x4000
    buffer_load_dwordx2 v[82:83], v4, s[8:11], s14 offen offset:256 sc1
    s_add_u32 s14, s14, 0xc000
    buffer_load_dwordx2 v[84:85], v4, s[8:11], s14 offen offset:256 sc1
    s_add_u32 s14, s14, 0x4000
    buffer_load_dwordx2 v[86:87], v4, s[8:11], s14 offen offset:256 sc1
    s_add_u32 s14, s14, 0xc000
    buffer_load_dwordx2 v[88:89], v4, s[8:11], s14 offen offset:256 sc1
    s_add_u32 s14, s14, 0x4000
    buffer_load_dwordx2 v[90:91], v4, s[8:11], s14 offen offset:256 sc1
    s_add_u32 s14, s14, 0xc000
    buffer_load_dwordx2 v[92:93], v4, s[8:11], s14 offen offset:256 sc1
    s_add_u32 s14, s14, 0x4000
    buffer_load_dwordx2 v[94:95], v4, s[8:11], s14 offen offset:256 sc1
    s_add_u32 s14, s14, 0xc000
    buffer_load_dwordx2 v[96:97], v4, s[8:11], s14 offen offset:256 sc1
    s_add_u32 s14, s14, 0x4000
    buffer_load_dwordx2 v[98:99], v4, s[8:11], s14 offen offset:256 sc1
    s_add_u32 s14, s14, 0xc000
L_q_mid:
    s_setprio 3
    s_barrier
    ds_read_b128 v[8:11], v6 offset:0
    ds_read_b128 v[24:27], v6 offset:2048
    ds_read_b64_tr_b16 v[40:41], v7 offset:0
    ds_read_b64_tr_b16 v[42:43], v7 offset:512
    ds_read_b128 v[12:15], v6 offset:4096
    ds_read_b128 v[28:31], v6 offset:6144
    ds_read_b64_tr_b16 v[44:45], v7 offset:1024
    ds_read_b64_tr_b16 v[46:47], v7 offset:1536
    ds_read_b128 v[16:19], v6 offset:8192
    ds_read_b128 v[32:35], v6 offset:10240
    ds_read_b64_tr_b16 v[48:49], v7 offset:2048
    ds_read_b64_tr_b16 v[50:51], v7 offset:2560
    ds_read_b128 v[20:23], v6 offset:12288
    ds_read_b128 v[36:39], v6 offset:14336
    ds_read_b64_tr_b16 v[52:53], v7 offset:3072
    ds_read_b64_tr_b16 v[54:55], v7 offset:3584
    s_waitcnt lgkmcnt(13)
    v_cndmask_b32 v8, v40, v8, s[70:71]
    v_cndmask_b32 v9, v41, v9, s[70:71]
    s_waitcnt lgkmcnt(12)
    v_cndmask_b32 v10, v42, v10, s[70:71]
    v_cndmask_b32 v11, v43, v11, s[70:71]
    s_nop 1
    v_mfma_f32_16x16x32_bf16 v[56:59], v[24:27], v[8:11], 0
    v_mfma_f32_16x16x32_bf16 v[60:63], v[40:43], v[8:11], 0
    s_waitcnt lgkmcnt(9)
    v_cndmask_b32 v12, v44, v12, s[70:71]
    v_cndmask_b32 v13, v45, v13, s[70:71]
    s_waitcnt lgkmcnt(8)
    v_cndmask_b32 v14, v46, v14, s[70:71]
    v_cndmask_b32 v15, v47, v15, s[70:71]
    s_nop 1
    v_mfma_f32_16x16x32_bf16 v[56:59], v[28:31], v[12:15], v[56:59]
    v_mfma_f32_16x16x32_bf16 v[60:63], v[44:47], v[12:15], v[60:63]
    s_waitcnt lgkmcnt(5)
    v_cndmask_b32 v16, v48, v16, s[70:71]
    v_cndmask_b32 v17, v49, v17, s[70:71]
    s_waitcnt lgkmcnt(4)
    v_cndmask_b32 v18, v50, v18, s[70:71]
    v_cndmask_b32 v19, v51, v19, s[70:71]
    s_nop 1
    v_mfma_f32_16x16x32_bf16 v[56:59], v[32:35], v[16:19], v[56:59]
    v_mfma_f32_16x16x32_bf16 v[60:63], v[48:51], v[16:19], v[60:63]
    s_waitcnt lgkmcnt(1)
    v_cndmask_b32 v20, v52, v20, s[70:71]
    v_cndmask_b32 v21, v53, v21, s[70:71]
    s_waitcnt lgkmcnt(0)
    v_cndmask_b32 v22, v54, v22, s[70:71]
    v_cndmask_b32 v23, v55, v23, s[70:71]
    s_nop 1
    v_mfma_f32_16x16x32_bf16 v[56:59], v[36:39], v[20:23], v[56:59]
    v_mfma_f32_16x16x32_bf16 v[60:63], v[52:55], v[20:23], v[60:63]
    s_nop 6
    buffer_atomic_add_f32 v56, v1, s[32:35], 0 offen
    buffer_atomic_add_f32 v57, v1, s[32:35], s49 offen
    buffer_atomic_add_f32 v58, v1, s[32:35], s50 offen
    buffer_atomic_add_f32 v59, v1, s[32:35], s51 offen
    v_cndmask_b32 v60, v60, v62, s[46:47]
    v_cndmask_b32 v61, v61, v63, s[46:47]
    buffer_atomic_add_f32 v60, v2, s[32:35], 0 offen
    buffer_atomic_add_f32 v61, v5, s[32:35], 0 offen
    s_setprio 0
    s_cmp_ge_u32 s2, 192
    s_cbranch_scc1 L_q_tail
    s_waitcnt vmcnt(40)
    v_mfma_f32_32x32x16_bf16 v[8:23], v[100:103], a[0:3], 0
    s_waitcnt vmcnt(38)
    v_mfma_f32_32x32x16_bf16 v[8:23], v[104:107], a[4:7], v[8:23]
    s_waitcnt vmcnt(36)
    v_mfma_f32_32x32x16_bf16 v[8:23], v[108:111], a[8:11], v[8:23]
    s_waitcnt vmcnt(34)
    v_mfma_f32_32x32x16_bf16 v[8:23], v[112:115], a[12:15], v[8:23]
    s_waitcnt vmcnt(32)
    v_mfma_f32_32x32x16_bf16 v[8:23], v[116:119], a[16:19], v[8:23]
    s_waitcnt vmcnt(30)
    v_mfma_f32_32x32x16_bf16 v[8:23], v[120:123], a[20:23], v[8:23]
    s_waitcnt vmcnt(28)
    v_mfma_f32_32x32x16_bf16 v[8:23], v[124:127], a[24:27], v[8:23]
    s_waitcnt vmcnt(26)
    v_mfma_f32_32x32x16_bf16 v[8:23], v[128:131], a[28:31], v[8:23]
    s_waitcnt vmcnt(24)
    v_mfma_f32_32x32x16_bf16 v[8:23], v[132:135], a[32:35], v[8:23]
    v_mfma_f32_32x32x16_bf16 v[24:39], v[136:139], a[0:3], 0
    v_mfma_f32_32x32x16_bf16 v[24:39], v[140:143], a[4:7], v[24:39]
    v_mfma_f32_32x32x16_bf16 v[24:39], v[144:147], a[8:11], v[24:39]
    v_mfma_f32_32x32x16_bf16 v[24:39], v[148:151], a[12:15], v[24:39]
    v_mfma_f32_32x32x16_bf16 v[24:39], v[152:155], a[16:19], v[24:39]
    v_mfma_f32_32x32x16_bf16 v[24:39], v[156:159], a[20:23], v[24:39]
    v_mfma_f32_32x32x16_bf16 v[24:39], v[160:163], a[24:27], v[24:39]
    v_mfma_f32_32x32x16_bf16 v[24:39], v[164:167], a[28:31], v[24:39]
    v_mfma_f32_32x32x16_bf16 v[24:39], v[168:171], a[32:35], v[24:39]
    v_mfma_f32_32x32x16_bf16 v[40:55], v[172:175], a[0:3], 0
    v_mfma_f32_32x32x16_bf16 v[40:55], v[176:179], a[4:7], v[40:55]
    v_mfma_f32_32x32x16_bf16 v[40:55], v[180:183], a[8:11], v[40:55]
    v_mfma_f32_32x32x16_bf16 v[40:55], v[184:187], a[12:15], v[40:55]
    v_mfma_f32_32x32x16_bf16 v[40:55], v[188:191], a[16:19], v[40:55]
    v_mfma_f32_32x32x16_bf16 v[40:55], v[192:195], a[20:23], v[40:55]
    v_mfma_f32_32x32x16_bf16 v[40:55], v[196:199], a[24:27], v[40:55]
    v_mfma_f32_32x32x16_bf16 v[40:55], v[200:203], a[28:31], v[40:55]
    v_mfma_f32_32x32x16_bf16 v[40:55], v[204:207], a[32:35], v[40:55]
    s_waitcnt vmcnt(22)
    v_mfma_f32_32x32x16_bf16 a[0:15], v[100:103], v[64:67], 0
    s_waitcnt vmcnt(20)
    v_mfma_f32_32x32x16_bf16 a[0:15], v[104:107], v[68:71], a[0:15]
    s_waitcnt vmcnt(18)
    v_mfma_f32_32x32x16_bf16 a[0:15], v[108:111], v[72:75], a[0:15]
    s_waitcnt vmcnt(16)
    v_mfma_f32_32x32x16_bf16 a[0:15], v[112:115], v[76:79], a[0:15]
    s_waitcnt vmcnt(14)
    v_mfma_f32_32x32x16_bf16 a[0:15], v[116:119], v[80:83], a[0:15]
    s_waitcnt vmcnt(12)
    v_mfma_f32_32x32x16_bf16 a[0:15], v[120:123], v[84:87], a[0:15]
    s_waitcnt vmcnt(10)
    v_mfma_f32_32x32x16_bf16 a[0:15], v[124:127], v[88:91], a[0:15]
    s_waitcnt vmcnt(8)
    v_mfma_f32_32x32x16_bf16 a[0:15], v[128:131], v[92:95], a[0:15]
    s_waitcnt vmcnt(6)
    v_mfma_f32_32x32x16_bf16 a[0:15], v[132:135], v[96:99], a[0:15]
    v_mfma_f32_32x32x16_bf16 a[16:31], v[136:139], v[64:67], 0
    v_mfma_f32_32x32x16_bf16 a[16:31], v[140:143], v[68:71], a[16:31]
    v_mfma_f32_32x32x16_bf16 a[16:31], v[144:147], v[72:75], a[16:31]
    v_mfma_f32_32x32x16_bf16 a[16:31], v[148:151], v[76:79], a[16:31]
    v_mfma_f32_32x32x16_bf16 a[16:31], v[152:155], v[80:83], a[16:31]
    v_mfma_f32_32x32x16_bf16 a[16:31], v[156:159], v[84:87], a[16:31]
    v_mfma_f32_32x32x16_bf16 a[16:31], v[160:163], v[88:91], a[16:31]
    v_mfma_f32_32x32x16_bf16 a[16:31], v[164:167], v[92:95], a[16:31]
    v_mfma_f32_32x32x16_bf16 a[16:31], v[168:171], v[96:99], a[16:31]
    v_mfma_f32_32x32x16_bf16 a[32:47], v[172:175], v[64:67], 0
    v_mfma_f32_32x32x16_bf16 a[32:47], v[176:179], v[68:71], a[32:47]
    v_mfma_f32_32x32x16_bf16 a[32:47], v[180:183], v[72:75], a[32:47]
    v_mfma_f32_32x32x16_bf16 a[32:47], v[184:187], v[76:79], a[32:47]
    v_mfma_f32_32x32x16_bf16 a[32:47], v[188:191], v[80:83], a[32:47]
    v_mfma_f32_32x32x16_bf16 a[32:47], v[192:195], v[84:87], a[32:47]
    v_mfma_f32_32x32x16_bf16 a[32:47], v[196:199], v[88:91], a[32:47]
    v_mfma_f32_32x32x16_bf16 a[32:47], v[200:203], v[92:95], a[32:47]
    v_mfma_f32_32x32x16_bf16 a[32:47], v[204:207], v[96:99], a[32:47]
L_q_tail:
    s_waitcnt vmcnt(0)
L_b3_done:
    s_lshl_b32 s3, s2, 7
    s_add_u32 s3, s3, 0x28000
    v_mov_b32 v1, s3
    v_mov_b32 v2, s64
    v_mov_b32 v3, s65
    s_cmp_lg_u32 s56, 0
    s_barrier
    s_cbranch_scc1 L_sig5_6330
    s_mov_b64 exec, 1
    buffer_store_dwordx2 v[2:3], v1, s[60:63], 0 offen sc1
    s_mov_b64 exec, -1
L_sig5_6330:
    s_cmp_ge_u32 s2, 192
    s_cbranch_scc1 L_b4_skip
    v_and_b32 v7, 63, v0
    v_lshlrev_b32 v7, 4, v7
    s_lshr_b32 s3, s2, 5
    s_mul_i32 s3, s3, 110592
    s_add_u32 s40, s4, 0x1268000
    s_addc_u32 s41, s5, 0
    s_add_u32 s40, s40, s3
    s_addc_u32 s41, s41, 0
    s_mov_b32 s42, 0x1b000
    s_mov_b32 s43, 0x20000
    s_cmp_lt_u32 s56, 4
    s_cbranch_scc1 L_b4_qe
    s_and_b32 s3, s56, 3
    s_mul_i32 s3, s3, 12288
    s_add_u32 s3, s3, 114688
    v_add_u32 v6, s3, v7
    ds_write_b128 v6, v[8:11] offset:0
    ds_write_b128 v6, v[12:15] offset:1024
    ds_write_b128 v6, v[16:19] offset:2048
    ds_write_b128 v6, v[20:23] offset:3072
    ds_write_b128 v6, v[24:27] offset:4096
    ds_write_b128 v6, v[28:31] offset:5120
    ds_write_b128 v6, v[32:35] offset:6144
    ds_write_b128 v6, v[36:39] offset:7168
    ds_write_b128 v6, v[40:43] offset:8192
    ds_write_b128 v6, v[44:47] offset:9216
    ds_write_b128 v6, v[48:51] offset:10240
    ds_write_b128 v6, v[52:55] offset:11264
    s_waitcnt lgkmcnt(0)
L_b4_qe:
    s_sub_u32 s44, s56, 0
    s_cmp_ge_u32 s44, 6
    s_cbranch_scc1 L_b4w_nd
    s_mul_i32 s44, s56, 18432
    s_mov_b32 m0, s44
    s_nop 0
    buffer_load_dwordx4 v7, s[40:43], s44 offen offset:0 sc1 lds
    buffer_load_dwordx4 v7, s[40:43], s44 offen offset:1024 sc1 lds
    buffer_load_dwordx4 v7, s[40:43], s44 offen offset:2048 sc1 lds
    buffer_load_dwordx4 v7, s[40:43], s44 offen offset:3072 sc1 lds
    s_add_u32 s44, s44, 0x1000
    s_mov_b32 m0, s44
    s_nop 0
    buffer_load_dwordx4 v7, s[40:43], s44 offen offset:0 sc1 lds
    buffer_load_dwordx4 v7, s[40:43], s44 offen offset:1024 sc1 lds
    buffer_load_dwordx4 v7, s[40:43], s44 offen offset:2048 sc1 lds
    buffer_load_dwordx4 v7, s[40:43], s44 offen offset:3072 sc1 lds
    s_add_u32 s44, s44, 0x1000
    s_mov_b32 m0, s44
    s_nop 0
    buffer_load_dwordx4 v7, s[40:43], s44 offen offset:0 sc1 lds
    buffer_load_dwordx4 v7, s[40:43], s44 offen offset:1024 sc1 lds
    buffer_load_dwordx4 v7, s[40:43], s44 offen offset:2048 sc1 lds
    buffer_load_dwordx4 v7, s[40:43], s44 offen offset:3072 sc1 lds
    s_add_u32 s44, s44, 0x1000
    s_mov_b32 m0, s44
    s_nop 0
    buffer_load_dwordx4 v7, s[40:43], s44 offen offset:0 sc1 lds
    buffer_load_dwordx4 v7, s[40:43], s44 offen offset:1024 sc1 lds
    buffer_load_dwordx4 v7, s[40:43], s44 offen offset:2048 sc1 lds
    buffer_load_dwordx4 v7, s[40:43], s44 offen offset:3072 sc1 lds
    s_add_u32 s44, s44, 0x1000
    s_mov_b32 m0, s44
    s_nop 0
    buffer_load_dwordx4 v7, s[40:43], s44 offen offset:0 sc1 lds
    buffer_load_dwordx4 v7, s[40:43], s44 offen offset:1024 sc1 lds
L_b4w_nd:
    s_and_b32 s20, s2, 7
    s_lshr_b32 s21, s2, 3
    s_and_b32 s22, s21, 3
    s_lshl_b32 s20, s20, 2
    s_add_u32 s22, s22, s20
    s_lshr_b32 s23, s21, 2
    v_and_b32 v1, 31, v0
    v_bfe_u32 v2, v0, 5, 1
    v_and_b32 v6, 63, v0
    v_lshlrev_b32 v7, 4, v6
    s_and_b32 s24, s56, 3
    s_lshr_b32 s57, s56, 2
    v_mul_u32_u24 v8, 1408, v2
    v_lshl_add_u32 v8, v1, 4, v8
    v_mov_b32 v4, 0x40000000
    v_cmp_gt_u32 vcc, 22, v1
    s_nop 1
    v_cndmask_b32 v8, v4, v8, vcc
    s_mul_i32 s25, s56, 5632
    s_lshl_b32 s26, s22, 1
    s_add_u32 s26, s26, s57
    s_mul_i32 s26, s26, 36
    s_mul_i32 s27, s24, 9
    s_add_u32 s26, s26, s27
    s_lshl_b32 s26, s26, 10
    s_add_u32 s16, s4, 0x1348000
    s_addc_u32 s17, s5, 0
    s_mov_b32 s18, 0x16000
    s_mov_b32 s19, 0x20000
    s_add_u32 s12, s4, 0xb40000
    s_addc_u32 s13, s5, 0
    s_add_u32 s12, s12, s26
    s_addc_u32 s13, s13, 0
    s_mov_b32 s14, 0x2400
    s_mov_b32 s15, 0x20000
    s_add_u32 s28, s25, 2816
    s_add_u32 s29, s25, 45056
    s_add_u32 s30, s29, 2816
    s_movk_i32 s31, 0x1000
    s_movk_i32 s27, 0x2000
    s_lshl_b32 s53, s56, 12
    s_add_u32 s53, s53, 114688
    v_lshrrev_b32 v115, 2, v6
    v_and_b32 v3, 3, v115
    v_lshrrev_b32 v112, 2, v115
    v_lshl_add_u32 v112, v3, 2, v112
    v_cmp_gt_u32 vcc, 16, v115
    s_nop 1
    v_cndmask_b32 v112, v115, v112, vcc
    v_cmp_lt_u32 vcc, 8, v112
    v_subrev_u32 v113, 9, v112
    s_nop 0
    v_cndmask_b32 v113, v112, v113, vcc
    v_cndmask_b32 v3, 0, 4, vcc
    v_and_b32 v5, 3, v113
    v_lshrrev_b32 v113, 2, v113
    v_lshl_add_u32 v5, v113, 3, v5
    v_add_u32 v114, v5, v3
    v_bfe_u32 v3, v6, 1, 1
    v_and_b32 v4, 1, v6
    v_lshlrev_b32 v116, 9, v3
    v_lshl_add_u32 v116, v4, 3, v116
    v_add_u32 v116, s53, v116
    v_lshl_add_u32 v9, v114, 4, v116
    v_cmp_gt_u32 s[48:49], 12, v1
    v_lshrrev_b32 v3, 2, v1
    v_add_u32 v3, 16, v3
    v_lshlrev_b32 v4, 1, v1
    v_subrev_u32 v4, 24, v4
    v_cndmask_b32 v115, v4, v3, s[48:49]
    v_and_b32 v3, 3, v115
    v_lshrrev_b32 v112, 2, v115
    v_lshl_add_u32 v112, v3, 2, v112
    v_cmp_gt_u32 vcc, 16, v115
    s_nop 1
    v_cndmask_b32 v112, v115, v112, vcc
    v_cmp_lt_u32 vcc, 8, v112
    v_subrev_u32 v113, 9, v112
    s_nop 0
    v_cndmask_b32 v113, v112, v113, vcc
    v_cndmask_b32 v3, 0, 4, vcc
    v_and_b32 v5, 3, v113
    v_lshrrev_b32 v113, 2, v113
    v_lshl_add_u32 v5, v113, 3, v5
    v_add_u32 v117, v5, v3
    v_cmp_eq_u32 vcc, 18, v112
    s_nop 1
    v_cndmask_b32 v118, v117, v5, vcc
    v_add_u32 v115, 1, v115
    v_and_b32 v3, 3, v115
    v_lshrrev_b32 v112, 2, v115
    v_lshl_add_u32 v112, v3, 2, v112
    v_cmp_gt_u32 vcc, 16, v115
    s_nop 1
    v_cndmask_b32 v112, v115, v112, vcc
    v_cmp_lt_u32 vcc, 8, v112
    v_subrev_u32 v113, 9, v112
    s_nop 0
    v_cndmask_b32 v113, v112, v113, vcc
    v_cndmask_b32 v3, 0, 4, vcc
    v_and_b32 v5, 3, v113
    v_lshrrev_b32 v113, 2, v113
    v_lshl_add_u32 v5, v113, 3, v5
    v_add_u32 v119, v5, v3
    v_lshl_add_u32 v116, v2, 10, v116
    s_lshl_b32 s53, s56, 9
    s_add_u32 s53, s53, 147456
    v_lshlrev_b32 v120, 7, v2
    v_add_u32 v120, s53, v120
    v_lshl_add_u32 v3, v117, 4, v116
    v_lshl_add_u32 v4, v117, 2, v120
    v_cndmask_b32 v10, v4, v3, s[48:49]
    v_lshl_add_u32 v3, v118, 4, v116
    v_lshl_add_u32 v4, v118, 2, v120
    v_cndmask_b32 v12, v4, v3, s[48:49]
    v_lshl_add_u32 v4, v119, 2, v120
    v_add_u32 v3, 4, v10
    v_cndmask_b32 v11, v4, v3, s[48:49]
    v_add_u32 v3, 4, v12
    v_cndmask_b32 v13, v4, v3, s[48:49]
    v_mov_b32 v3, 151552
    v_cmp_lt_u32 vcc, 21, v1
    s_nop 1
    v_cndmask_b32 v10, v10, v3, vcc
    v_cndmask_b32 v12, v12, v3, vcc
    v_cmp_lt_u32 vcc, 20, v1
    s_nop 1
    v_cndmask_b32 v11, v11, v3, vcc
    v_cndmask_b32 v13, v13, v3, vcc
    v_mov_b32 v3, 0x800
    v_mov_b32 v4, 0x100
    v_cndmask_b32 v14, v4, v3, s[48:49]
    v_lshlrev_b32 v3, 2, v0
    v_add_u32 v15, 152064, v3
    s_mov_b32 s32, s6
    s_mov_b32 s33, s7
    s_mov_b32 s34, 0x240000
    s_mov_b32 s35, 0x20000
    v_lshrrev_b32 v3, 3, v6
    s_lshl_b32 s53, s56, 3
    v_add_u32 v3, s53, v3
    v_and_b32 v4, 7, v6
    v_mul_u32_u24 v18, 144, v3
    v_lshl_add_u32 v18, v4, 4, v18
    v_and_b32 v5, 15, v3
    v_lshlrev_b32 v5, 1, v5
    v_bfe_u32 v16, v3, 4, 1
    v_add_u32 v5, v5, v16
    v_and_b32 v3, 32, v3
    v_add_u32 v5, v5, v3
    s_mov_b32 s53, 36864
    v_mul_lo_u32 v16, v5, s53
    v_lshl_add_u32 v16, v4, 3, v16
    s_mul_i32 s50, s22, 1152
    s_mul_i32 s51, s23, 192
    s_add_u32 s50, s50, s51
    s_mul_i32 s53, s24, 9216
    s_mul_i32 s55, s57, 4608
    s_add_u32 s53, s53, s55
    v_mul_u32_u24 v17, 144, v1
    v_lshl_add_u32 v17, v2, 4, v17
    v_add_u32 v17, s53, v17
    s_mul_i32 s53, s24, 9216
    v_add_u32 v19, s53, v7
    v_add_u32 v20, 73728, v19
    v_mov_b32 v72, 0
    v_mov_b32 v78, 0
    v_mov_b32 v73, 0
    v_mov_b32 v79, 0
    v_mov_b32 v74, 0
    v_mov_b32 v80, 0
    v_mov_b32 v75, 0
    v_mov_b32 v81, 0
    v_mov_b32 v76, 0
    v_mov_b32 v82, 0
    v_mov_b32 v77, 0
    v_mov_b32 v83, 0
    s_lshl_b32 s53, s24, 13
    s_add_u32 s53, s53, 114688
    v_add_u32 v84, s53, v7
    s_lshl_b32 s53, s24, 10
    s_add_u32 s53, s53, 147456
    v_lshlrev_b32 v85, 2, v1
    v_add_u32 v85, s53, v85
    v_mov_b32 v86, 0x358637bd
    v_subrev_u32 v32, 1, v2
    v_not_b32 v33, v32
    s_cmp_ge_u32 s56, 4
    s_cbranch_scc1 L_wait5_6576_d
    v_min_u32 v88, 255, v0
    v_lshlrev_b32 v88, 7, v88
    v_add_u32 v88, 0x28000, v88
    s_mov_b32 s3, 0
L_wait5_6576_p:
    buffer_load_dwordx2 v[92:93], v88, s[60:63], 0 offen sc1
    s_waitcnt vmcnt(0)
    v_cmp_ne_u64 vcc, s[64:65], v[92:93]
    s_nop 0
    s_mov_b64 exec, vcc
    s_add_u32 s3, s3, 1
    s_cmp_gt_u32 s3, 0x30d40
    s_cbranch_scc1 L_wait5_6576_x
    s_cmp_eq_u64 vcc, 0
    s_cbranch_scc1 L_wait5_6576_x
    s_sleep 1
    s_branch L_wait5_6576_p
L_wait5_6576_x:
    s_mov_b64 exec, -1
L_wait5_6576_d:
    s_barrier
    buffer_load_dwordx4 v[88:91], v7, s[16:19], s25 offen offset:0 sc1
    buffer_load_dwordx4 v[92:95], v7, s[16:19], s25 offen offset:1408 sc1
    buffer_load_dwordx4 v[96:99], v7, s[16:19], s28 offen offset:0 sc1
    buffer_load_dwordx4 v[100:103], v7, s[16:19], s28 offen offset:1408 sc1
    buffer_load_dwordx4 v[104:107], v8, s[16:19], s25 offen offset:1024 sc1
    buffer_load_dwordx4 v[108:111], v8, s[16:19], s28 offen offset:1024 sc1
    s_cmp_ge_u32 s56, 4
    s_cbranch_scc1 L_b4_qf
    s_mul_i32 s3, s56, 12288
    s_add_u32 s3, s3, 114688
    v_add_u32 v3, s3, v7
    ds_read_b128 a[0:3], v3 offset:0
    ds_read_b128 a[4:7], v3 offset:1024
    ds_read_b128 a[8:11], v3 offset:2048
    ds_read_b128 a[12:15], v3 offset:3072
    ds_read_b128 a[16:19], v3 offset:4096
    ds_read_b128 a[20:23], v3 offset:5120
    ds_read_b128 a[24:27], v3 offset:6144
    ds_read_b128 a[28:31], v3 offset:7168
    ds_read_b128 a[32:35], v3 offset:8192
    ds_read_b128 a[36:39], v3 offset:9216
    ds_read_b128 a[40:43], v3 offset:10240
    ds_read_b128 a[44:47], v3 offset:11264
L_b4_qf:
    s_waitcnt lgkmcnt(0)
    s_barrier
    buffer_load_dwordx4 v[200:203], v7, s[12:15], s27 offen offset:0 sc1
    buffer_load_dwordx4 v[168:171], v7, s[12:15], 0 offen offset:0 sc1
    buffer_load_dwordx4 v[172:175], v7, s[12:15], 0 offen offset:1024 sc1
    buffer_load_dwordx4 v[176:179], v7, s[12:15], 0 offen offset:2048 sc1
    buffer_load_dwordx4 v[180:183], v7, s[12:15], 0 offen offset:3072 sc1
    s_waitcnt vmcnt(10)
    v_cvt_pk_bf16_f32 v88, v88, v89
    v_cvt_pk_bf16_f32 v89, v90, v91
    ds_write_b64 v9, v[88:89] offset:0
    s_waitcnt vmcnt(9)
    v_cvt_pk_bf16_f32 v92, v92, v93
    v_cvt_pk_bf16_f32 v93, v94, v95
    ds_write_b64 v9, v[92:93] offset:1024
    s_waitcnt vmcnt(8)
    v_cvt_pk_bf16_f32 v96, v96, v97
    v_cvt_pk_bf16_f32 v97, v98, v99
    ds_write_b64 v9, v[96:97] offset:2048
    s_waitcnt vmcnt(7)
    v_cvt_pk_bf16_f32 v100, v100, v101
    v_cvt_pk_bf16_f32 v101, v102, v103
    ds_write_b64 v9, v[100:101] offset:3072
    s_waitcnt vmcnt(6)
    v_cvt_pk_bf16_f32 v104, v104, v105
    v_cvt_pk_bf16_f32 v105, v106, v107
    ds_write_b32 v10, v104
    ds_write_b32 v12, v104
    ds_write_b32 v11, v105
    ds_write_b32 v13, v105
    v_add_u32 v10, v10, v14
    v_add_u32 v12, v12, v14
    v_add_u32 v11, v11, v14
    v_add_u32 v13, v13, v14
    s_waitcnt vmcnt(5)
    v_cvt_pk_bf16_f32 v108, v108, v109
    v_cvt_pk_bf16_f32 v109, v110, v111
    ds_write_b32 v10, v108
    ds_write_b32 v12, v108
    ds_write_b32 v11, v109
    ds_write_b32 v13, v109
    s_waitcnt lgkmcnt(0)
    s_barrier
    ds_read_b128 v[88:91], v84 offset:0
    ds_read_b32 v120, v85 offset:0
    ds_read_b128 v[92:95], v84 offset:1024
    ds_read_b32 v121, v85 offset:128
    ds_read_b128 v[96:99], v84 offset:2048
    ds_read_b32 v122, v85 offset:256
    ds_read_b128 v[100:103], v84 offset:3072
    ds_read_b32 v123, v85 offset:384
    ds_read_b128 v[104:107], v84 offset:4096
    ds_read_b32 v124, v85 offset:512
    ds_read_b128 v[108:111], v84 offset:5120
    ds_read_b32 v125, v85 offset:640
    ds_read_b128 v[112:115], v84 offset:6144
    ds_read_b32 v126, v85 offset:768
    ds_read_b128 v[116:119], v84 offset:7168
    ds_read_b32 v127, v85 offset:896
    ds_read_b128 v[128:131], v19 offset:8192
    ds_read_b128 v[132:135], v19 offset:45056
    buffer_load_dwordx4 v[184:187], v7, s[12:15], s31 offen offset:0 sc1
    buffer_load_dwordx4 v[188:191], v7, s[12:15], s31 offen offset:1024 sc1
    s_waitcnt lgkmcnt(15)
    v_and_b32 v74, v32, v120
    s_waitcnt vmcnt(5)
    v_mfma_f32_32x32x16_bf16 v[136:151], v[88:91], v[168:171], 0
    v_mfma_f32_32x32x16_bf16 v[136:151], v[74:77], v[200:203], v[136:151]
    ds_read_b128 v[88:91], v19 offset:0
    ds_read_b128 v[168:171], v19 offset:36864
    buffer_load_dwordx4 v[192:195], v7, s[12:15], s31 offen offset:2048 sc1
    buffer_load_dwordx4 v[196:199], v7, s[12:15], s31 offen offset:3072 sc1
    s_waitcnt lgkmcnt(15)
    v_and_b32 v81, v32, v121
    s_waitcnt vmcnt(6)
    v_mfma_f32_32x32x16_bf16 v[152:167], v[92:95], v[172:175], 0
    v_mfma_f32_32x32x16_bf16 v[152:167], v[80:83], v[200:203], v[152:167]
    ds_read_b128 v[92:95], v19 offset:1024
    ds_read_b128 v[172:175], v19 offset:37888
    s_nop 0
    v_add_f32 v145, v145, v86
    v_rcp_f32 v145, v145
    s_nop 0
    v_mul_f32 v136, v136, v145
    v_mul_f32 v137, v137, v145
    v_mul_f32 v138, v138, v145
    v_mul_f32 v139, v139, v145
    v_mul_f32 v140, v140, v145
    v_mul_f32 v141, v141, v145
    v_mul_f32 v142, v142, v145
    v_mul_f32 v143, v143, v145
    v_mul_f32 v87, v144, v145
    v_cvt_pk_bf16_f32 v36, v136, v137
    v_cvt_pk_bf16_f32 v37, v138, v139
    v_cvt_pk_bf16_f32 v38, v140, v141
    v_cvt_pk_bf16_f32 v39, v142, v143
    s_waitcnt lgkmcnt(15)
    v_and_b32 v74, v32, v122
    s_waitcnt vmcnt(5)
    v_mfma_f32_32x32x16_bf16 v[136:151], v[96:99], v[176:179], 0
    v_mfma_f32_32x32x16_bf16 v[136:151], v[72:75], v[200:203], v[136:151]
    ds_read_b128 v[96:99], v19 offset:2048
    ds_read_b128 v[176:179], v19 offset:38912
    s_waitcnt lgkmcnt(5)
    v_mfma_f32_32x32x16_bf16 a[0:15], v[88:91], v[36:39], a[0:15]
    ds_read_b128 v[88:91], v20 offset:0
    v_add_f32 v161, v161, v86
    v_rcp_f32 v161, v161
    s_nop 0
    v_mul_f32 v152, v152, v161
    v_mul_f32 v153, v153, v161
    v_mul_f32 v154, v154, v161
    v_mul_f32 v155, v155, v161
    v_mul_f32 v156, v156, v161
    v_mul_f32 v157, v157, v161
    v_mul_f32 v158, v158, v161
    v_mul_f32 v159, v159, v161
    v_mul_f32 v160, v160, v161
    v_cvt_pk_bf16_f32 v40, v87, v152
    v_cvt_pk_bf16_f32 v41, v153, v154
    v_cvt_pk_bf16_f32 v42, v155, v156
    v_cvt_pk_bf16_f32 v43, v157, v158
    v_cvt_pk_bf16_f32 v44, v159, v160
    v_and_b32 v81, v32, v123
    s_waitcnt vmcnt(4)
    v_mfma_f32_32x32x16_bf16 v[152:167], v[100:103], v[180:183], 0
    v_mfma_f32_32x32x16_bf16 v[152:167], v[78:81], v[200:203], v[152:167]
    ds_read_b128 v[100:103], v19 offset:3072
    ds_read_b128 v[180:183], v19 offset:39936
    s_waitcnt lgkmcnt(6)
    v_mfma_f32_32x32x16_bf16 a[0:15], v[92:95], v[40:43], a[0:15]
    ds_read_b128 v[92:95], v20 offset:1024
    v_add_f32 v145, v145, v86
    v_rcp_f32 v145, v145
    s_nop 0
    v_mul_f32 v136, v136, v145
    v_mul_f32 v137, v137, v145
    v_mul_f32 v138, v138, v145
    v_mul_f32 v139, v139, v145
    v_mul_f32 v140, v140, v145
    v_mul_f32 v141, v141, v145
    v_mul_f32 v142, v142, v145
    v_mul_f32 v143, v143, v145
    v_mul_f32 v87, v144, v145
    v_cvt_pk_bf16_f32 v45, v136, v137
    v_cvt_pk_bf16_f32 v46, v138, v139
    v_cvt_pk_bf16_f32 v47, v140, v141
    v_cvt_pk_bf16_f32 v48, v142, v143
    v_and_b32 v74, v33, v124
    s_waitcnt vmcnt(3)
    v_mfma_f32_32x32x16_bf16 v[136:151], v[104:107], v[184:187], 0
    v_mfma_f32_32x32x16_bf16 v[136:151], v[74:77], v[200:203], v[136:151]
    ds_read_b128 v[104:107], v19 offset:4096
    ds_read_b128 v[184:187], v19 offset:40960
    s_waitcnt lgkmcnt(7)
    v_mfma_f32_32x32x16_bf16 a[0:15], v[96:99], v[44:47], a[0:15]
    ds_read_b128 v[96:99], v20 offset:2048
    v_add_f32 v161, v161, v86
    v_rcp_f32 v161, v161
    s_nop 0
    v_mul_f32 v152, v152, v161
    v_mul_f32 v153, v153, v161
    v_mul_f32 v154, v154, v161
    v_mul_f32 v155, v155, v161
    v_mul_f32 v156, v156, v161
    v_mul_f32 v157, v157, v161
    v_mul_f32 v158, v158, v161
    v_mul_f32 v159, v159, v161
    v_mul_f32 v160, v160, v161
    v_cvt_pk_bf16_f32 v49, v87, v152
    v_cvt_pk_bf16_f32 v50, v153, v154
    v_cvt_pk_bf16_f32 v51, v155, v156
    v_cvt_pk_bf16_f32 v52, v157, v158
    v_cvt_pk_bf16_f32 v53, v159, v160
    v_and_b32 v81, v33, v125
    s_waitcnt vmcnt(2)
    v_mfma_f32_32x32x16_bf16 v[152:167], v[108:111], v[188:191], 0
    v_mfma_f32_32x32x16_bf16 v[152:167], v[80:83], v[200:203], v[152:167]
    ds_read_b128 v[108:111], v19 offset:5120
    ds_read_b128 v[188:191], v19 offset:41984
    s_waitcnt lgkmcnt(7)
    v_mfma_f32_32x32x16_bf16 a[0:15], v[100:103], v[48:51], a[0:15]
    ds_read_b128 v[100:103], v20 offset:3072
    v_add_f32 v145, v145, v86
    v_rcp_f32 v145, v145
    s_nop 0
    v_mul_f32 v136, v136, v145
    v_mul_f32 v137, v137, v145
    v_mul_f32 v138, v138, v145
    v_mul_f32 v139, v139, v145
    v_mul_f32 v140, v140, v145
    v_mul_f32 v141, v141, v145
    v_mul_f32 v142, v142, v145
    v_mul_f32 v143, v143, v145
    v_mul_f32 v87, v144, v145
    v_cvt_pk_bf16_f32 v54, v136, v137
    v_cvt_pk_bf16_f32 v55, v138, v139
    v_cvt_pk_bf16_f32 v56, v140, v141
    v_cvt_pk_bf16_f32 v57, v142, v143
    v_and_b32 v74, v33, v126
    s_waitcnt vmcnt(1)
    v_mfma_f32_32x32x16_bf16 v[136:151], v[112:115], v[192:195], 0
    v_mfma_f32_32x32x16_bf16 v[136:151], v[72:75], v[200:203], v[136:151]
    ds_read_b128 v[112:115], v19 offset:6144
    ds_read_b128 v[192:195], v19 offset:43008
    s_waitcnt lgkmcnt(7)
    v_mfma_f32_32x32x16_bf16 a[0:15], v[104:107], v[52:55], a[0:15]
    ds_read_b128 v[104:107], v20 offset:4096
    v_add_f32 v161, v161, v86
    v_rcp_f32 v161, v161
    s_nop 0
    v_mul_f32 v152, v152, v161
    v_mul_f32 v153, v153, v161
    v_mul_f32 v154, v154, v161
    v_mul_f32 v155, v155, v161
    v_mul_f32 v156, v156, v161
    v_mul_f32 v157, v157, v161
    v_mul_f32 v158, v158, v161
    v_mul_f32 v159, v159, v161
    v_mul_f32 v160, v160, v161
    v_cvt_pk_bf16_f32 v58, v87, v152
    v_cvt_pk_bf16_f32 v59, v153, v154
    v_cvt_pk_bf16_f32 v60, v155, v156
    v_cvt_pk_bf16_f32 v61, v157, v158
    v_cvt_pk_bf16_f32 v62, v159, v160
    v_and_b32 v81, v33, v127
    s_waitcnt vmcnt(0)
    v_mfma_f32_32x32x16_bf16 v[152:167], v[116:119], v[196:199], 0
    v_mfma_f32_32x32x16_bf16 v[152:167], v[78:81], v[200:203], v[152:167]
    ds_read_b128 v[116:119], v19 offset:7168
    ds_read_b128 v[196:199], v19 offset:44032
    s_waitcnt lgkmcnt(7)
    v_mfma_f32_32x32x16_bf16 a[0:15], v[108:111], v[56:59], a[0:15]
    ds_read_b128 v[108:111], v20 offset:5120
    v_add_f32 v145, v145, v86
    v_rcp_f32 v145, v145
    s_nop 0
    v_mul_f32 v136, v136, v145
    v_mul_f32 v137, v137, v145
    v_mul_f32 v138, v138, v145
    v_mul_f32 v139, v139, v145
    v_mul_f32 v140, v140, v145
    v_mul_f32 v141, v141, v145
    v_mul_f32 v142, v142, v145
    v_mul_f32 v143, v143, v145
    v_mul_f32 v87, v144, v145
    v_cvt_pk_bf16_f32 v63, v136, v137
    v_cvt_pk_bf16_f32 v64, v138, v139
    v_cvt_pk_bf16_f32 v65, v140, v141
    v_cvt_pk_bf16_f32 v66, v142, v143
    ds_read_b128 v[200:203], v20 offset:8192
    s_waitcnt lgkmcnt(6)
    v_mfma_f32_32x32x16_bf16 a[0:15], v[112:115], v[60:63], a[0:15]
    ds_read_b128 v[112:115], v20 offset:6144
    v_mfma_f32_32x32x16_bf16 a[16:31], v[168:171], v[36:39], a[16:31]
    v_add_f32 v161, v161, v86
    v_rcp_f32 v161, v161
    s_nop 0
    v_mul_f32 v152, v152, v161
    v_mul_f32 v153, v153, v161
    v_mul_f32 v154, v154, v161
    v_mul_f32 v155, v155, v161
    v_mfma_f32_32x32x16_bf16 a[16:31], v[172:175], v[40:43], a[16:31]
    v_mul_f32 v156, v156, v161
    v_mul_f32 v157, v157, v161
    v_mul_f32 v158, v158, v161
    v_mul_f32 v159, v159, v161
    v_mul_f32 v160, v160, v161
    v_cvt_pk_bf16_f32 v67, v87, v152
    v_mfma_f32_32x32x16_bf16 a[16:31], v[176:179], v[44:47], a[16:31]
    v_cvt_pk_bf16_f32 v68, v153, v154
    v_cvt_pk_bf16_f32 v69, v155, v156
    v_cvt_pk_bf16_f32 v70, v157, v158
    v_cvt_pk_bf16_f32 v71, v159, v160
    s_waitcnt lgkmcnt(4)
    v_mfma_f32_32x32x16_bf16 a[0:15], v[116:119], v[64:67], a[0:15]
    ds_read_b128 v[116:119], v20 offset:7168
    v_mfma_f32_32x32x16_bf16 a[0:15], v[128:131], v[68:71], a[0:15]
    v_mfma_f32_32x32x16_bf16 a[16:31], v[180:183], v[48:51], a[16:31]
    s_waitcnt lgkmcnt(0)
    s_barrier
    v_mfma_f32_32x32x16_bf16 a[16:31], v[184:187], v[52:55], a[16:31]
    v_add_u32 v22, 114688, v17
    s_nop 6
    ds_write_b128 v22, a[0:3] offset:0
    v_mfma_f32_32x32x16_bf16 a[16:31], v[188:191], v[56:59], a[16:31]
    ds_write_b128 v22, a[4:7] offset:32
    ds_write_b128 v22, a[8:11] offset:64
    v_mfma_f32_32x32x16_bf16 a[16:31], v[192:195], v[60:63], a[16:31]
    ds_write_b128 v22, a[12:15] offset:96
    v_mfma_f32_32x32x16_bf16 a[16:31], v[196:199], v[64:67], a[16:31]
    v_mfma_f32_32x32x16_bf16 a[16:31], v[132:135], v[68:71], a[16:31]
    s_waitcnt lgkmcnt(0)
    s_barrier
    v_mfma_f32_32x32x16_bf16 a[32:47], v[88:91], v[36:39], a[32:47]
    v_add_u32 v23, 114688, v18
    ds_read_b128 v[72:75], v23 offset:0
    ds_read_b128 v[76:79], v23 offset:9216
    ds_read_b128 v[80:83], v23 offset:18432
    v_mfma_f32_32x32x16_bf16 a[32:47], v[92:95], v[40:43], a[32:47]
    ds_read_b128 v[84:87], v23 offset:27648
    s_nop 0
    s_nop 0
    s_nop 0
    v_mfma_f32_32x32x16_bf16 a[32:47], v[96:99], v[44:47], a[32:47]
    ds_write_b128 v17, a[16:19] offset:0
    ds_write_b128 v17, a[20:23] offset:32
    ds_write_b128 v17, a[24:27] offset:64
    ds_write_b128 v17, a[28:31] offset:96
    v_mfma_f32_32x32x16_bf16 a[32:47], v[100:103], v[48:51], a[32:47]
    s_waitcnt lgkmcnt(6)
    v_add_f32 v72, v72, v76
    v_add_f32 v73, v73, v77
    v_add_f32 v74, v74, v78
    v_add_f32 v75, v75, v79
    v_mfma_f32_32x32x16_bf16 a[32:47], v[104:107], v[52:55], a[32:47]
    s_waitcnt lgkmcnt(4)
    v_add_f32 v80, v80, v84
    v_add_f32 v81, v81, v85
    v_add_f32 v82, v82, v86
    v_add_f32 v83, v83, v87
    v_mfma_f32_32x32x16_bf16 a[32:47], v[108:111], v[56:59], a[32:47]
    v_add_f32 v72, v72, v80
    v_add_f32 v73, v73, v81
    v_add_f32 v74, v74, v82
    v_add_f32 v75, v75, v83
    v_mfma_f32_32x32x16_bf16 a[32:47], v[112:115], v[60:63], a[32:47]
    v_cvt_pk_bf16_f32 v24, v72, v73
    v_cvt_pk_bf16_f32 v25, v74, v75
    buffer_store_dwordx2 v[24:25], v16, s[32:35], s50 offen offset:0 sc1
    v_mfma_f32_32x32x16_bf16 a[32:47], v[116:119], v[64:67], a[32:47]
    v_mfma_f32_32x32x16_bf16 a[32:47], v[200:203], v[68:71], a[32:47]
    v_add_u32 v22, 36864, v17
    s_nop 10
    ds_write_b128 v22, a[32:35] offset:0
    ds_write_b128 v22, a[36:39] offset:32
    ds_write_b128 v22, a[40:43] offset:64
    ds_write_b128 v22, a[44:47] offset:96
    s_waitcnt lgkmcnt(0)
    s_barrier
    ds_read_b128 v[72:75], v18 offset:0
    ds_read_b128 v[76:79], v18 offset:9216
    ds_read_b128 v[80:83], v18 offset:18432
    ds_read_b128 v[84:87], v18 offset:27648
    v_add_u32 v23, 36864, v18
    ds_read_b128 v[136:139], v23 offset:0
    ds_read_b128 v[140:143], v23 offset:9216
    ds_read_b128 v[144:147], v23 offset:18432
    ds_read_b128 v[148:151], v23 offset:27648
    s_waitcnt lgkmcnt(6)
    v_add_f32 v72, v72, v76
    v_add_f32 v73, v73, v77
    v_add_f32 v74, v74, v78
    v_add_f32 v75, v75, v79
    s_waitcnt lgkmcnt(4)
    v_add_f32 v80, v80, v84
    v_add_f32 v81, v81, v85
    v_add_f32 v82, v82, v86
    v_add_f32 v83, v83, v87
    v_add_f32 v72, v72, v80
    v_add_f32 v73, v73, v81
    v_add_f32 v74, v74, v82
    v_add_f32 v75, v75, v83
    v_cvt_pk_bf16_f32 v26, v72, v73
    v_cvt_pk_bf16_f32 v27, v74, v75
    buffer_store_dwordx2 v[26:27], v16, s[32:35], s50 offen offset:64 sc1
    s_waitcnt lgkmcnt(2)
    v_add_f32 v136, v136, v140
    v_add_f32 v137, v137, v141
    v_add_f32 v138, v138, v142
    v_add_f32 v139, v139, v143
    s_waitcnt lgkmcnt(0)
    v_add_f32 v144, v144, v148
    v_add_f32 v145, v145, v149
    v_add_f32 v146, v146, v150
    v_add_f32 v147, v147, v151
    v_add_f32 v136, v136, v144
    v_add_f32 v137, v137, v145
    v_add_f32 v138, v138, v146
    v_add_f32 v139, v139, v147
    v_cvt_pk_bf16_f32 v28, v136, v137
    v_cvt_pk_bf16_f32 v29, v138, v139
    buffer_store_dwordx2 v[28:29], v16, s[32:35], s50 offen offset:128 sc1
L_b4_skip:
L_end:
    s_endpgm
L_interleave_layers__spectral_gfnet__linear_attn_block__prompt_kernel_codeend:
.section .rodata,"a"
.p2align 6
.amdhsa_kernel interleave_layers__spectral_gfnet__linear_attn_block__prompt_kernel
  .amdhsa_next_free_vgpr 256
  .amdhsa_next_free_sgpr 72
  .amdhsa_accum_offset 208
  .amdhsa_group_segment_fixed_size 0
  .amdhsa_kernarg_size 72
  .amdhsa_user_sgpr_count 2
  .amdhsa_user_sgpr_kernarg_segment_ptr 1
  .amdhsa_system_sgpr_workgroup_id_x 1
.end_amdhsa_kernel
```
